```python
import torch

def _softmax(x, axis=-1):
    return torch.softmax(x, dim=axis)
def _gelu(x):
    return torch.nn.functional.gelu(x, approximate="tanh")
def _silu(x):
    return torch.nn.functional.silu(x)
def _sigmoid(x):
    return torch.sigmoid(x)
def _layernorm(x, axis=-1, eps=1e-5):
    m = x.mean(dim=axis, keepdim=True)
    v = x.var(dim=axis, keepdim=True, unbiased=False)
    return (x - m) / torch.sqrt(v + eps)
def _scatter_add(tgt, idx, src, axis=0):
    return tgt.clone().index_add_(axis, idx, src)
def _segment_sum(src, seg, n):
    out = torch.zeros((n,) + src.shape[1:], dtype=src.dtype)
    return out.index_add_(0, seg, src)
def _pad(x, pw):
    flat = tuple(v for pair in reversed(pw) for v in pair)
    return torch.nn.functional.pad(x, flat)

kernel_name = 'parallel_sum__sliding_block__glu_gated_glu__prompt'

def setup_inputs():

    _w = (lambda a: (lambda t: t.to(torch.bfloat16) if t.is_floating_point() else t)(torch.as_tensor(a)))
    def _A_setup():
        B, S, D = 1, 2048, 640
        return {
            "x": _w((lambda *s: torch.randn(*s, dtype=torch.bfloat16) * 0.05)(B, S, D)),
            "wqkv": _w((lambda *s: torch.randn(*s, dtype=torch.bfloat16) * 0.05)(D, 3 * D)),
            "wo": _w((lambda *s: torch.randn(*s, dtype=torch.bfloat16) * 0.05)(D, D)),
        }
    _A_in = _A_setup()

    def _B_setup():
        B, S, D, F = 1, 2048, 640, 1728
        return {
            "x": _w((lambda *s: torch.randn(*s, dtype=torch.bfloat16) * 0.05)(B, S, D)),
            "w_gate": _w((lambda *s: torch.randn(*s, dtype=torch.bfloat16) * 0.05)(D, F)),
            "w_up": _w((lambda *s: torch.randn(*s, dtype=torch.bfloat16) * 0.05)(D, F)),
            "w_down": _w((lambda *s: torch.randn(*s, dtype=torch.bfloat16) * 0.05)(F, D)),
        }
    _B_in = _B_setup()

    return {
        "A_x": _A_in["x"],
        "A_wqkv": _A_in["wqkv"],
        "A_wo": _A_in["wo"],
        "B_x": _B_in["x"],
        "B_w_gate": _B_in["w_gate"],
        "B_w_up": _B_in["w_up"],
        "B_w_down": _B_in["w_down"],
    }

def reference(A_x, A_wqkv, A_wo, B_x, B_w_gate, B_w_up, B_w_down):
    def _A_ref(x, wqkv, wo):
        B, S, D = x.shape
        H = 32; Dh = D // H; W = 256
        qkv = (lambda x, *d: x.permute(*d))((x @ wqkv).reshape(B, S, 3, H, Dh), 2, 0, 3, 1, 4)
        q, k, v = qkv[0], qkv[1], qkv[2]
        scores = torch.einsum("bhqd,bhkd->bhqk", q, k) * (Dh ** -0.5)
        idx = torch.arange(S)
        mask = (idx[:, None] - idx[None, :] >= 0) & (idx[:, None] - idx[None, :] < W)
        scores = torch.where(mask[None, None], scores, -1e9)
        p = _softmax(scores, axis=-1)
        o = torch.einsum("bhqk,bhkd->bhqd", p, v)
        return (lambda x, *d: x.permute(*d))(o, 0, 2, 1, 3).reshape(B, S, D) @ wo

    def _B_ref(x, w_gate, w_up, w_down):
        g = torch.einsum("bsd,df->bsf", x, w_gate)
        u = torch.einsum("bsd,df->bsf", x, w_up)
        h = _sigmoid(g) * u
        return torch.einsum("bsf,fd->bsd", h, w_down)

    x = A_x
    xn = _layernorm(x, axis=-1)
    return x + _A_ref(xn, A_wqkv, A_wo) + _B_ref(xn, B_w_gate, B_w_up, B_w_down)
```

```asm
; @launch kernel=k1_kernel grid=(256,1,1) block=(256,1,1) lds=163840
; @launch kernel=k2_kernel grid=(256,1,1) block=(512,1,1) lds=162304
.amdgcn_target "amdgcn-amd-amdhsa--gfx950"
.text
.globl k1_kernel
.p2align 8
.type k1_kernel,@function
k1_kernel:
s_cmp_ge_u32 s2, 256
s_cbranch_scc1 K1_END
s_load_dwordx4 s[76:79], s[0:1], 0
s_load_dwordx4 s[80:83], s[0:1], 32
s_load_dwordx2 s[84:85], s[0:1], 72
s_load_dwordx2 s[74:75], s[0:1], 48
s_load_dwordx2 s[86:87], s[0:1], 16
v_and_b32 v1, 63, v0
v_lshrrev_b32 v28, 6, v0
s_and_b32 s50, s2, 3
v_readfirstlane_b32 s32, v28
s_lshl_b32 s50, s50, 2
s_bfe_u32 s51, s2, 0x20003
s_add_u32 s33, s50, s51
s_bfe_u32 s50, s2, 0x10002
s_lshl_b32 s50, s50, 3
s_lshr_b32 s52, s2, 5
s_add_u32 s34, s50, s52
s_mul_i32 s50, s51, 5
s_lshr_b32 s50, s50, 1
s_add_u32 s64, s50, s52
s_cmp_ge_u32 s64, 10
s_cselect_b32 s50, 10, 0
s_sub_u32 s64, s64, s50
s_lshr_b32 s35, s34, 3
s_lshl_b32 s50, s33, 2
s_add_u32 s50, s50, s32
s_mul_i32 s36, s50, 40960
s_lshl_b32 s62, s32, 13
s_add_u32 s62, s62, 131072
s_lshr_b32 s50, s32, 1
s_lshl_b32 s47, s50, 13
s_and_b32 s50, s32, 1
s_lshl_b32 s50, s50, 12
s_add_u32 s47, s47, s50
v_lshrrev_b32 v28, 3, v1
v_mul_u32_u24 v28, 1280, v28
v_lshrrev_b32 v29, 4, v1
v_and_b32 v30, 7, v1
v_xor_b32 v31, v30, v29
v_xor_b32 v32, 4, v31
v_lshl_add_u32 v2, v31, 4, v28
v_lshl_add_u32 v3, v32, 4, v28
s_lshl_b32 s52, s64, 7
s_waitcnt lgkmcnt(0)
s_mov_b32 s4, s76
s_and_b32 s5, s77, 0xffff
s_mov_b32 s6, 2621440
s_mov_b32 s7, 0x20000
s_mov_b32 s65, s52
s_add_u32 s51, s36, s65
s_add_u32 m0, s47, 0
s_add_u32 s50, s51, 0
buffer_load_dwordx4 v2, s[4:7], s50 offen lds
s_add_u32 m0, s47, 1024
s_add_u32 s50, s51, 10240
buffer_load_dwordx4 v3, s[4:7], s50 offen lds
s_add_u32 m0, s47, 2048
s_add_u32 s50, s51, 20480
buffer_load_dwordx4 v2, s[4:7], s50 offen lds
s_add_u32 m0, s47, 3072
s_add_u32 s50, s51, 30720
buffer_load_dwordx4 v3, s[4:7], s50 offen lds
s_add_u32 s65, s65, 128
s_cmp_ge_u32 s65, 1280
s_cselect_b32 s50, 1280, 0
s_sub_u32 s65, s65, s50
s_add_u32 s51, s36, s65
s_add_u32 m0, s47, 16384
s_add_u32 s50, s51, 0
buffer_load_dwordx4 v2, s[4:7], s50 offen lds
s_add_u32 m0, s47, 17408
s_add_u32 s50, s51, 10240
buffer_load_dwordx4 v3, s[4:7], s50 offen lds
s_add_u32 m0, s47, 18432
s_add_u32 s50, s51, 20480
buffer_load_dwordx4 v2, s[4:7], s50 offen lds
s_add_u32 m0, s47, 19456
s_add_u32 s50, s51, 30720
buffer_load_dwordx4 v3, s[4:7], s50 offen lds
s_add_u32 s65, s65, 128
s_cmp_ge_u32 s65, 1280
s_cselect_b32 s50, 1280, 0
s_sub_u32 s65, s65, s50
s_add_u32 s51, s36, s65
s_add_u32 m0, s47, 32768
s_add_u32 s50, s51, 0
buffer_load_dwordx4 v2, s[4:7], s50 offen lds
s_add_u32 m0, s47, 33792
s_add_u32 s50, s51, 10240
buffer_load_dwordx4 v3, s[4:7], s50 offen lds
s_add_u32 m0, s47, 34816
s_add_u32 s50, s51, 20480
buffer_load_dwordx4 v2, s[4:7], s50 offen lds
s_add_u32 m0, s47, 35840
s_add_u32 s50, s51, 30720
buffer_load_dwordx4 v3, s[4:7], s50 offen lds
s_add_u32 s65, s65, 128
s_cmp_ge_u32 s65, 1280
s_cselect_b32 s50, 1280, 0
s_sub_u32 s65, s65, s50
s_mov_b32 s8, s78
s_and_b32 s9, s79, 0xffff
s_mov_b32 s10, 2457600
s_mov_b32 s11, 0x20000
s_mov_b32 s12, s80
s_and_b32 s13, s81, 0xffff
s_mov_b32 s14, 2211840
s_mov_b32 s15, 0x20000
s_mov_b32 s16, s82
s_and_b32 s17, s83, 0xffff
s_mov_b32 s18, 2211840
s_mov_b32 s19, 0x20000
s_mov_b32 s20, s84
s_and_b32 s21, s85, 0xffff
s_mov_b32 s22, 25165824
s_mov_b32 s23, 0x20000
s_getpc_b64 s[76:77]
K1_PFB:
s_lshr_b32 s50, s2, 3
s_lshl_b32 s50, s50, 2
s_add_u32 s50, s50, s32
s_lshl_b32 s50, s50, 2
s_mov_b32 s51, TEXT_END-K1_PFB-4
v_add_u32 v33, s50, v1
v_lshlrev_b32 v33, 7, v33
v_min_u32 v33, s51, v33
s_mov_b64 exec, 15
global_load_dword v27, v33, s[76:77]
s_mov_b64 exec, -1
s_mul_i32 s50, s34, 3
s_add_u32 s50, s50, 8
s_and_b32 s51, s50, 1
s_add_u32 s66, s50, s51
s_min_u32 s66, s66, 52
s_xor_b32 s51, s51, 1
s_lshl_b32 s51, s51, 1
s_add_u32 s67, s50, s51
s_min_u32 s67, s67, 53
s_lshl_b32 s50, s34, 2
s_add_u32 s51, s50, 2
s_cmp_eq_u32 s35, 0
s_cselect_b32 s66, s50, s66
s_cselect_b32 s67, s51, s67
s_mul_i32 s50, s34, 3
s_mul_i32 s51, s34, 5
s_sub_u32 s51, s51, 16
s_cmp_eq_u32 s35, 0
s_cselect_b32 s50, s50, s51
s_cselect_b32 s52, 0, 2
s_and_b32 s51, s50, 1
s_add_u32 s68, s50, s51
s_add_u32 s69, s68, s52
s_add_u32 s52, s52, 2
s_cmp_eq_u32 s51, 0
s_cselect_b32 s52, s52, 0
s_add_u32 s70, s50, s52
s_min_u32 s68, s68, 58
s_min_u32 s69, s69, 58
s_min_u32 s70, s70, 59
s_lshl_b32 s52, s33, 2
s_add_u32 s52, s52, s32
s_mul_i32 s50, s52, 110592
s_add_u32 s50, s50, 8388608
s_add_u32 s51, s66, 0
s_min_u32 s51, s51, 53
s_lshl_b32 s51, s51, 11
s_add_u32 s53, s51, s50
s_add_u32 s51, s66, 1
s_min_u32 s51, s51, 53
s_lshl_b32 s51, s51, 11
s_add_u32 s54, s51, s50
s_add_u32 s51, s67, 0
s_min_u32 s51, s51, 53
s_lshl_b32 s51, s51, 11
s_add_u32 s55, s51, s50
s_add_u32 s51, s67, 1
s_min_u32 s51, s51, 53
s_lshl_b32 s51, s51, 11
s_add_u32 s56, s51, s50
s_lshl_b32 s50, s52, 8
s_add_u32 s50, s50, 0
s_add_u32 s51, s68, 0
s_lshl_b32 s51, s51, 17
s_add_u32 s57, s51, s50
s_add_u32 s51, s68, 1
s_lshl_b32 s51, s51, 17
s_add_u32 s58, s51, s50
s_add_u32 s51, s69, 0
s_lshl_b32 s51, s51, 17
s_add_u32 s59, s51, s50
s_add_u32 s51, s69, 1
s_lshl_b32 s51, s51, 17
s_add_u32 s60, s51, s50
s_add_u32 s51, s70, 0
s_lshl_b32 s51, s51, 17
s_add_u32 s61, s51, s50
s_and_b32 s50, s32, 1
s_and_b32 s71, s50, s35
s_cmp_eq_u32 s50, 0
s_cselect_b32 s51, s66, s67
s_lshl_b32 s51, s51, 6
s_lshr_b32 s52, s32, 1
s_mul_i32 s50, s52, 55296
s_add_u32 s51, s51, s50
s_mov_b32 s37, s51
s_add_u32 s38, s51, 27648
s_mov_b32 s39, s51
s_add_u32 s40, s51, 27648
s_lshl_b32 s50, s68, 6
s_mul_i32 s52, s52, 61440
s_add_u32 s50, s50, s52
s_add_u32 s52, s50, 30720
s_cmp_eq_u32 s71, 1
s_cselect_b32 s38, s51, s38
s_cselect_b32 s39, s50, s39
s_cselect_b32 s40, s52, s40
s_cselect_b32 s24, s16, s12
s_cselect_b32 s25, s17, s13
s_mov_b32 s26, 2211840
s_mov_b32 s27, 0x20000
s_cselect_b32 s28, s8, s16
s_cselect_b32 s29, s9, s17
s_cselect_b32 s30, s10, s18
s_mov_b32 s31, 0x20000
s_mov_b32 s43, 110592
s_cselect_b32 s43, 122880, s43
s_mul_i32 s41, s64, 221184
s_mul_i32 s42, s64, s43
s_lshl_b32 s42, s42, 1
s_and_b32 s50, s32, 1
s_mul_i32 s50, s50, 122880
s_lshl_b32 s44, s69, 6
s_add_u32 s44, s44, s50
s_lshl_b32 s45, s70, 6
s_add_u32 s45, s45, s50
s_lshr_b32 s50, s32, 1
s_add_u32 s50, s50, s64
s_cmp_ge_u32 s50, 10
s_cselect_b32 s51, 10, 0
s_sub_u32 s50, s50, s51
s_mul_i32 s46, s50, 245760
s_mul_i32 s48, s32, 6144
s_mov_b32 s49, 0xffff0000
s_mov_b32 s63, 0x3fb8aa3b
v_lshrrev_b32 v28, 3, v1
v_bfe_u32 v29, v1, 4, 1
v_lshlrev_b32 v29, 2, v29
v_and_b32 v30, 7, v1
v_xor_b32 v29, v29, v30
v_lshlrev_b32 v29, 4, v29
v_mul_u32_u24 v30, 3456, v28
v_add_u32 v30, v30, v29
v_mul_u32_u24 v21, 3840, v28
v_add_u32 v21, v21, v29
v_bfe_u32 v31, v1, 2, 2
v_lshrrev_b32 v32, 5, v1
v_lshl_add_u32 v31, v32, 2, v31
v_bfe_u32 v32, v1, 4, 1
v_lshl_add_u32 v31, v32, 3, v31
v_and_b32 v32, 3, v1
v_lshlrev_b32 v32, 4, v32
v_mul_u32_u24 v33, 3456, v31
v_add_u32 v33, v33, v32
v_mul_u32_u24 v22, 3840, v31
v_add_u32 v22, v22, v32
s_cmp_eq_u32 s71, 1
s_cselect_b64 vcc, -1, 0
v_cndmask_b32 v19, v30, v33, vcc
v_cndmask_b32 v20, v30, v21, vcc
v_lshrrev_b32 v28, 5, v1
v_bfe_u32 v29, v1, 2, 2
v_bfe_u32 v30, v1, 4, 1
v_lshlrev_b32 v30, 5, v30
v_and_b32 v31, 3, v1
v_lshl_add_u32 v30, v31, 3, v30
v_lshl_add_u32 v31, v28, 3, v29
v_lshlrev_b32 v31, 7, v31
v_bfe_u32 v32, v1, 3, 1
v_lshl_add_u32 v31, v32, 6, v31
v_add_u32 v12, v31, v30
v_xor_b32 v13, 64, v12
v_lshl_add_u32 v31, v28, 2, v29
v_lshl_add_u32 v33, v31, 6, v30
v_add_u32 v14, 2048, v33
s_cmp_eq_u32 s35, 0
s_cselect_b64 vcc, -1, 0
v_add_u32 v34, 4096, v33
v_add_u32 v35, 4096, v12
v_cndmask_b32 v15, v34, v35, vcc
v_add_u32 v34, 5120, v33
v_add_u32 v35, 6144, v12
v_cndmask_b32 v16, v34, v35, vcc
v_add_u32 v34, 6144, v12
v_add_u32 v35, 4096, v13
v_cndmask_b32 v17, v34, v35, vcc
v_add_u32 v18, 6144, v13
v_lshlrev_b32 v23, 4, v1
v_and_b32 v29, 31, v1
v_lshlrev_b32 v30, 3, v29
v_lshl_add_u32 v25, v28, 14, v30
v_bfe_u32 v30, v1, 1, 3
v_lshlrev_b32 v31, 7, v29
v_add_u32 v32, 0, v28
v_xor_b32 v32, v32, v30
v_lshl_add_u32 v32, v32, 4, v31
v_add_u32 v4, s62, v32
v_add_u32 v8, s47, v32
v_add_u32 v32, 2, v28
v_xor_b32 v32, v32, v30
v_lshl_add_u32 v32, v32, 4, v31
v_add_u32 v5, s62, v32
v_add_u32 v9, s47, v32
v_add_u32 v32, 4, v28
v_xor_b32 v32, v32, v30
v_lshl_add_u32 v32, v32, 4, v31
v_add_u32 v6, s62, v32
v_add_u32 v10, s47, v32
v_add_u32 v32, 6, v28
v_xor_b32 v32, v32, v30
v_lshl_add_u32 v32, v32, 4, v31
v_add_u32 v7, s62, v32
v_add_u32 v11, s47, v32
v_and_b32 v32, 7, v1
v_bfe_u32 v33, v1, 4, 1
v_lshlrev_b32 v33, 2, v33
v_cmp_eq_u32 vcc, v32, v33
v_mov_b32 v34, 0x3f803f80
s_nop 0
v_cndmask_b32 v40, 0, v34, vcc
v_mov_b32 v41, v40
v_mov_b32 v42, v40
v_mov_b32 v43, v40
v_mov_b32 v28, 0
v_mov_b32 v29, 0
v_mov_b32 v30, 0
v_mov_b32 v31, 0
v_mov_b32 v32, 0
s_lshl_b32 s50, s2, 4
s_add_u32 s50, s50, 19922944
s_mov_b64 exec, 1
buffer_store_dwordx4 v[28:31], v32, s[20:23], s50 offen sc1
s_mov_b64 exec, -1
s_waitcnt vmcnt(10)
ds_read_b128 v[96:99], v8 offset:0
ds_read_b128 v[100:103], v9 offset:0
ds_read_b128 v[104:107], v10 offset:0
ds_read_b128 v[108:111], v11 offset:0
s_add_u32 s51, s36, s65
s_add_u32 m0, s47, 49152
s_add_u32 s50, s51, 0
buffer_load_dwordx4 v2, s[4:7], s50 offen lds
s_add_u32 m0, s47, 50176
s_add_u32 s50, s51, 10240
buffer_load_dwordx4 v3, s[4:7], s50 offen lds
s_add_u32 m0, s47, 51200
s_add_u32 s50, s51, 20480
buffer_load_dwordx4 v2, s[4:7], s50 offen lds
s_add_u32 m0, s47, 52224
s_add_u32 s50, s51, 30720
buffer_load_dwordx4 v3, s[4:7], s50 offen lds
s_add_u32 s65, s65, 128
s_cmp_ge_u32 s65, 1280
s_cselect_b32 s50, 1280, 0
s_sub_u32 s65, s65, s50
s_waitcnt vmcnt(10)
ds_read_b128 v[112:115], v8 offset:16384
ds_read_b128 v[116:119], v9 offset:16384
ds_read_b128 v[120:123], v10 offset:16384
ds_read_b128 v[124:127], v11 offset:16384
s_add_u32 s51, s36, s65
s_add_u32 m0, s47, 65536
s_add_u32 s50, s51, 0
buffer_load_dwordx4 v2, s[4:7], s50 offen lds
s_add_u32 m0, s47, 66560
s_add_u32 s50, s51, 10240
buffer_load_dwordx4 v3, s[4:7], s50 offen lds
s_add_u32 m0, s47, 67584
s_add_u32 s50, s51, 20480
buffer_load_dwordx4 v2, s[4:7], s50 offen lds
s_add_u32 m0, s47, 68608
s_add_u32 s50, s51, 30720
buffer_load_dwordx4 v3, s[4:7], s50 offen lds
s_add_u32 s65, s65, 128
s_cmp_ge_u32 s65, 1280
s_cselect_b32 s50, 1280, 0
s_sub_u32 s65, s65, s50
s_waitcnt lgkmcnt(7)
v_mfma_f32_32x32x16_bf16 v[80:95], v[96:99], v[96:99], 0
v_mfma_f32_16x16x32_bf16 v[44:47], v[40:43], v[96:99], 0
s_waitcnt lgkmcnt(6)
v_mfma_f32_32x32x16_bf16 v[80:95], v[100:103], v[100:103], v[80:95]
v_mfma_f32_16x16x32_bf16 v[44:47], v[40:43], v[100:103], v[44:47]
s_waitcnt lgkmcnt(5)
v_mfma_f32_32x32x16_bf16 v[80:95], v[104:107], v[104:107], v[80:95]
v_mfma_f32_16x16x32_bf16 v[44:47], v[40:43], v[104:107], v[44:47]
s_waitcnt lgkmcnt(4)
v_mfma_f32_32x32x16_bf16 v[80:95], v[108:111], v[108:111], v[80:95]
v_mfma_f32_16x16x32_bf16 v[44:47], v[40:43], v[108:111], v[44:47]
s_waitcnt vmcnt(10)
ds_read_b128 v[128:131], v8 offset:32768
ds_read_b128 v[132:135], v9 offset:32768
ds_read_b128 v[136:139], v10 offset:32768
ds_read_b128 v[140:143], v11 offset:32768
s_add_u32 s51, s36, s65
s_add_u32 m0, s47, 81920
s_add_u32 s50, s51, 0
buffer_load_dwordx4 v2, s[4:7], s50 offen lds
s_add_u32 m0, s47, 82944
s_add_u32 s50, s51, 10240
buffer_load_dwordx4 v3, s[4:7], s50 offen lds
s_add_u32 m0, s47, 83968
s_add_u32 s50, s51, 20480
buffer_load_dwordx4 v2, s[4:7], s50 offen lds
s_add_u32 m0, s47, 84992
s_add_u32 s50, s51, 30720
buffer_load_dwordx4 v3, s[4:7], s50 offen lds
s_add_u32 s65, s65, 128
s_cmp_ge_u32 s65, 1280
s_cselect_b32 s50, 1280, 0
s_sub_u32 s65, s65, s50
s_waitcnt lgkmcnt(7)
v_mfma_f32_32x32x16_bf16 v[80:95], v[112:115], v[112:115], v[80:95]
v_mfma_f32_16x16x32_bf16 v[44:47], v[40:43], v[112:115], v[44:47]
s_waitcnt lgkmcnt(6)
v_mfma_f32_32x32x16_bf16 v[80:95], v[116:119], v[116:119], v[80:95]
v_mfma_f32_16x16x32_bf16 v[44:47], v[40:43], v[116:119], v[44:47]
s_waitcnt lgkmcnt(5)
v_mfma_f32_32x32x16_bf16 v[80:95], v[120:123], v[120:123], v[80:95]
v_mfma_f32_16x16x32_bf16 v[44:47], v[40:43], v[120:123], v[44:47]
s_waitcnt lgkmcnt(4)
v_mfma_f32_32x32x16_bf16 v[80:95], v[124:127], v[124:127], v[80:95]
v_mfma_f32_16x16x32_bf16 v[44:47], v[40:43], v[124:127], v[44:47]
s_waitcnt vmcnt(8)
ds_read_b128 v[144:147], v8 offset:49152
ds_read_b128 v[148:151], v9 offset:49152
ds_read_b128 v[152:155], v10 offset:49152
ds_read_b128 v[156:159], v11 offset:49152
s_add_u32 s51, s36, s65
s_add_u32 m0, s47, 98304
s_add_u32 s50, s51, 0
buffer_load_dwordx4 v2, s[4:7], s50 offen lds
s_add_u32 m0, s47, 99328
s_add_u32 s50, s51, 10240
buffer_load_dwordx4 v3, s[4:7], s50 offen lds
s_add_u32 m0, s47, 100352
s_add_u32 s50, s51, 20480
buffer_load_dwordx4 v2, s[4:7], s50 offen lds
s_add_u32 m0, s47, 101376
s_add_u32 s50, s51, 30720
buffer_load_dwordx4 v3, s[4:7], s50 offen lds
s_add_u32 s65, s65, 128
s_cmp_ge_u32 s65, 1280
s_cselect_b32 s50, 1280, 0
s_sub_u32 s65, s65, s50
s_waitcnt lgkmcnt(7)
v_mfma_f32_32x32x16_bf16 v[80:95], v[128:131], v[128:131], v[80:95]
v_mfma_f32_16x16x32_bf16 v[44:47], v[40:43], v[128:131], v[44:47]
s_waitcnt lgkmcnt(6)
v_mfma_f32_32x32x16_bf16 v[80:95], v[132:135], v[132:135], v[80:95]
v_mfma_f32_16x16x32_bf16 v[44:47], v[40:43], v[132:135], v[44:47]
s_waitcnt lgkmcnt(5)
v_mfma_f32_32x32x16_bf16 v[80:95], v[136:139], v[136:139], v[80:95]
v_mfma_f32_16x16x32_bf16 v[44:47], v[40:43], v[136:139], v[44:47]
s_waitcnt lgkmcnt(4)
v_mfma_f32_32x32x16_bf16 v[80:95], v[140:143], v[140:143], v[80:95]
v_mfma_f32_16x16x32_bf16 v[44:47], v[40:43], v[140:143], v[44:47]
s_waitcnt vmcnt(8)
v_add_u32 v8, 0x10000, v8
ds_read_b128 v[160:163], v8 offset:0
v_add_u32 v9, 0x10000, v9
ds_read_b128 v[164:167], v9 offset:0
v_add_u32 v10, 0x10000, v10
ds_read_b128 v[168:171], v10 offset:0
v_add_u32 v11, 0x10000, v11
ds_read_b128 v[172:175], v11 offset:0
s_add_u32 s51, s36, s65
s_add_u32 m0, s47, 114688
s_add_u32 s50, s51, 0
buffer_load_dwordx4 v2, s[4:7], s50 offen lds
s_add_u32 m0, s47, 115712
s_add_u32 s50, s51, 10240
buffer_load_dwordx4 v3, s[4:7], s50 offen lds
s_add_u32 m0, s47, 116736
s_add_u32 s50, s51, 20480
buffer_load_dwordx4 v2, s[4:7], s50 offen lds
s_add_u32 m0, s47, 117760
s_add_u32 s50, s51, 30720
buffer_load_dwordx4 v3, s[4:7], s50 offen lds
s_add_u32 s65, s65, 128
s_cmp_ge_u32 s65, 1280
s_cselect_b32 s50, 1280, 0
s_sub_u32 s65, s65, s50
s_waitcnt lgkmcnt(7)
v_mfma_f32_32x32x16_bf16 v[80:95], v[144:147], v[144:147], v[80:95]
v_mfma_f32_16x16x32_bf16 v[44:47], v[40:43], v[144:147], v[44:47]
s_waitcnt lgkmcnt(6)
v_mfma_f32_32x32x16_bf16 v[80:95], v[148:151], v[148:151], v[80:95]
v_mfma_f32_16x16x32_bf16 v[44:47], v[40:43], v[148:151], v[44:47]
s_waitcnt lgkmcnt(5)
v_mfma_f32_32x32x16_bf16 v[80:95], v[152:155], v[152:155], v[80:95]
v_mfma_f32_16x16x32_bf16 v[44:47], v[40:43], v[152:155], v[44:47]
s_waitcnt lgkmcnt(4)
v_mfma_f32_32x32x16_bf16 v[80:95], v[156:159], v[156:159], v[80:95]
v_mfma_f32_16x16x32_bf16 v[44:47], v[40:43], v[156:159], v[44:47]
s_waitcnt vmcnt(8)
ds_read_b128 v[176:179], v8 offset:16384
ds_read_b128 v[180:183], v9 offset:16384
ds_read_b128 v[184:187], v10 offset:16384
ds_read_b128 v[188:191], v11 offset:16384
s_add_u32 s51, s36, s65
s_add_u32 m0, s62, 0
s_add_u32 s50, s51, 0
buffer_load_dwordx4 v2, s[4:7], s50 offen lds
s_add_u32 m0, s62, 1024
s_add_u32 s50, s51, 10240
buffer_load_dwordx4 v3, s[4:7], s50 offen lds
s_add_u32 m0, s62, 2048
s_add_u32 s50, s51, 20480
buffer_load_dwordx4 v2, s[4:7], s50 offen lds
s_add_u32 m0, s62, 3072
s_add_u32 s50, s51, 30720
buffer_load_dwordx4 v3, s[4:7], s50 offen lds
s_add_u32 s65, s65, 128
s_cmp_ge_u32 s65, 1280
s_cselect_b32 s50, 1280, 0
s_sub_u32 s65, s65, s50
s_waitcnt lgkmcnt(7)
v_mfma_f32_32x32x16_bf16 v[80:95], v[160:163], v[160:163], v[80:95]
v_mfma_f32_16x16x32_bf16 v[44:47], v[40:43], v[160:163], v[44:47]
s_waitcnt lgkmcnt(6)
v_mfma_f32_32x32x16_bf16 v[80:95], v[164:167], v[164:167], v[80:95]
v_mfma_f32_16x16x32_bf16 v[44:47], v[40:43], v[164:167], v[44:47]
s_waitcnt lgkmcnt(5)
v_mfma_f32_32x32x16_bf16 v[80:95], v[168:171], v[168:171], v[80:95]
v_mfma_f32_16x16x32_bf16 v[44:47], v[40:43], v[168:171], v[44:47]
s_waitcnt lgkmcnt(4)
v_mfma_f32_32x32x16_bf16 v[80:95], v[172:175], v[172:175], v[80:95]
v_mfma_f32_16x16x32_bf16 v[44:47], v[40:43], v[172:175], v[44:47]
s_waitcnt vmcnt(8)
ds_read_b128 v[192:195], v8 offset:32768
ds_read_b128 v[196:199], v9 offset:32768
ds_read_b128 v[200:203], v10 offset:32768
ds_read_b128 v[204:207], v11 offset:32768
s_add_u32 s51, s36, s65
s_add_u32 m0, s62, 4096
s_add_u32 s50, s51, 0
buffer_load_dwordx4 v2, s[4:7], s50 offen lds
s_add_u32 m0, s62, 5120
s_add_u32 s50, s51, 10240
buffer_load_dwordx4 v3, s[4:7], s50 offen lds
s_add_u32 m0, s62, 6144
s_add_u32 s50, s51, 20480
buffer_load_dwordx4 v2, s[4:7], s50 offen lds
s_add_u32 m0, s62, 7168
s_add_u32 s50, s51, 30720
buffer_load_dwordx4 v3, s[4:7], s50 offen lds
s_add_u32 s65, s65, 128
s_cmp_ge_u32 s65, 1280
s_cselect_b32 s50, 1280, 0
s_sub_u32 s65, s65, s50
s_waitcnt lgkmcnt(7)
v_mfma_f32_32x32x16_bf16 v[80:95], v[176:179], v[176:179], v[80:95]
v_mfma_f32_16x16x32_bf16 v[44:47], v[40:43], v[176:179], v[44:47]
s_waitcnt lgkmcnt(6)
v_mfma_f32_32x32x16_bf16 v[80:95], v[180:183], v[180:183], v[80:95]
v_mfma_f32_16x16x32_bf16 v[44:47], v[40:43], v[180:183], v[44:47]
s_waitcnt lgkmcnt(5)
v_mfma_f32_32x32x16_bf16 v[80:95], v[184:187], v[184:187], v[80:95]
v_mfma_f32_16x16x32_bf16 v[44:47], v[40:43], v[184:187], v[44:47]
s_waitcnt lgkmcnt(4)
v_mfma_f32_32x32x16_bf16 v[80:95], v[188:191], v[188:191], v[80:95]
v_mfma_f32_16x16x32_bf16 v[44:47], v[40:43], v[188:191], v[44:47]
v_add_u32 v2, s39, v20
s_sub_u32 s52, s40, 1024
v_add_u32 v3, s52, v20
s_sub_u32 s52, s38, 1024
v_add_u32 v20, s52, v19
v_add_u32 v19, s37, v19
s_add_u32 m0, s47, 0
s_nop 0
buffer_load_dwordx4 v19, s[12:15], s41 offen offset:0 lds
buffer_load_dwordx4 v20, s[24:27], s41 offen offset:1024 lds
s_add_u32 m0, s47, 2048
s_nop 0
buffer_load_dwordx4 v2, s[28:31], s42 offen offset:0 lds
buffer_load_dwordx4 v3, s[28:31], s42 offen offset:1024 lds
s_add_u32 s41, s41, 110592
s_add_u32 s42, s42, s43
s_add_u32 m0, s47, 16384
s_nop 0
buffer_load_dwordx4 v19, s[12:15], s41 offen offset:0 lds
buffer_load_dwordx4 v20, s[24:27], s41 offen offset:1024 lds
s_add_u32 m0, s47, 18432
s_nop 0
buffer_load_dwordx4 v2, s[28:31], s42 offen offset:0 lds
buffer_load_dwordx4 v3, s[28:31], s42 offen offset:1024 lds
s_add_u32 s41, s41, 110592
s_add_u32 s42, s42, s43
s_cmp_ge_u32 s41, 2211840
s_cselect_b32 s41, 0, s41
s_cselect_b32 s42, 0, s42
s_waitcnt vmcnt(16)
ds_read_b128 v[208:211], v8 offset:49152
ds_read_b128 v[212:215], v9 offset:49152
ds_read_b128 v[216:219], v10 offset:49152
ds_read_b128 v[220:223], v11 offset:49152
s_waitcnt lgkmcnt(7)
v_mfma_f32_32x32x16_bf16 v[80:95], v[192:195], v[192:195], v[80:95]
v_mfma_f32_16x16x32_bf16 v[44:47], v[40:43], v[192:195], v[44:47]
s_waitcnt lgkmcnt(6)
v_mfma_f32_32x32x16_bf16 v[80:95], v[196:199], v[196:199], v[80:95]
v_mfma_f32_16x16x32_bf16 v[44:47], v[40:43], v[196:199], v[44:47]
s_waitcnt lgkmcnt(5)
v_mfma_f32_32x32x16_bf16 v[80:95], v[200:203], v[200:203], v[80:95]
v_mfma_f32_16x16x32_bf16 v[44:47], v[40:43], v[200:203], v[44:47]
s_waitcnt lgkmcnt(4)
v_mfma_f32_32x32x16_bf16 v[80:95], v[204:207], v[204:207], v[80:95]
v_mfma_f32_16x16x32_bf16 v[44:47], v[40:43], v[204:207], v[44:47]
s_waitcnt vmcnt(12)
ds_read_b128 v[224:227], v4 offset:0
ds_read_b128 v[228:231], v5 offset:0
ds_read_b128 v[232:235], v6 offset:0
ds_read_b128 v[236:239], v7 offset:0
s_waitcnt lgkmcnt(7)
v_mfma_f32_32x32x16_bf16 v[80:95], v[208:211], v[208:211], v[80:95]
v_mfma_f32_16x16x32_bf16 v[44:47], v[40:43], v[208:211], v[44:47]
s_waitcnt lgkmcnt(6)
v_mfma_f32_32x32x16_bf16 v[80:95], v[212:215], v[212:215], v[80:95]
v_mfma_f32_16x16x32_bf16 v[44:47], v[40:43], v[212:215], v[44:47]
s_waitcnt lgkmcnt(5)
v_mfma_f32_32x32x16_bf16 v[80:95], v[216:219], v[216:219], v[80:95]
v_mfma_f32_16x16x32_bf16 v[44:47], v[40:43], v[216:219], v[44:47]
s_waitcnt lgkmcnt(4)
v_mfma_f32_32x32x16_bf16 v[80:95], v[220:223], v[220:223], v[80:95]
v_mfma_f32_16x16x32_bf16 v[44:47], v[40:43], v[220:223], v[44:47]
s_waitcnt vmcnt(8)
ds_read_b128 v[240:243], v4 offset:4096
ds_read_b128 v[244:247], v5 offset:4096
ds_read_b128 v[248:251], v6 offset:4096
ds_read_b128 v[252:255], v7 offset:4096
s_waitcnt lgkmcnt(7)
v_mfma_f32_32x32x16_bf16 v[80:95], v[224:227], v[224:227], v[80:95]
v_mfma_f32_16x16x32_bf16 v[44:47], v[40:43], v[224:227], v[44:47]
s_waitcnt lgkmcnt(6)
v_mfma_f32_32x32x16_bf16 v[80:95], v[228:231], v[228:231], v[80:95]
v_mfma_f32_16x16x32_bf16 v[44:47], v[40:43], v[228:231], v[44:47]
s_waitcnt lgkmcnt(5)
v_mfma_f32_32x32x16_bf16 v[80:95], v[232:235], v[232:235], v[80:95]
v_mfma_f32_16x16x32_bf16 v[44:47], v[40:43], v[232:235], v[44:47]
s_waitcnt lgkmcnt(4)
v_mfma_f32_32x32x16_bf16 v[80:95], v[236:239], v[236:239], v[80:95]
v_mfma_f32_16x16x32_bf16 v[44:47], v[40:43], v[236:239], v[44:47]
s_waitcnt lgkmcnt(3)
v_mfma_f32_32x32x16_bf16 v[80:95], v[240:243], v[240:243], v[80:95]
v_mfma_f32_16x16x32_bf16 v[44:47], v[40:43], v[240:243], v[44:47]
s_waitcnt lgkmcnt(2)
v_mfma_f32_32x32x16_bf16 v[80:95], v[244:247], v[244:247], v[80:95]
v_mfma_f32_16x16x32_bf16 v[44:47], v[40:43], v[244:247], v[44:47]
s_waitcnt lgkmcnt(1)
v_mfma_f32_32x32x16_bf16 v[80:95], v[248:251], v[248:251], v[80:95]
v_mfma_f32_16x16x32_bf16 v[44:47], v[40:43], v[248:251], v[44:47]
s_waitcnt lgkmcnt(0)
v_mfma_f32_32x32x16_bf16 v[80:95], v[252:255], v[252:255], v[80:95]
v_mfma_f32_16x16x32_bf16 v[44:47], v[40:43], v[252:255], v[44:47]
v_add_u32 v4, 0x10000, v12
v_add_u32 v5, 0x10000, v13
v_add_u32 v6, 0x10000, v14
v_add_u32 v7, 0x10000, v15
v_add_u32 v8, 0x10000, v16
v_add_u32 v9, 0x10000, v17
v_add_u32 v10, 0x10000, v18
v_bfe_u32 v28, v1, 0, 1
v_cmp_eq_u32 s[66:67], 1, v28
v_bfe_u32 v28, v1, 1, 1
v_cmp_eq_u32 s[68:69], 1, v28
v_bfe_u32 v28, v1, 3, 1
v_cmp_eq_u32 s[70:71], 1, v28
v_bfe_u32 v28, v1, 4, 1
v_cmp_eq_u32 s[72:73], 1, v28
v_bfe_u32 v28, v1, 2, 1
v_cmp_eq_u32 s[84:85], 1, v28
v_cndmask_b32 v28, v80, v81, s[66:67]
v_cndmask_b32 v29, v82, v83, s[66:67]
v_cndmask_b32 v30, v84, v85, s[66:67]
v_cndmask_b32 v31, v86, v87, s[66:67]
v_cndmask_b32 v32, v88, v89, s[66:67]
v_cndmask_b32 v33, v90, v91, s[66:67]
v_cndmask_b32 v34, v92, v93, s[66:67]
v_cndmask_b32 v35, v94, v95, s[66:67]
v_cndmask_b32 v28, v28, v29, s[68:69]
v_cndmask_b32 v29, v30, v31, s[68:69]
v_cndmask_b32 v30, v32, v33, s[68:69]
v_cndmask_b32 v31, v34, v35, s[68:69]
v_cndmask_b32 v28, v28, v29, s[70:71]
v_cndmask_b32 v29, v30, v31, s[70:71]
v_cndmask_b32 v28, v28, v29, s[72:73]
v_mov_b32 v29, v28
s_nop 1
v_permlane32_swap_b32 v28, v29
v_cndmask_b32 v28, v28, v29, s[84:85]
v_mul_f32 v30, 0.0015625, v44
v_mul_f32 v28, 0.0015625, v28
v_fma_f32 v28, -v30, v30, v28
v_max_f32 v28, 0, v28
v_add_f32 v28, 0x3727c5ac, v28
v_rsq_f32 v24, v28
s_nop 0
v_mul_f32 v24, s63, v24
v_mul_f32 v26, v30, v24
v_mul_f32 v26, -1.0, v26
s_lshl_b32 s80, s2, 2
s_add_u32 s80, s80, s32
s_cmp_ge_u32 s80, 592
s_cselect_b32 s3, 1, 0
s_cselect_b32 s50, 592, 0
s_sub_u32 s80, s80, s50
s_lshr_b32 s50, s80, 2
s_and_b32 s83, s80, 3
s_sub_u32 s51, s50, 108
s_mul_i32 s81, s51, 6554
s_lshr_b32 s81, s81, 16
s_mul_i32 s82, s81, 10
s_sub_u32 s82, s51, s82
s_mul_i32 s81, s81, 160
s_cmp_lt_u32 s82, 8
s_cselect_b32 s51, 20, 80
s_cselect_b32 s52, 0, 624
s_mul_i32 s51, s51, s82
s_cselect_b32 s82, 4, 20
s_add_u32 s81, s81, s51
s_sub_u32 s81, s81, s52
s_mov_b32 s79, 819200
s_lshl_b32 s51, s50, 4
s_cmp_lt_u32 s50, 108
s_cselect_b32 s76, s74, s86
s_cselect_b32 s77, s75, s87
s_cselect_b32 s78, 2211840, s79
s_cselect_b32 s81, s51, s81
s_cselect_b32 s82, 4, s82
s_and_b32 s77, s77, 0xffff
s_mov_b32 s79, 0x20000
s_mul_i32 s81, s81, 1280
s_mul_i32 s51, s83, 320
s_add_u32 s81, s81, s51
s_mul_i32 s83, s83, 757760
s_mul_i32 s50, s50, 2560
s_add_u32 s83, s83, s50
s_add_u32 s83, s83, 20971520
v_lshlrev_b32 v28, 16, v96
v_and_b32 v29, s49, v96
v_lshlrev_b32 v30, 16, v97
v_and_b32 v31, s49, v97
v_fma_f32 v28, v28, v24, v26
v_fma_f32 v29, v29, v24, v26
v_fma_f32 v30, v30, v24, v26
v_fma_f32 v31, v31, v24, v26
v_cvt_pk_bf16_f32 v96, v28, v29
v_cvt_pk_bf16_f32 v97, v30, v31
v_lshlrev_b32 v32, 16, v98
v_and_b32 v33, s49, v98
v_lshlrev_b32 v34, 16, v99
v_and_b32 v35, s49, v99
v_fma_f32 v32, v32, v24, v26
v_fma_f32 v33, v33, v24, v26
v_fma_f32 v34, v34, v24, v26
v_fma_f32 v35, v35, v24, v26
v_cvt_pk_bf16_f32 v98, v32, v33
v_cvt_pk_bf16_f32 v99, v34, v35
s_add_u32 m0, s47, 32768
s_nop 0
buffer_load_dwordx4 v19, s[12:15], s41 offen offset:0 lds
buffer_load_dwordx4 v20, s[24:27], s41 offen offset:1024 lds
s_add_u32 m0, s47, 34816
s_nop 0
buffer_load_dwordx4 v2, s[28:31], s42 offen offset:0 lds
buffer_load_dwordx4 v3, s[28:31], s42 offen offset:1024 lds
s_add_u32 s41, s41, 110592
s_add_u32 s42, s42, s43
s_add_u32 m0, s47, 49152
s_nop 0
buffer_load_dwordx4 v19, s[12:15], s41 offen offset:0 lds
buffer_load_dwordx4 v20, s[24:27], s41 offen offset:1024 lds
s_add_u32 m0, s47, 51200
s_nop 0
buffer_load_dwordx4 v2, s[28:31], s42 offen offset:0 lds
buffer_load_dwordx4 v3, s[28:31], s42 offen offset:1024 lds
s_add_u32 s41, s41, 110592
s_add_u32 s42, s42, s43
s_cmp_ge_u32 s41, 2211840
s_cselect_b32 s41, 0, s41
s_cselect_b32 s42, 0, s42
s_waitcnt vmcnt(8)
s_barrier
ds_read_b64_tr_b16 a[128:129], v12 offset:0
ds_read_b64_tr_b16 a[130:131], v12 offset:512
ds_read_b64_tr_b16 a[132:133], v12 offset:2048
ds_read_b64_tr_b16 a[134:135], v12 offset:2560
ds_read_b64_tr_b16 a[136:137], v13 offset:0
ds_read_b64_tr_b16 a[138:139], v13 offset:512
ds_read_b64_tr_b16 a[140:141], v13 offset:2048
ds_read_b64_tr_b16 a[142:143], v13 offset:2560
ds_read_b64_tr_b16 a[144:145], v15 offset:0
ds_read_b64_tr_b16 a[146:147], v15 offset:512
s_waitcnt lgkmcnt(6)
v_mfma_f32_32x32x16_bf16 a[0:15], a[128:131], v[96:99], 0
ds_read_b64_tr_b16 a[148:149], v16 offset:0
ds_read_b64_tr_b16 a[150:151], v16 offset:512
s_add_u32 m0, s47, 65536
s_nop 0
buffer_load_dwordx4 v19, s[12:15], s41 offen offset:0 lds
v_lshlrev_b32 v28, 16, v100
v_and_b32 v29, s49, v100
v_mfma_f32_32x32x16_bf16 a[16:31], a[132:135], v[96:99], 0
ds_read_b64_tr_b16 a[152:153], v17 offset:0
ds_read_b64_tr_b16 a[154:155], v17 offset:512
v_lshlrev_b32 v30, 16, v101
v_and_b32 v31, s49, v101
v_fma_f32 v28, v28, v24, v26
v_fma_f32 v29, v29, v24, v26
s_waitcnt lgkmcnt(6)
v_mfma_f32_32x32x16_bf16 a[32:47], a[136:139], v[96:99], 0
ds_read_b64_tr_b16 a[156:157], v18 offset:0
ds_read_b64_tr_b16 a[158:159], v18 offset:512
buffer_load_dwordx4 v20, s[24:27], s41 offen offset:1024 lds
s_add_u32 m0, s47, 67584
v_fma_f32 v30, v30, v24, v26
v_fma_f32 v31, v31, v24, v26
v_mfma_f32_32x32x16_bf16 a[48:63], a[140:143], v[96:99], 0
ds_read_b64_tr_b16 a[128:129], v12 offset:8192
ds_read_b64_tr_b16 a[130:131], v12 offset:8704
v_cvt_pk_bf16_f32 v100, v28, v29
v_cvt_pk_bf16_f32 v101, v30, v31
v_lshlrev_b32 v32, 16, v102
v_and_b32 v33, s49, v102
s_waitcnt lgkmcnt(6)
v_mfma_f32_32x32x16_bf16 a[64:79], a[144:147], v[96:99], 0
ds_read_b64_tr_b16 a[132:133], v12 offset:10240
ds_read_b64_tr_b16 a[134:135], v12 offset:10752
buffer_load_dwordx4 v2, s[28:31], s42 offen offset:0 lds
v_lshlrev_b32 v34, 16, v103
v_and_b32 v35, s49, v103
v_fma_f32 v32, v32, v24, v26
v_mfma_f32_32x32x16_bf16 a[80:95], a[148:151], v[96:99], 0
ds_read_b64_tr_b16 a[136:137], v13 offset:8192
ds_read_b64_tr_b16 a[138:139], v13 offset:8704
v_fma_f32 v33, v33, v24, v26
v_fma_f32 v34, v34, v24, v26
v_fma_f32 v35, v35, v24, v26
v_cvt_pk_bf16_f32 v102, v32, v33
s_waitcnt lgkmcnt(6)
v_mfma_f32_32x32x16_bf16 a[96:111], a[152:155], v[96:99], 0
ds_read_b64_tr_b16 a[140:141], v13 offset:10240
ds_read_b64_tr_b16 a[142:143], v13 offset:10752
buffer_load_dwordx4 v3, s[28:31], s42 offen offset:1024 lds
s_add_u32 s41, s41, 110592
s_add_u32 s42, s42, s43
s_add_u32 m0, s47, 81920
v_mfma_f32_32x32x16_bf16 a[112:127], a[156:159], v[96:99], 0
ds_read_b64_tr_b16 a[144:145], v15 offset:8192
ds_read_b64_tr_b16 a[146:147], v15 offset:8704
v_cvt_pk_bf16_f32 v103, v34, v35
v_add_u32 v36, 0, v1
v_mul_u32_u24 v37, 3277, v36
v_lshrrev_b32 v37, 16, v37
s_waitcnt lgkmcnt(6)
v_mfma_f32_32x32x16_bf16 a[0:15], a[128:131], v[100:103], a[0:15]
ds_read_b64_tr_b16 a[148:149], v16 offset:8192
ds_read_b64_tr_b16 a[150:151], v16 offset:8704
buffer_load_dwordx4 v19, s[12:15], s41 offen offset:0 lds
v_lshlrev_b32 v28, 16, v104
v_and_b32 v29, s49, v104
v_lshlrev_b32 v30, 16, v105
v_mfma_f32_32x32x16_bf16 a[16:31], a[132:135], v[100:103], a[16:31]
ds_read_b64_tr_b16 a[152:153], v17 offset:8192
ds_read_b64_tr_b16 a[154:155], v17 offset:8704
v_and_b32 v31, s49, v105
v_fma_f32 v28, v28, v24, v26
v_fma_f32 v29, v29, v24, v26
v_fma_f32 v30, v30, v24, v26
s_waitcnt lgkmcnt(6)
v_mfma_f32_32x32x16_bf16 a[32:47], a[136:139], v[100:103], a[32:47]
ds_read_b64_tr_b16 a[156:157], v18 offset:8192
ds_read_b64_tr_b16 a[158:159], v18 offset:8704
buffer_load_dwordx4 v20, s[24:27], s41 offen offset:1024 lds
s_add_u32 m0, s47, 83968
v_fma_f32 v31, v31, v24, v26
v_cvt_pk_bf16_f32 v104, v28, v29
v_mfma_f32_32x32x16_bf16 a[48:63], a[140:143], v[100:103], a[48:63]
ds_read_b64_tr_b16 a[128:129], v12 offset:16384
ds_read_b64_tr_b16 a[130:131], v12 offset:16896
v_cvt_pk_bf16_f32 v105, v30, v31
v_lshlrev_b32 v32, 16, v106
v_and_b32 v33, s49, v106
v_lshlrev_b32 v34, 16, v107
s_waitcnt lgkmcnt(6)
v_mfma_f32_32x32x16_bf16 a[64:79], a[144:147], v[100:103], a[64:79]
ds_read_b64_tr_b16 a[132:133], v12 offset:18432
ds_read_b64_tr_b16 a[134:135], v12 offset:18944
buffer_load_dwordx4 v2, s[28:31], s42 offen offset:0 lds
v_and_b32 v35, s49, v107
v_fma_f32 v32, v32, v24, v26
v_fma_f32 v33, v33, v24, v26
v_mfma_f32_32x32x16_bf16 a[80:95], a[148:151], v[100:103], a[80:95]
ds_read_b64_tr_b16 a[136:137], v13 offset:16384
ds_read_b64_tr_b16 a[138:139], v13 offset:16896
v_fma_f32 v34, v34, v24, v26
v_fma_f32 v35, v35, v24, v26
v_cvt_pk_bf16_f32 v106, v32, v33
v_cvt_pk_bf16_f32 v107, v34, v35
s_waitcnt lgkmcnt(6)
v_mfma_f32_32x32x16_bf16 a[96:111], a[152:155], v[100:103], a[96:111]
ds_read_b64_tr_b16 a[140:141], v13 offset:18432
ds_read_b64_tr_b16 a[142:143], v13 offset:18944
buffer_load_dwordx4 v3, s[28:31], s42 offen offset:1024 lds
s_add_u32 s41, s41, 110592
s_add_u32 s42, s42, s43
s_cmp_ge_u32 s41, 2211840
s_cselect_b32 s41, 0, s41
s_cselect_b32 s42, 0, s42
s_add_u32 m0, s47, 98304
v_mfma_f32_32x32x16_bf16 a[112:127], a[156:159], v[100:103], a[112:127]
ds_read_b64_tr_b16 a[144:145], v15 offset:16384
ds_read_b64_tr_b16 a[146:147], v15 offset:16896
v_mul_u32_u24 v38, 20, v37
v_sub_u32 v36, v36, v38
v_lshrrev_b32 v38, 2, v37
v_mul_u32_u24 v38, s82, v38
s_waitcnt lgkmcnt(6)
v_mfma_f32_32x32x16_bf16 a[0:15], a[128:131], v[104:107], a[0:15]
ds_read_b64_tr_b16 a[148:149], v16 offset:16384
ds_read_b64_tr_b16 a[150:151], v16 offset:16896
buffer_load_dwordx4 v19, s[12:15], s41 offen offset:0 lds
v_lshlrev_b32 v28, 16, v108
v_and_b32 v29, s49, v108
v_lshlrev_b32 v30, 16, v109
v_mfma_f32_32x32x16_bf16 a[16:31], a[132:135], v[104:107], a[16:31]
ds_read_b64_tr_b16 a[152:153], v17 offset:16384
ds_read_b64_tr_b16 a[154:155], v17 offset:16896
v_and_b32 v31, s49, v109
v_fma_f32 v28, v28, v24, v26
v_fma_f32 v29, v29, v24, v26
v_fma_f32 v30, v30, v24, v26
s_waitcnt lgkmcnt(6)
v_mfma_f32_32x32x16_bf16 a[32:47], a[136:139], v[104:107], a[32:47]
ds_read_b64_tr_b16 a[156:157], v18 offset:16384
ds_read_b64_tr_b16 a[158:159], v18 offset:16896
buffer_load_dwordx4 v20, s[24:27], s41 offen offset:1024 lds
s_add_u32 m0, s47, 100352
v_fma_f32 v31, v31, v24, v26
v_cvt_pk_bf16_f32 v108, v28, v29
v_mfma_f32_32x32x16_bf16 a[48:63], a[140:143], v[104:107], a[48:63]
ds_read_b64_tr_b16 a[128:129], v12 offset:24576
ds_read_b64_tr_b16 a[130:131], v12 offset:25088
v_cvt_pk_bf16_f32 v109, v30, v31
v_lshlrev_b32 v32, 16, v110
v_and_b32 v33, s49, v110
v_lshlrev_b32 v34, 16, v111
s_waitcnt lgkmcnt(6)
v_mfma_f32_32x32x16_bf16 a[64:79], a[144:147], v[104:107], a[64:79]
ds_read_b64_tr_b16 a[132:133], v12 offset:26624
ds_read_b64_tr_b16 a[134:135], v12 offset:27136
buffer_load_dwordx4 v2, s[28:31], s42 offen offset:0 lds
v_and_b32 v35, s49, v111
v_fma_f32 v32, v32, v24, v26
v_fma_f32 v33, v33, v24, v26
v_mfma_f32_32x32x16_bf16 a[80:95], a[148:151], v[104:107], a[80:95]
ds_read_b64_tr_b16 a[136:137], v13 offset:24576
ds_read_b64_tr_b16 a[138:139], v13 offset:25088
v_fma_f32 v34, v34, v24, v26
v_fma_f32 v35, v35, v24, v26
v_cvt_pk_bf16_f32 v110, v32, v33
v_cvt_pk_bf16_f32 v111, v34, v35
s_waitcnt lgkmcnt(6)
v_mfma_f32_32x32x16_bf16 a[96:111], a[152:155], v[104:107], a[96:111]
ds_read_b64_tr_b16 a[140:141], v13 offset:26624
ds_read_b64_tr_b16 a[142:143], v13 offset:27136
buffer_load_dwordx4 v3, s[28:31], s42 offen offset:1024 lds
s_add_u32 s41, s41, 110592
s_add_u32 s42, s42, s43
s_add_u32 m0, s47, 114688
v_mfma_f32_32x32x16_bf16 a[112:127], a[156:159], v[104:107], a[112:127]
ds_read_b64_tr_b16 a[144:145], v15 offset:24576
ds_read_b64_tr_b16 a[146:147], v15 offset:25088
v_and_b32 v37, 3, v37
v_add_u32 v37, v37, v38
v_mul_u32_u24 v37, 1280, v37
v_lshl_add_u32 v40, v36, 4, v37
s_waitcnt lgkmcnt(6)
v_mfma_f32_32x32x16_bf16 a[0:15], a[128:131], v[108:111], a[0:15]
ds_read_b64_tr_b16 a[148:149], v16 offset:24576
ds_read_b64_tr_b16 a[150:151], v16 offset:25088
buffer_load_dwordx4 v19, s[12:15], s41 offen offset:0 lds
v_lshlrev_b32 v28, 16, v112
v_and_b32 v29, s49, v112
v_lshlrev_b32 v30, 16, v113
v_mfma_f32_32x32x16_bf16 a[16:31], a[132:135], v[108:111], a[16:31]
ds_read_b64_tr_b16 a[152:153], v17 offset:24576
ds_read_b64_tr_b16 a[154:155], v17 offset:25088
v_and_b32 v31, s49, v113
v_fma_f32 v28, v28, v24, v26
v_fma_f32 v29, v29, v24, v26
v_fma_f32 v30, v30, v24, v26
s_waitcnt lgkmcnt(6)
v_mfma_f32_32x32x16_bf16 a[32:47], a[136:139], v[108:111], a[32:47]
ds_read_b64_tr_b16 a[156:157], v18 offset:24576
ds_read_b64_tr_b16 a[158:159], v18 offset:25088
buffer_load_dwordx4 v20, s[24:27], s41 offen offset:1024 lds
s_add_u32 m0, s47, 116736
v_fma_f32 v31, v31, v24, v26
v_cvt_pk_bf16_f32 v112, v28, v29
v_mfma_f32_32x32x16_bf16 a[48:63], a[140:143], v[108:111], a[48:63]
s_waitcnt vmcnt(14)
s_barrier
ds_read_b64_tr_b16 a[128:129], v12 offset:32768
ds_read_b64_tr_b16 a[130:131], v12 offset:33280
v_cvt_pk_bf16_f32 v113, v30, v31
v_lshlrev_b32 v32, 16, v114
v_and_b32 v33, s49, v114
v_lshlrev_b32 v34, 16, v115
s_waitcnt lgkmcnt(6)
v_mfma_f32_32x32x16_bf16 a[64:79], a[144:147], v[108:111], a[64:79]
ds_read_b64_tr_b16 a[132:133], v12 offset:34816
ds_read_b64_tr_b16 a[134:135], v12 offset:35328
buffer_load_dwordx4 v2, s[28:31], s42 offen offset:0 lds
v_and_b32 v35, s49, v115
v_fma_f32 v32, v32, v24, v26
v_fma_f32 v33, v33, v24, v26
v_mfma_f32_32x32x16_bf16 a[80:95], a[148:151], v[108:111], a[80:95]
ds_read_b64_tr_b16 a[136:137], v13 offset:32768
ds_read_b64_tr_b16 a[138:139], v13 offset:33280
v_fma_f32 v34, v34, v24, v26
v_fma_f32 v35, v35, v24, v26
v_cvt_pk_bf16_f32 v114, v32, v33
v_cvt_pk_bf16_f32 v115, v34, v35
s_waitcnt lgkmcnt(6)
v_mfma_f32_32x32x16_bf16 a[96:111], a[152:155], v[108:111], a[96:111]
ds_read_b64_tr_b16 a[140:141], v13 offset:34816
ds_read_b64_tr_b16 a[142:143], v13 offset:35328
buffer_load_dwordx4 v3, s[28:31], s42 offen offset:1024 lds
s_add_u32 s41, s41, 110592
s_add_u32 s42, s42, s43
s_cmp_ge_u32 s41, 2211840
s_cselect_b32 s41, 0, s41
s_cselect_b32 s42, 0, s42
v_mfma_f32_32x32x16_bf16 a[112:127], a[156:159], v[108:111], a[112:127]
ds_read_b64_tr_b16 a[144:145], v15 offset:32768
ds_read_b64_tr_b16 a[146:147], v15 offset:33280
v_add_u32 v36, 64, v1
v_mul_u32_u24 v37, 3277, v36
v_lshrrev_b32 v37, 16, v37
v_mul_u32_u24 v38, 20, v37
s_waitcnt lgkmcnt(6)
v_mfma_f32_32x32x16_bf16 a[0:15], a[128:131], v[112:115], a[0:15]
ds_read_b64_tr_b16 a[148:149], v16 offset:32768
ds_read_b64_tr_b16 a[150:151], v16 offset:33280
v_lshlrev_b32 v28, 16, v116
v_and_b32 v29, s49, v116
v_lshlrev_b32 v30, 16, v117
v_and_b32 v31, s49, v117
v_mfma_f32_32x32x16_bf16 a[16:31], a[132:135], v[112:115], a[16:31]
ds_read_b64_tr_b16 a[152:153], v17 offset:32768
ds_read_b64_tr_b16 a[154:155], v17 offset:33280
v_fma_f32 v28, v28, v24, v26
v_fma_f32 v29, v29, v24, v26
v_fma_f32 v30, v30, v24, v26
v_fma_f32 v31, v31, v24, v26
s_waitcnt lgkmcnt(6)
v_mfma_f32_32x32x16_bf16 a[32:47], a[136:139], v[112:115], a[32:47]
ds_read_b64_tr_b16 a[156:157], v18 offset:32768
ds_read_b64_tr_b16 a[158:159], v18 offset:33280
v_cvt_pk_bf16_f32 v116, v28, v29
v_cvt_pk_bf16_f32 v117, v30, v31
v_lshlrev_b32 v32, 16, v118
v_and_b32 v33, s49, v118
v_mfma_f32_32x32x16_bf16 a[48:63], a[140:143], v[112:115], a[48:63]
ds_read_b64_tr_b16 a[128:129], v12 offset:40960
ds_read_b64_tr_b16 a[130:131], v12 offset:41472
v_lshlrev_b32 v34, 16, v119
v_and_b32 v35, s49, v119
v_fma_f32 v32, v32, v24, v26
v_fma_f32 v33, v33, v24, v26
s_waitcnt lgkmcnt(6)
v_mfma_f32_32x32x16_bf16 a[64:79], a[144:147], v[112:115], a[64:79]
ds_read_b64_tr_b16 a[132:133], v12 offset:43008
ds_read_b64_tr_b16 a[134:135], v12 offset:43520
v_fma_f32 v34, v34, v24, v26
v_fma_f32 v35, v35, v24, v26
v_cvt_pk_bf16_f32 v118, v32, v33
v_cvt_pk_bf16_f32 v119, v34, v35
v_mfma_f32_32x32x16_bf16 a[80:95], a[148:151], v[112:115], a[80:95]
ds_read_b64_tr_b16 a[136:137], v13 offset:40960
ds_read_b64_tr_b16 a[138:139], v13 offset:41472
v_sub_u32 v36, v36, v38
v_lshrrev_b32 v38, 2, v37
v_mul_u32_u24 v38, s82, v38
v_and_b32 v37, 3, v37
s_waitcnt lgkmcnt(6)
v_mfma_f32_32x32x16_bf16 a[96:111], a[152:155], v[112:115], a[96:111]
ds_read_b64_tr_b16 a[140:141], v13 offset:43008
ds_read_b64_tr_b16 a[142:143], v13 offset:43520
v_add_u32 v37, v37, v38
v_mul_u32_u24 v37, 1280, v37
v_lshl_add_u32 v41, v36, 4, v37
v_add_u32 v36, 128, v1
v_mfma_f32_32x32x16_bf16 a[112:127], a[156:159], v[112:115], a[112:127]
ds_read_b64_tr_b16 a[144:145], v15 offset:40960
ds_read_b64_tr_b16 a[146:147], v15 offset:41472
v_mul_u32_u24 v37, 3277, v36
v_lshrrev_b32 v37, 16, v37
v_mul_u32_u24 v38, 20, v37
v_sub_u32 v36, v36, v38
s_waitcnt lgkmcnt(6)
v_mfma_f32_32x32x16_bf16 a[0:15], a[128:131], v[116:119], a[0:15]
ds_read_b64_tr_b16 a[148:149], v16 offset:40960
ds_read_b64_tr_b16 a[150:151], v16 offset:41472
v_lshlrev_b32 v28, 16, v120
v_and_b32 v29, s49, v120
v_lshlrev_b32 v30, 16, v121
v_and_b32 v31, s49, v121
v_mfma_f32_32x32x16_bf16 a[16:31], a[132:135], v[116:119], a[16:31]
ds_read_b64_tr_b16 a[152:153], v17 offset:40960
ds_read_b64_tr_b16 a[154:155], v17 offset:41472
v_fma_f32 v28, v28, v24, v26
v_fma_f32 v29, v29, v24, v26
v_fma_f32 v30, v30, v24, v26
v_fma_f32 v31, v31, v24, v26
s_waitcnt lgkmcnt(6)
v_mfma_f32_32x32x16_bf16 a[32:47], a[136:139], v[116:119], a[32:47]
ds_read_b64_tr_b16 a[156:157], v18 offset:40960
ds_read_b64_tr_b16 a[158:159], v18 offset:41472
v_cvt_pk_bf16_f32 v120, v28, v29
v_cvt_pk_bf16_f32 v121, v30, v31
v_lshlrev_b32 v32, 16, v122
v_and_b32 v33, s49, v122
v_mfma_f32_32x32x16_bf16 a[48:63], a[140:143], v[116:119], a[48:63]
ds_read_b64_tr_b16 a[128:129], v12 offset:49152
ds_read_b64_tr_b16 a[130:131], v12 offset:49664
v_lshlrev_b32 v34, 16, v123
v_and_b32 v35, s49, v123
v_fma_f32 v32, v32, v24, v26
v_fma_f32 v33, v33, v24, v26
s_waitcnt lgkmcnt(6)
v_mfma_f32_32x32x16_bf16 a[64:79], a[144:147], v[116:119], a[64:79]
ds_read_b64_tr_b16 a[132:133], v12 offset:51200
ds_read_b64_tr_b16 a[134:135], v12 offset:51712
v_fma_f32 v34, v34, v24, v26
v_fma_f32 v35, v35, v24, v26
v_cvt_pk_bf16_f32 v122, v32, v33
v_cvt_pk_bf16_f32 v123, v34, v35
v_mfma_f32_32x32x16_bf16 a[80:95], a[148:151], v[116:119], a[80:95]
ds_read_b64_tr_b16 a[136:137], v13 offset:49152
ds_read_b64_tr_b16 a[138:139], v13 offset:49664
v_lshrrev_b32 v38, 2, v37
v_mul_u32_u24 v38, s82, v38
v_and_b32 v37, 3, v37
v_add_u32 v37, v37, v38
s_waitcnt lgkmcnt(6)
v_mfma_f32_32x32x16_bf16 a[96:111], a[152:155], v[116:119], a[96:111]
ds_read_b64_tr_b16 a[140:141], v13 offset:51200
ds_read_b64_tr_b16 a[142:143], v13 offset:51712
v_mul_u32_u24 v37, 1280, v37
v_lshl_add_u32 v42, v36, 4, v37
v_add_u32 v36, 192, v1
v_mul_u32_u24 v37, 3277, v36
v_mfma_f32_32x32x16_bf16 a[112:127], a[156:159], v[116:119], a[112:127]
ds_read_b64_tr_b16 a[144:145], v15 offset:49152
ds_read_b64_tr_b16 a[146:147], v15 offset:49664
v_lshrrev_b32 v37, 16, v37
v_mul_u32_u24 v38, 20, v37
v_sub_u32 v36, v36, v38
v_lshrrev_b32 v38, 2, v37
s_waitcnt lgkmcnt(6)
v_mfma_f32_32x32x16_bf16 a[0:15], a[128:131], v[120:123], a[0:15]
ds_read_b64_tr_b16 a[148:149], v16 offset:49152
ds_read_b64_tr_b16 a[150:151], v16 offset:49664
v_lshlrev_b32 v28, 16, v124
v_and_b32 v29, s49, v124
v_lshlrev_b32 v30, 16, v125
v_and_b32 v31, s49, v125
v_mfma_f32_32x32x16_bf16 a[16:31], a[132:135], v[120:123], a[16:31]
ds_read_b64_tr_b16 a[152:153], v17 offset:49152
ds_read_b64_tr_b16 a[154:155], v17 offset:49664
v_fma_f32 v28, v28, v24, v26
v_fma_f32 v29, v29, v24, v26
v_fma_f32 v30, v30, v24, v26
v_fma_f32 v31, v31, v24, v26
s_waitcnt lgkmcnt(6)
v_mfma_f32_32x32x16_bf16 a[32:47], a[136:139], v[120:123], a[32:47]
ds_read_b64_tr_b16 a[156:157], v18 offset:49152
ds_read_b64_tr_b16 a[158:159], v18 offset:49664
v_cvt_pk_bf16_f32 v124, v28, v29
v_cvt_pk_bf16_f32 v125, v30, v31
v_lshlrev_b32 v32, 16, v126
v_and_b32 v33, s49, v126
v_mfma_f32_32x32x16_bf16 a[48:63], a[140:143], v[120:123], a[48:63]
ds_read_b64_tr_b16 a[128:129], v12 offset:57344
ds_read_b64_tr_b16 a[130:131], v12 offset:57856
v_lshlrev_b32 v34, 16, v127
v_and_b32 v35, s49, v127
v_fma_f32 v32, v32, v24, v26
v_fma_f32 v33, v33, v24, v26
s_waitcnt lgkmcnt(6)
v_mfma_f32_32x32x16_bf16 a[64:79], a[144:147], v[120:123], a[64:79]
ds_read_b64_tr_b16 a[132:133], v12 offset:59392
ds_read_b64_tr_b16 a[134:135], v12 offset:59904
v_fma_f32 v34, v34, v24, v26
v_fma_f32 v35, v35, v24, v26
v_cvt_pk_bf16_f32 v126, v32, v33
v_cvt_pk_bf16_f32 v127, v34, v35
v_mfma_f32_32x32x16_bf16 a[80:95], a[148:151], v[120:123], a[80:95]
ds_read_b64_tr_b16 a[136:137], v13 offset:57344
ds_read_b64_tr_b16 a[138:139], v13 offset:57856
v_mul_u32_u24 v38, s82, v38
v_and_b32 v37, 3, v37
v_add_u32 v37, v37, v38
v_mul_u32_u24 v37, 1280, v37
s_waitcnt lgkmcnt(6)
v_mfma_f32_32x32x16_bf16 a[96:111], a[152:155], v[120:123], a[96:111]
ds_read_b64_tr_b16 a[140:141], v13 offset:59392
ds_read_b64_tr_b16 a[142:143], v13 offset:59904
v_lshl_add_u32 v43, v36, 4, v37
v_add_u32 v36, 256, v1
v_mul_u32_u24 v37, 3277, v36
v_lshrrev_b32 v37, 16, v37
v_mfma_f32_32x32x16_bf16 a[112:127], a[156:159], v[120:123], a[112:127]
ds_read_b64_tr_b16 a[144:145], v15 offset:57344
ds_read_b64_tr_b16 a[146:147], v15 offset:57856
v_mul_u32_u24 v38, 20, v37
v_sub_u32 v36, v36, v38
v_lshrrev_b32 v38, 2, v37
v_mul_u32_u24 v38, s82, v38
s_waitcnt lgkmcnt(6)
v_mfma_f32_32x32x16_bf16 a[0:15], a[128:131], v[124:127], a[0:15]
ds_read_b64_tr_b16 a[148:149], v16 offset:57344
ds_read_b64_tr_b16 a[150:151], v16 offset:57856
v_lshlrev_b32 v28, 16, v128
v_and_b32 v29, s49, v128
v_lshlrev_b32 v30, 16, v129
v_and_b32 v31, s49, v129
v_mfma_f32_32x32x16_bf16 a[16:31], a[132:135], v[124:127], a[16:31]
ds_read_b64_tr_b16 a[152:153], v17 offset:57344
ds_read_b64_tr_b16 a[154:155], v17 offset:57856
v_fma_f32 v28, v28, v24, v26
v_fma_f32 v29, v29, v24, v26
v_fma_f32 v30, v30, v24, v26
v_fma_f32 v31, v31, v24, v26
s_waitcnt lgkmcnt(6)
v_mfma_f32_32x32x16_bf16 a[32:47], a[136:139], v[124:127], a[32:47]
ds_read_b64_tr_b16 a[156:157], v18 offset:57344
ds_read_b64_tr_b16 a[158:159], v18 offset:57856
v_cvt_pk_bf16_f32 v128, v28, v29
v_cvt_pk_bf16_f32 v129, v30, v31
v_lshlrev_b32 v32, 16, v130
v_and_b32 v33, s49, v130
v_mfma_f32_32x32x16_bf16 a[48:63], a[140:143], v[124:127], a[48:63]
s_waitcnt vmcnt(0)
s_barrier
ds_read_b64_tr_b16 a[128:129], v4 offset:0
ds_read_b64_tr_b16 a[130:131], v4 offset:512
s_add_u32 m0, s47, 0
s_nop 0
buffer_load_dwordx4 v19, s[12:15], s41 offen offset:0 lds
v_lshlrev_b32 v34, 16, v131
v_and_b32 v35, s49, v131
s_waitcnt lgkmcnt(6)
v_mfma_f32_32x32x16_bf16 a[64:79], a[144:147], v[124:127], a[64:79]
ds_read_b64_tr_b16 a[132:133], v4 offset:2048
ds_read_b64_tr_b16 a[134:135], v4 offset:2560
v_fma_f32 v32, v32, v24, v26
v_fma_f32 v33, v33, v24, v26
v_fma_f32 v34, v34, v24, v26
v_fma_f32 v35, v35, v24, v26
v_mfma_f32_32x32x16_bf16 a[80:95], a[148:151], v[124:127], a[80:95]
ds_read_b64_tr_b16 a[136:137], v5 offset:0
ds_read_b64_tr_b16 a[138:139], v5 offset:512
buffer_load_dwordx4 v20, s[24:27], s41 offen offset:1024 lds
s_add_u32 m0, s47, 2048
v_cvt_pk_bf16_f32 v130, v32, v33
v_cvt_pk_bf16_f32 v131, v34, v35
s_waitcnt lgkmcnt(6)
v_mfma_f32_32x32x16_bf16 a[96:111], a[152:155], v[124:127], a[96:111]
ds_read_b64_tr_b16 a[140:141], v5 offset:2048
ds_read_b64_tr_b16 a[142:143], v5 offset:2560
v_and_b32 v37, 3, v37
v_add_u32 v37, v37, v38
v_mul_u32_u24 v37, 1280, v37
v_lshl_add_u32 v44, v36, 4, v37
v_mfma_f32_32x32x16_bf16 a[112:127], a[156:159], v[124:127], a[112:127]
ds_read_b64_tr_b16 a[144:145], v7 offset:0
ds_read_b64_tr_b16 a[146:147], v7 offset:512
buffer_load_dwordx4 v2, s[28:31], s42 offen offset:0 lds
v_lshrrev_b32 v36, 5, v1
v_bfe_u32 v37, v1, 2, 2
v_lshl_add_u32 v37, v36, 2, v37
s_waitcnt lgkmcnt(6)
v_mfma_f32_32x32x16_bf16 a[0:15], a[128:131], v[128:131], a[0:15]
ds_read_b64_tr_b16 a[148:149], v8 offset:0
ds_read_b64_tr_b16 a[150:151], v8 offset:512
v_lshlrev_b32 v28, 16, v132
v_and_b32 v29, s49, v132
v_lshlrev_b32 v30, 16, v133
v_and_b32 v31, s49, v133
v_mfma_f32_32x32x16_bf16 a[16:31], a[132:135], v[128:131], a[16:31]
ds_read_b64_tr_b16 a[152:153], v9 offset:0
ds_read_b64_tr_b16 a[154:155], v9 offset:512
buffer_load_dwordx4 v3, s[28:31], s42 offen offset:1024 lds
s_add_u32 s41, s41, 110592
s_add_u32 s42, s42, s43
s_add_u32 m0, s47, 16384
s_waitcnt lgkmcnt(6)
v_mfma_f32_32x32x16_bf16 a[32:47], a[136:139], v[128:131], a[32:47]
ds_read_b64_tr_b16 a[156:157], v10 offset:0
ds_read_b64_tr_b16 a[158:159], v10 offset:512
v_fma_f32 v28, v28, v24, v26
v_fma_f32 v29, v29, v24, v26
v_fma_f32 v30, v30, v24, v26
v_fma_f32 v31, v31, v24, v26
v_mfma_f32_32x32x16_bf16 a[48:63], a[140:143], v[128:131], a[48:63]
ds_read_b64_tr_b16 a[128:129], v4 offset:8192
ds_read_b64_tr_b16 a[130:131], v4 offset:8704
buffer_load_dwordx4 v19, s[12:15], s41 offen offset:0 lds
v_cvt_pk_bf16_f32 v132, v28, v29
v_cvt_pk_bf16_f32 v133, v30, v31
v_lshlrev_b32 v32, 16, v134
s_waitcnt lgkmcnt(6)
v_mfma_f32_32x32x16_bf16 a[64:79], a[144:147], v[128:131], a[64:79]
ds_read_b64_tr_b16 a[132:133], v4 offset:10240
ds_read_b64_tr_b16 a[134:135], v4 offset:10752
v_and_b32 v33, s49, v134
v_lshlrev_b32 v34, 16, v135
v_and_b32 v35, s49, v135
v_fma_f32 v32, v32, v24, v26
v_mfma_f32_32x32x16_bf16 a[80:95], a[148:151], v[128:131], a[80:95]
ds_read_b64_tr_b16 a[136:137], v5 offset:8192
ds_read_b64_tr_b16 a[138:139], v5 offset:8704
buffer_load_dwordx4 v20, s[24:27], s41 offen offset:1024 lds
s_add_u32 m0, s47, 18432
v_fma_f32 v33, v33, v24, v26
v_fma_f32 v34, v34, v24, v26
s_waitcnt lgkmcnt(6)
v_mfma_f32_32x32x16_bf16 a[96:111], a[152:155], v[128:131], a[96:111]
ds_read_b64_tr_b16 a[140:141], v5 offset:10240
ds_read_b64_tr_b16 a[142:143], v5 offset:10752
v_fma_f32 v35, v35, v24, v26
v_cvt_pk_bf16_f32 v134, v32, v33
v_cvt_pk_bf16_f32 v135, v34, v35
v_mul_u32_u24 v37, 320, v37
v_mfma_f32_32x32x16_bf16 a[112:127], a[156:159], v[128:131], a[112:127]
ds_read_b64_tr_b16 a[144:145], v7 offset:8192
ds_read_b64_tr_b16 a[146:147], v7 offset:8704
buffer_load_dwordx4 v2, s[28:31], s42 offen offset:0 lds
v_bfe_u32 v38, v1, 4, 1
v_lshl_add_u32 v37, v38, 5, v37
v_and_b32 v38, 3, v1
s_waitcnt lgkmcnt(6)
v_mfma_f32_32x32x16_bf16 a[0:15], a[128:131], v[132:135], a[0:15]
ds_read_b64_tr_b16 a[148:149], v8 offset:8192
ds_read_b64_tr_b16 a[150:151], v8 offset:8704
v_lshlrev_b32 v28, 16, v136
v_and_b32 v29, s49, v136
v_lshlrev_b32 v30, 16, v137
v_and_b32 v31, s49, v137
v_mfma_f32_32x32x16_bf16 a[16:31], a[132:135], v[132:135], a[16:31]
ds_read_b64_tr_b16 a[152:153], v9 offset:8192
ds_read_b64_tr_b16 a[154:155], v9 offset:8704
buffer_load_dwordx4 v3, s[28:31], s42 offen offset:1024 lds
s_add_u32 s41, s41, 110592
s_add_u32 s42, s42, s43
s_cmp_ge_u32 s41, 2211840
s_cselect_b32 s41, 0, s41
s_cselect_b32 s42, 0, s42
s_add_u32 m0, s47, 32768
s_waitcnt lgkmcnt(6)
v_mfma_f32_32x32x16_bf16 a[32:47], a[136:139], v[132:135], a[32:47]
ds_read_b64_tr_b16 a[156:157], v10 offset:8192
ds_read_b64_tr_b16 a[158:159], v10 offset:8704
v_fma_f32 v28, v28, v24, v26
v_fma_f32 v29, v29, v24, v26
v_fma_f32 v30, v30, v24, v26
v_fma_f32 v31, v31, v24, v26
v_mfma_f32_32x32x16_bf16 a[48:63], a[140:143], v[132:135], a[48:63]
ds_read_b64_tr_b16 a[128:129], v4 offset:16384
ds_read_b64_tr_b16 a[130:131], v4 offset:16896
buffer_load_dwordx4 v19, s[12:15], s41 offen offset:0 lds
v_cvt_pk_bf16_f32 v136, v28, v29
v_cvt_pk_bf16_f32 v137, v30, v31
v_lshlrev_b32 v32, 16, v138
s_waitcnt lgkmcnt(6)
v_mfma_f32_32x32x16_bf16 a[64:79], a[144:147], v[132:135], a[64:79]
ds_read_b64_tr_b16 a[132:133], v4 offset:18432
ds_read_b64_tr_b16 a[134:135], v4 offset:18944
v_and_b32 v33, s49, v138
v_lshlrev_b32 v34, 16, v139
v_and_b32 v35, s49, v139
v_fma_f32 v32, v32, v24, v26
v_mfma_f32_32x32x16_bf16 a[80:95], a[148:151], v[132:135], a[80:95]
ds_read_b64_tr_b16 a[136:137], v5 offset:16384
ds_read_b64_tr_b16 a[138:139], v5 offset:16896
buffer_load_dwordx4 v20, s[24:27], s41 offen offset:1024 lds
s_add_u32 m0, s47, 34816
v_fma_f32 v33, v33, v24, v26
v_fma_f32 v34, v34, v24, v26
s_waitcnt lgkmcnt(6)
v_mfma_f32_32x32x16_bf16 a[96:111], a[152:155], v[132:135], a[96:111]
ds_read_b64_tr_b16 a[140:141], v5 offset:18432
ds_read_b64_tr_b16 a[142:143], v5 offset:18944
v_fma_f32 v35, v35, v24, v26
v_cvt_pk_bf16_f32 v138, v32, v33
v_cvt_pk_bf16_f32 v139, v34, v35
v_lshl_add_u32 v37, v38, 3, v37
v_mfma_f32_32x32x16_bf16 a[112:127], a[156:159], v[132:135], a[112:127]
ds_read_b64_tr_b16 a[144:145], v7 offset:16384
ds_read_b64_tr_b16 a[146:147], v7 offset:16896
buffer_load_dwordx4 v2, s[28:31], s42 offen offset:0 lds
v_add_u32 v45, s62, v37
s_waitcnt lgkmcnt(6)
v_mfma_f32_32x32x16_bf16 a[0:15], a[128:131], v[136:139], a[0:15]
ds_read_b64_tr_b16 a[148:149], v8 offset:16384
ds_read_b64_tr_b16 a[150:151], v8 offset:16896
v_lshlrev_b32 v28, 16, v140
v_and_b32 v29, s49, v140
v_lshlrev_b32 v30, 16, v141
v_and_b32 v31, s49, v141
v_mfma_f32_32x32x16_bf16 a[16:31], a[132:135], v[136:139], a[16:31]
ds_read_b64_tr_b16 a[152:153], v9 offset:16384
ds_read_b64_tr_b16 a[154:155], v9 offset:16896
buffer_load_dwordx4 v3, s[28:31], s42 offen offset:1024 lds
s_add_u32 s41, s41, 110592
s_add_u32 s42, s42, s43
s_add_u32 m0, s47, 49152
s_waitcnt lgkmcnt(6)
v_mfma_f32_32x32x16_bf16 a[32:47], a[136:139], v[136:139], a[32:47]
ds_read_b64_tr_b16 a[156:157], v10 offset:16384
ds_read_b64_tr_b16 a[158:159], v10 offset:16896
v_fma_f32 v28, v28, v24, v26
v_fma_f32 v29, v29, v24, v26
v_fma_f32 v30, v30, v24, v26
v_fma_f32 v31, v31, v24, v26
v_mfma_f32_32x32x16_bf16 a[48:63], a[140:143], v[136:139], a[48:63]
ds_read_b64_tr_b16 a[128:129], v4 offset:24576
ds_read_b64_tr_b16 a[130:131], v4 offset:25088
buffer_load_dwordx4 v19, s[12:15], s41 offen offset:0 lds
v_cvt_pk_bf16_f32 v140, v28, v29
v_cvt_pk_bf16_f32 v141, v30, v31
v_lshlrev_b32 v32, 16, v142
s_waitcnt lgkmcnt(6)
v_mfma_f32_32x32x16_bf16 a[64:79], a[144:147], v[136:139], a[64:79]
ds_read_b64_tr_b16 a[132:133], v4 offset:26624
ds_read_b64_tr_b16 a[134:135], v4 offset:27136
v_and_b32 v33, s49, v142
v_lshlrev_b32 v34, 16, v143
v_and_b32 v35, s49, v143
v_fma_f32 v32, v32, v24, v26
v_mfma_f32_32x32x16_bf16 a[80:95], a[148:151], v[136:139], a[80:95]
ds_read_b64_tr_b16 a[136:137], v5 offset:24576
ds_read_b64_tr_b16 a[138:139], v5 offset:25088
buffer_load_dwordx4 v20, s[24:27], s41 offen offset:1024 lds
s_add_u32 m0, s47, 51200
v_fma_f32 v33, v33, v24, v26
v_fma_f32 v34, v34, v24, v26
s_waitcnt lgkmcnt(6)
v_mfma_f32_32x32x16_bf16 a[96:111], a[152:155], v[136:139], a[96:111]
ds_read_b64_tr_b16 a[140:141], v5 offset:26624
ds_read_b64_tr_b16 a[142:143], v5 offset:27136
v_fma_f32 v35, v35, v24, v26
v_cvt_pk_bf16_f32 v142, v32, v33
v_cvt_pk_bf16_f32 v143, v34, v35
v_mfma_f32_32x32x16_bf16 a[112:127], a[156:159], v[136:139], a[112:127]
ds_read_b64_tr_b16 a[144:145], v7 offset:24576
ds_read_b64_tr_b16 a[146:147], v7 offset:25088
buffer_load_dwordx4 v2, s[28:31], s42 offen offset:0 lds
s_waitcnt lgkmcnt(6)
v_mfma_f32_32x32x16_bf16 a[0:15], a[128:131], v[140:143], a[0:15]
ds_read_b64_tr_b16 a[148:149], v8 offset:24576
ds_read_b64_tr_b16 a[150:151], v8 offset:25088
v_lshlrev_b32 v28, 16, v144
v_and_b32 v29, s49, v144
v_lshlrev_b32 v30, 16, v145
v_and_b32 v31, s49, v145
v_mfma_f32_32x32x16_bf16 a[16:31], a[132:135], v[140:143], a[16:31]
ds_read_b64_tr_b16 a[152:153], v9 offset:24576
ds_read_b64_tr_b16 a[154:155], v9 offset:25088
buffer_load_dwordx4 v3, s[28:31], s42 offen offset:1024 lds
s_add_u32 s41, s41, 110592
s_add_u32 s42, s42, s43
s_cmp_ge_u32 s41, 2211840
s_cselect_b32 s41, 0, s41
s_cselect_b32 s42, 0, s42
s_waitcnt lgkmcnt(6)
v_mfma_f32_32x32x16_bf16 a[32:47], a[136:139], v[140:143], a[32:47]
ds_read_b64_tr_b16 a[156:157], v10 offset:24576
ds_read_b64_tr_b16 a[158:159], v10 offset:25088
v_fma_f32 v28, v28, v24, v26
v_fma_f32 v29, v29, v24, v26
v_fma_f32 v30, v30, v24, v26
v_fma_f32 v31, v31, v24, v26
v_mfma_f32_32x32x16_bf16 a[48:63], a[140:143], v[140:143], a[48:63]
ds_read_b64_tr_b16 a[128:129], v4 offset:32768
ds_read_b64_tr_b16 a[130:131], v4 offset:33280
v_cvt_pk_bf16_f32 v144, v28, v29
v_cvt_pk_bf16_f32 v145, v30, v31
v_lshlrev_b32 v32, 16, v146
v_and_b32 v33, s49, v146
s_waitcnt lgkmcnt(6)
v_mfma_f32_32x32x16_bf16 a[64:79], a[144:147], v[140:143], a[64:79]
ds_read_b64_tr_b16 a[132:133], v4 offset:34816
ds_read_b64_tr_b16 a[134:135], v4 offset:35328
v_lshlrev_b32 v34, 16, v147
v_and_b32 v35, s49, v147
v_fma_f32 v32, v32, v24, v26
v_fma_f32 v33, v33, v24, v26
v_mfma_f32_32x32x16_bf16 a[80:95], a[148:151], v[140:143], a[80:95]
ds_read_b64_tr_b16 a[136:137], v5 offset:32768
ds_read_b64_tr_b16 a[138:139], v5 offset:33280
v_fma_f32 v34, v34, v24, v26
v_fma_f32 v35, v35, v24, v26
v_cvt_pk_bf16_f32 v146, v32, v33
v_cvt_pk_bf16_f32 v147, v34, v35
s_waitcnt lgkmcnt(6)
v_mfma_f32_32x32x16_bf16 a[96:111], a[152:155], v[140:143], a[96:111]
ds_read_b64_tr_b16 a[140:141], v5 offset:34816
ds_read_b64_tr_b16 a[142:143], v5 offset:35328
s_add_u32 m0, s62, 0
s_nop 0
buffer_load_dwordx4 v40, s[76:79], s81 offen lds
s_add_u32 m0, s62, 1024
s_nop 0
buffer_load_dwordx4 v41, s[76:79], s81 offen lds
s_add_u32 m0, s62, 2048
s_nop 0
buffer_load_dwordx4 v42, s[76:79], s81 offen lds
s_add_u32 m0, s62, 3072
s_nop 0
buffer_load_dwordx4 v43, s[76:79], s81 offen lds
v_mfma_f32_32x32x16_bf16 a[112:127], a[156:159], v[140:143], a[112:127]
ds_read_b64_tr_b16 a[144:145], v7 offset:32768
ds_read_b64_tr_b16 a[146:147], v7 offset:33280
s_add_u32 m0, s62, 4096
s_nop 0
buffer_load_dwordx4 v44, s[76:79], s81 offen lds
s_waitcnt lgkmcnt(6)
v_mfma_f32_32x32x16_bf16 a[0:15], a[128:131], v[144:147], a[0:15]
ds_read_b64_tr_b16 a[148:149], v8 offset:32768
ds_read_b64_tr_b16 a[150:151], v8 offset:33280
v_lshlrev_b32 v28, 16, v148
v_and_b32 v29, s49, v148
v_lshlrev_b32 v30, 16, v149
v_and_b32 v31, s49, v149
v_mfma_f32_32x32x16_bf16 a[16:31], a[132:135], v[144:147], a[16:31]
ds_read_b64_tr_b16 a[152:153], v9 offset:32768
ds_read_b64_tr_b16 a[154:155], v9 offset:33280
v_fma_f32 v28, v28, v24, v26
v_fma_f32 v29, v29, v24, v26
v_fma_f32 v30, v30, v24, v26
v_fma_f32 v31, v31, v24, v26
s_waitcnt lgkmcnt(6)
v_mfma_f32_32x32x16_bf16 a[32:47], a[136:139], v[144:147], a[32:47]
ds_read_b64_tr_b16 a[156:157], v10 offset:32768
ds_read_b64_tr_b16 a[158:159], v10 offset:33280
v_cvt_pk_bf16_f32 v148, v28, v29
v_cvt_pk_bf16_f32 v149, v30, v31
v_lshlrev_b32 v32, 16, v150
v_and_b32 v33, s49, v150
v_mfma_f32_32x32x16_bf16 a[48:63], a[140:143], v[144:147], a[48:63]
ds_read_b64_tr_b16 a[128:129], v4 offset:40960
ds_read_b64_tr_b16 a[130:131], v4 offset:41472
v_lshlrev_b32 v34, 16, v151
v_and_b32 v35, s49, v151
v_fma_f32 v32, v32, v24, v26
v_fma_f32 v33, v33, v24, v26
s_waitcnt lgkmcnt(6)
v_mfma_f32_32x32x16_bf16 a[64:79], a[144:147], v[144:147], a[64:79]
ds_read_b64_tr_b16 a[132:133], v4 offset:43008
ds_read_b64_tr_b16 a[134:135], v4 offset:43520
v_fma_f32 v34, v34, v24, v26
v_fma_f32 v35, v35, v24, v26
v_cvt_pk_bf16_f32 v150, v32, v33
v_cvt_pk_bf16_f32 v151, v34, v35
v_mfma_f32_32x32x16_bf16 a[80:95], a[148:151], v[144:147], a[80:95]
ds_read_b64_tr_b16 a[136:137], v5 offset:40960
ds_read_b64_tr_b16 a[138:139], v5 offset:41472
s_waitcnt lgkmcnt(6)
v_mfma_f32_32x32x16_bf16 a[96:111], a[152:155], v[144:147], a[96:111]
ds_read_b64_tr_b16 a[140:141], v5 offset:43008
ds_read_b64_tr_b16 a[142:143], v5 offset:43520
v_mfma_f32_32x32x16_bf16 a[112:127], a[156:159], v[144:147], a[112:127]
ds_read_b64_tr_b16 a[144:145], v7 offset:40960
ds_read_b64_tr_b16 a[146:147], v7 offset:41472
s_waitcnt lgkmcnt(6)
v_mfma_f32_32x32x16_bf16 a[0:15], a[128:131], v[148:151], a[0:15]
ds_read_b64_tr_b16 a[148:149], v8 offset:40960
ds_read_b64_tr_b16 a[150:151], v8 offset:41472
v_lshlrev_b32 v28, 16, v152
v_and_b32 v29, s49, v152
v_lshlrev_b32 v30, 16, v153
v_and_b32 v31, s49, v153
v_mfma_f32_32x32x16_bf16 a[16:31], a[132:135], v[148:151], a[16:31]
ds_read_b64_tr_b16 a[152:153], v9 offset:40960
ds_read_b64_tr_b16 a[154:155], v9 offset:41472
v_fma_f32 v28, v28, v24, v26
v_fma_f32 v29, v29, v24, v26
v_fma_f32 v30, v30, v24, v26
v_fma_f32 v31, v31, v24, v26
s_waitcnt lgkmcnt(6)
v_mfma_f32_32x32x16_bf16 a[32:47], a[136:139], v[148:151], a[32:47]
ds_read_b64_tr_b16 a[156:157], v10 offset:40960
ds_read_b64_tr_b16 a[158:159], v10 offset:41472
v_cvt_pk_bf16_f32 v152, v28, v29
v_cvt_pk_bf16_f32 v153, v30, v31
v_lshlrev_b32 v32, 16, v154
v_and_b32 v33, s49, v154
v_mfma_f32_32x32x16_bf16 a[48:63], a[140:143], v[148:151], a[48:63]
ds_read_b64_tr_b16 a[128:129], v4 offset:49152
ds_read_b64_tr_b16 a[130:131], v4 offset:49664
v_lshlrev_b32 v34, 16, v155
v_and_b32 v35, s49, v155
v_fma_f32 v32, v32, v24, v26
v_fma_f32 v33, v33, v24, v26
s_waitcnt lgkmcnt(6)
v_mfma_f32_32x32x16_bf16 a[64:79], a[144:147], v[148:151], a[64:79]
ds_read_b64_tr_b16 a[132:133], v4 offset:51200
ds_read_b64_tr_b16 a[134:135], v4 offset:51712
v_fma_f32 v34, v34, v24, v26
v_fma_f32 v35, v35, v24, v26
v_cvt_pk_bf16_f32 v154, v32, v33
v_cvt_pk_bf16_f32 v155, v34, v35
v_mfma_f32_32x32x16_bf16 a[80:95], a[148:151], v[148:151], a[80:95]
ds_read_b64_tr_b16 a[136:137], v5 offset:49152
ds_read_b64_tr_b16 a[138:139], v5 offset:49664
s_waitcnt lgkmcnt(6)
v_mfma_f32_32x32x16_bf16 a[96:111], a[152:155], v[148:151], a[96:111]
ds_read_b64_tr_b16 a[140:141], v5 offset:51200
ds_read_b64_tr_b16 a[142:143], v5 offset:51712
v_mfma_f32_32x32x16_bf16 a[112:127], a[156:159], v[148:151], a[112:127]
ds_read_b64_tr_b16 a[144:145], v7 offset:49152
ds_read_b64_tr_b16 a[146:147], v7 offset:49664
s_waitcnt lgkmcnt(6)
v_mfma_f32_32x32x16_bf16 a[0:15], a[128:131], v[152:155], a[0:15]
ds_read_b64_tr_b16 a[148:149], v8 offset:49152
ds_read_b64_tr_b16 a[150:151], v8 offset:49664
v_lshlrev_b32 v28, 16, v156
v_and_b32 v29, s49, v156
v_lshlrev_b32 v30, 16, v157
v_and_b32 v31, s49, v157
v_mfma_f32_32x32x16_bf16 a[16:31], a[132:135], v[152:155], a[16:31]
ds_read_b64_tr_b16 a[152:153], v9 offset:49152
ds_read_b64_tr_b16 a[154:155], v9 offset:49664
v_fma_f32 v28, v28, v24, v26
v_fma_f32 v29, v29, v24, v26
v_fma_f32 v30, v30, v24, v26
v_fma_f32 v31, v31, v24, v26
s_waitcnt lgkmcnt(6)
v_mfma_f32_32x32x16_bf16 a[32:47], a[136:139], v[152:155], a[32:47]
ds_read_b64_tr_b16 a[156:157], v10 offset:49152
ds_read_b64_tr_b16 a[158:159], v10 offset:49664
v_cvt_pk_bf16_f32 v156, v28, v29
v_cvt_pk_bf16_f32 v157, v30, v31
v_lshlrev_b32 v32, 16, v158
v_and_b32 v33, s49, v158
v_mfma_f32_32x32x16_bf16 a[48:63], a[140:143], v[152:155], a[48:63]
ds_read_b64_tr_b16 a[128:129], v4 offset:57344
ds_read_b64_tr_b16 a[130:131], v4 offset:57856
v_lshlrev_b32 v34, 16, v159
v_and_b32 v35, s49, v159
v_fma_f32 v32, v32, v24, v26
v_fma_f32 v33, v33, v24, v26
s_waitcnt lgkmcnt(6)
v_mfma_f32_32x32x16_bf16 a[64:79], a[144:147], v[152:155], a[64:79]
ds_read_b64_tr_b16 a[132:133], v4 offset:59392
ds_read_b64_tr_b16 a[134:135], v4 offset:59904
v_fma_f32 v34, v34, v24, v26
v_fma_f32 v35, v35, v24, v26
v_cvt_pk_bf16_f32 v158, v32, v33
v_cvt_pk_bf16_f32 v159, v34, v35
v_mfma_f32_32x32x16_bf16 a[80:95], a[148:151], v[152:155], a[80:95]
ds_read_b64_tr_b16 a[136:137], v5 offset:57344
ds_read_b64_tr_b16 a[138:139], v5 offset:57856
s_waitcnt lgkmcnt(6)
v_mfma_f32_32x32x16_bf16 a[96:111], a[152:155], v[152:155], a[96:111]
ds_read_b64_tr_b16 a[140:141], v5 offset:59392
ds_read_b64_tr_b16 a[142:143], v5 offset:59904
v_mfma_f32_32x32x16_bf16 a[112:127], a[156:159], v[152:155], a[112:127]
ds_read_b64_tr_b16 a[144:145], v7 offset:57344
ds_read_b64_tr_b16 a[146:147], v7 offset:57856
s_waitcnt lgkmcnt(6)
v_mfma_f32_32x32x16_bf16 a[0:15], a[128:131], v[156:159], a[0:15]
ds_read_b64_tr_b16 a[148:149], v8 offset:57344
ds_read_b64_tr_b16 a[150:151], v8 offset:57856
v_lshlrev_b32 v28, 16, v160
v_and_b32 v29, s49, v160
v_lshlrev_b32 v30, 16, v161
v_and_b32 v31, s49, v161
v_mfma_f32_32x32x16_bf16 a[16:31], a[132:135], v[156:159], a[16:31]
ds_read_b64_tr_b16 a[152:153], v9 offset:57344
ds_read_b64_tr_b16 a[154:155], v9 offset:57856
v_fma_f32 v28, v28, v24, v26
v_fma_f32 v29, v29, v24, v26
v_fma_f32 v30, v30, v24, v26
v_fma_f32 v31, v31, v24, v26
s_waitcnt lgkmcnt(6)
v_mfma_f32_32x32x16_bf16 a[32:47], a[136:139], v[156:159], a[32:47]
ds_read_b64_tr_b16 a[156:157], v10 offset:57344
ds_read_b64_tr_b16 a[158:159], v10 offset:57856
v_cvt_pk_bf16_f32 v160, v28, v29
v_cvt_pk_bf16_f32 v161, v30, v31
v_lshlrev_b32 v32, 16, v162
v_and_b32 v33, s49, v162
v_mfma_f32_32x32x16_bf16 a[48:63], a[140:143], v[156:159], a[48:63]
s_waitcnt vmcnt(5)
s_barrier
ds_read_b64_tr_b16 a[128:129], v12 offset:0
ds_read_b64_tr_b16 a[130:131], v12 offset:512
s_add_u32 m0, s47, 65536
s_nop 0
buffer_load_dwordx4 v19, s[12:15], s41 offen offset:0 lds
v_lshlrev_b32 v34, 16, v163
v_and_b32 v35, s49, v163
s_waitcnt lgkmcnt(6)
v_mfma_f32_32x32x16_bf16 a[64:79], a[144:147], v[156:159], a[64:79]
ds_read_b64_tr_b16 a[132:133], v12 offset:2048
ds_read_b64_tr_b16 a[134:135], v12 offset:2560
v_fma_f32 v32, v32, v24, v26
v_fma_f32 v33, v33, v24, v26
v_fma_f32 v34, v34, v24, v26
v_fma_f32 v35, v35, v24, v26
v_mfma_f32_32x32x16_bf16 a[80:95], a[148:151], v[156:159], a[80:95]
ds_read_b64_tr_b16 a[136:137], v13 offset:0
ds_read_b64_tr_b16 a[138:139], v13 offset:512
buffer_load_dwordx4 v20, s[24:27], s41 offen offset:1024 lds
s_add_u32 m0, s47, 67584
v_cvt_pk_bf16_f32 v162, v32, v33
v_cvt_pk_bf16_f32 v163, v34, v35
s_waitcnt lgkmcnt(6)
v_mfma_f32_32x32x16_bf16 a[96:111], a[152:155], v[156:159], a[96:111]
ds_read_b64_tr_b16 a[140:141], v13 offset:2048
ds_read_b64_tr_b16 a[142:143], v13 offset:2560
v_mfma_f32_32x32x16_bf16 a[112:127], a[156:159], v[156:159], a[112:127]
ds_read_b64_tr_b16 a[144:145], v15 offset:0
ds_read_b64_tr_b16 a[146:147], v15 offset:512
buffer_load_dwordx4 v2, s[28:31], s42 offen offset:0 lds
s_waitcnt lgkmcnt(6)
v_mfma_f32_32x32x16_bf16 a[0:15], a[128:131], v[160:163], a[0:15]
ds_read_b64_tr_b16 a[148:149], v16 offset:0
ds_read_b64_tr_b16 a[150:151], v16 offset:512
v_lshlrev_b32 v28, 16, v164
v_and_b32 v29, s49, v164
v_lshlrev_b32 v30, 16, v165
v_and_b32 v31, s49, v165
v_mfma_f32_32x32x16_bf16 a[16:31], a[132:135], v[160:163], a[16:31]
ds_read_b64_tr_b16 a[152:153], v17 offset:0
ds_read_b64_tr_b16 a[154:155], v17 offset:512
buffer_load_dwordx4 v3, s[28:31], s42 offen offset:1024 lds
s_add_u32 s41, s41, 110592
s_add_u32 s42, s42, s43
s_add_u32 m0, s47, 81920
s_waitcnt lgkmcnt(6)
v_mfma_f32_32x32x16_bf16 a[32:47], a[136:139], v[160:163], a[32:47]
ds_read_b64_tr_b16 a[156:157], v18 offset:0
ds_read_b64_tr_b16 a[158:159], v18 offset:512
v_fma_f32 v28, v28, v24, v26
v_fma_f32 v29, v29, v24, v26
v_fma_f32 v30, v30, v24, v26
v_fma_f32 v31, v31, v24, v26
v_mfma_f32_32x32x16_bf16 a[48:63], a[140:143], v[160:163], a[48:63]
ds_read_b64_tr_b16 a[128:129], v12 offset:8192
ds_read_b64_tr_b16 a[130:131], v12 offset:8704
buffer_load_dwordx4 v19, s[12:15], s41 offen offset:0 lds
v_cvt_pk_bf16_f32 v164, v28, v29
v_cvt_pk_bf16_f32 v165, v30, v31
v_lshlrev_b32 v32, 16, v166
s_waitcnt lgkmcnt(6)
v_mfma_f32_32x32x16_bf16 a[64:79], a[144:147], v[160:163], a[64:79]
ds_read_b64_tr_b16 a[132:133], v12 offset:10240
ds_read_b64_tr_b16 a[134:135], v12 offset:10752
v_and_b32 v33, s49, v166
v_lshlrev_b32 v34, 16, v167
v_and_b32 v35, s49, v167
v_fma_f32 v32, v32, v24, v26
v_mfma_f32_32x32x16_bf16 a[80:95], a[148:151], v[160:163], a[80:95]
ds_read_b64_tr_b16 a[136:137], v13 offset:8192
ds_read_b64_tr_b16 a[138:139], v13 offset:8704
buffer_load_dwordx4 v20, s[24:27], s41 offen offset:1024 lds
s_add_u32 m0, s47, 83968
v_fma_f32 v33, v33, v24, v26
v_fma_f32 v34, v34, v24, v26
s_waitcnt lgkmcnt(6)
v_mfma_f32_32x32x16_bf16 a[96:111], a[152:155], v[160:163], a[96:111]
ds_read_b64_tr_b16 a[140:141], v13 offset:10240
ds_read_b64_tr_b16 a[142:143], v13 offset:10752
v_fma_f32 v35, v35, v24, v26
v_cvt_pk_bf16_f32 v166, v32, v33
v_cvt_pk_bf16_f32 v167, v34, v35
v_mfma_f32_32x32x16_bf16 a[112:127], a[156:159], v[160:163], a[112:127]
ds_read_b64_tr_b16 a[144:145], v15 offset:8192
ds_read_b64_tr_b16 a[146:147], v15 offset:8704
buffer_load_dwordx4 v2, s[28:31], s42 offen offset:0 lds
s_waitcnt lgkmcnt(6)
v_mfma_f32_32x32x16_bf16 a[0:15], a[128:131], v[164:167], a[0:15]
ds_read_b64_tr_b16 a[148:149], v16 offset:8192
ds_read_b64_tr_b16 a[150:151], v16 offset:8704
v_lshlrev_b32 v28, 16, v168
v_and_b32 v29, s49, v168
v_lshlrev_b32 v30, 16, v169
v_and_b32 v31, s49, v169
v_mfma_f32_32x32x16_bf16 a[16:31], a[132:135], v[164:167], a[16:31]
ds_read_b64_tr_b16 a[152:153], v17 offset:8192
ds_read_b64_tr_b16 a[154:155], v17 offset:8704
buffer_load_dwordx4 v3, s[28:31], s42 offen offset:1024 lds
s_add_u32 s41, s41, 110592
s_add_u32 s42, s42, s43
s_cmp_ge_u32 s41, 2211840
s_cselect_b32 s41, 0, s41
s_cselect_b32 s42, 0, s42
s_add_u32 m0, s47, 98304
s_waitcnt lgkmcnt(6)
v_mfma_f32_32x32x16_bf16 a[32:47], a[136:139], v[164:167], a[32:47]
ds_read_b64_tr_b16 a[156:157], v18 offset:8192
ds_read_b64_tr_b16 a[158:159], v18 offset:8704
v_fma_f32 v28, v28, v24, v26
v_fma_f32 v29, v29, v24, v26
v_fma_f32 v30, v30, v24, v26
v_fma_f32 v31, v31, v24, v26
v_mfma_f32_32x32x16_bf16 a[48:63], a[140:143], v[164:167], a[48:63]
ds_read_b64_tr_b16 a[128:129], v12 offset:16384
ds_read_b64_tr_b16 a[130:131], v12 offset:16896
buffer_load_dwordx4 v19, s[12:15], s41 offen offset:0 lds
v_cvt_pk_bf16_f32 v168, v28, v29
v_cvt_pk_bf16_f32 v169, v30, v31
v_lshlrev_b32 v32, 16, v170
s_waitcnt lgkmcnt(6)
v_mfma_f32_32x32x16_bf16 a[64:79], a[144:147], v[164:167], a[64:79]
ds_read_b64_tr_b16 a[132:133], v12 offset:18432
ds_read_b64_tr_b16 a[134:135], v12 offset:18944
s_waitcnt vmcnt(9)
ds_read_b64_tr_b16 v[48:49], v45 offset:0
ds_read_b64_tr_b16 v[50:51], v45 offset:2560
ds_read_b64_tr_b16 v[52:53], v45 offset:64
ds_read_b64_tr_b16 v[54:55], v45 offset:2624
ds_read_b64_tr_b16 v[56:57], v45 offset:128
ds_read_b64_tr_b16 v[58:59], v45 offset:2688
v_mfma_f32_32x32x16_bf16 a[80:95], a[148:151], v[164:167], a[80:95]
ds_read_b64_tr_b16 a[136:137], v13 offset:16384
ds_read_b64_tr_b16 a[138:139], v13 offset:16896
buffer_load_dwordx4 v20, s[24:27], s41 offen offset:1024 lds
s_add_u32 m0, s47, 100352
v_and_b32 v33, s49, v170
v_lshlrev_b32 v34, 16, v171
s_waitcnt lgkmcnt(12)
v_mfma_f32_32x32x16_bf16 a[96:111], a[152:155], v[164:167], a[96:111]
ds_read_b64_tr_b16 a[140:141], v13 offset:18432
ds_read_b64_tr_b16 a[142:143], v13 offset:18944
ds_read_b64_tr_b16 v[60:61], v45 offset:160
ds_read_b64_tr_b16 v[62:63], v45 offset:2720
ds_read_b64_tr_b16 v[64:65], v45 offset:224
ds_read_b64_tr_b16 v[66:67], v45 offset:2784
ds_read_b64_tr_b16 v[68:69], v45 offset:288
ds_read_b64_tr_b16 v[70:71], v45 offset:2848
v_mfma_f32_32x32x16_bf16 a[112:127], a[156:159], v[164:167], a[112:127]
ds_read_b64_tr_b16 a[144:145], v15 offset:16384
ds_read_b64_tr_b16 a[146:147], v15 offset:16896
buffer_load_dwordx4 v2, s[28:31], s42 offen offset:0 lds
v_and_b32 v35, s49, v171
v_fma_f32 v32, v32, v24, v26
v_fma_f32 v33, v33, v24, v26
v_fma_f32 v34, v34, v24, v26
v_fma_f32 v35, v35, v24, v26
v_cvt_pk_bf16_f32 v170, v32, v33
v_cvt_pk_bf16_f32 v171, v34, v35
s_waitcnt lgkmcnt(15)
s_nop 0
v_mfma_f32_32x32x16_bf16 a[0:15], a[128:131], v[168:171], a[0:15]
ds_read_b64_tr_b16 a[148:149], v16 offset:16384
ds_read_b64_tr_b16 a[150:151], v16 offset:16896
v_lshlrev_b32 v28, 16, v172
v_and_b32 v29, s49, v172
v_lshlrev_b32 v30, 16, v173
v_and_b32 v31, s49, v173
v_mfma_f32_32x32x16_bf16 a[16:31], a[132:135], v[168:171], a[16:31]
ds_read_b64_tr_b16 a[152:153], v17 offset:16384
ds_read_b64_tr_b16 a[154:155], v17 offset:16896
buffer_load_dwordx4 v3, s[28:31], s42 offen offset:1024 lds
s_add_u32 s41, s41, 110592
s_add_u32 s42, s42, s43
s_add_u32 m0, s47, 114688
s_waitcnt lgkmcnt(12)
v_mfma_f32_32x32x16_bf16 a[32:47], a[136:139], v[168:171], a[32:47]
ds_read_b64_tr_b16 a[156:157], v18 offset:16384
ds_read_b64_tr_b16 a[158:159], v18 offset:16896
v_fma_f32 v28, v28, v24, v26
v_fma_f32 v29, v29, v24, v26
v_fma_f32 v30, v30, v24, v26
v_fma_f32 v31, v31, v24, v26
v_mfma_f32_32x32x16_bf16 a[48:63], a[140:143], v[168:171], a[48:63]
ds_read_b64_tr_b16 a[128:129], v12 offset:24576
ds_read_b64_tr_b16 a[130:131], v12 offset:25088
buffer_load_dwordx4 v19, s[12:15], s41 offen offset:0 lds
v_cvt_pk_bf16_f32 v172, v28, v29
v_cvt_pk_bf16_f32 v173, v30, v31
v_lshlrev_b32 v32, 16, v174
s_waitcnt lgkmcnt(6)
v_mfma_f32_32x32x16_bf16 a[64:79], a[144:147], v[168:171], a[64:79]
ds_read_b64_tr_b16 a[132:133], v12 offset:26624
ds_read_b64_tr_b16 a[134:135], v12 offset:27136
s_cmp_eq_u32 s3, 1
s_cbranch_scc1 RPS0
s_add_u32 s81, s83, 0
buffer_store_dwordx4 v[48:51], v23, s[20:23], s81 offen sc1
RPS0:
v_mfma_f32_32x32x16_bf16 a[80:95], a[148:151], v[168:171], a[80:95]
ds_read_b64_tr_b16 a[136:137], v13 offset:24576
ds_read_b64_tr_b16 a[138:139], v13 offset:25088
buffer_load_dwordx4 v20, s[24:27], s41 offen offset:1024 lds
s_add_u32 m0, s47, 116736
v_and_b32 v33, s49, v174
v_lshlrev_b32 v34, 16, v175
s_waitcnt lgkmcnt(6)
v_mfma_f32_32x32x16_bf16 a[96:111], a[152:155], v[168:171], a[96:111]
ds_read_b64_tr_b16 a[140:141], v13 offset:26624
ds_read_b64_tr_b16 a[142:143], v13 offset:27136
s_cmp_eq_u32 s3, 1
s_cbranch_scc1 RPS1
s_add_u32 s81, s83, 1024
buffer_store_dwordx4 v[52:55], v23, s[20:23], s81 offen sc1
RPS1:
v_mfma_f32_32x32x16_bf16 a[112:127], a[156:159], v[168:171], a[112:127]
ds_read_b64_tr_b16 a[144:145], v15 offset:24576
ds_read_b64_tr_b16 a[146:147], v15 offset:25088
buffer_load_dwordx4 v2, s[28:31], s42 offen offset:0 lds
v_and_b32 v35, s49, v175
v_fma_f32 v32, v32, v24, v26
v_fma_f32 v33, v33, v24, v26
v_fma_f32 v34, v34, v24, v26
v_fma_f32 v35, v35, v24, v26
v_cvt_pk_bf16_f32 v174, v32, v33
v_cvt_pk_bf16_f32 v175, v34, v35
s_waitcnt lgkmcnt(6)
s_nop 0
v_mfma_f32_32x32x16_bf16 a[0:15], a[128:131], v[172:175], a[0:15]
ds_read_b64_tr_b16 a[148:149], v16 offset:24576
ds_read_b64_tr_b16 a[150:151], v16 offset:25088
s_cmp_eq_u32 s3, 1
s_cbranch_scc1 RPS2
v_lshrrev_b32 v40, 5, v1
v_and_b32 v41, 15, v1
v_lshl_add_u32 v40, v40, 4, v41
v_lshlrev_b32 v40, 4, v40
s_add_u32 s81, s83, 2048
s_mov_b32 exec_lo, 0xffff
s_mov_b32 exec_hi, 0xffff
buffer_store_dwordx4 v[56:59], v40, s[20:23], s81 offen sc1
s_mov_b64 exec, -1
RPS2:
v_mfma_f32_32x32x16_bf16 a[16:31], a[132:135], v[172:175], a[16:31]
ds_read_b64_tr_b16 a[152:153], v17 offset:24576
ds_read_b64_tr_b16 a[154:155], v17 offset:25088
buffer_load_dwordx4 v3, s[28:31], s42 offen offset:1024 lds
s_add_u32 s41, s41, 110592
s_add_u32 s42, s42, s43
s_cmp_ge_u32 s41, 2211840
s_cselect_b32 s41, 0, s41
s_cselect_b32 s42, 0, s42
s_waitcnt lgkmcnt(6)
v_mfma_f32_32x32x16_bf16 a[32:47], a[136:139], v[172:175], a[32:47]
ds_read_b64_tr_b16 a[156:157], v18 offset:24576
ds_read_b64_tr_b16 a[158:159], v18 offset:25088
s_cmp_eq_u32 s3, 1
s_cbranch_scc1 RPS3
s_add_u32 s81, s83, 378880
buffer_store_dwordx4 v[60:63], v23, s[20:23], s81 offen sc1
RPS3:
v_mfma_f32_32x32x16_bf16 a[48:63], a[140:143], v[172:175], a[48:63]
ds_read_b64_tr_b16 a[128:129], v12 offset:32768
ds_read_b64_tr_b16 a[130:131], v12 offset:33280
v_lshlrev_b32 v28, 16, v176
v_and_b32 v29, s49, v176
v_lshlrev_b32 v30, 16, v177
v_and_b32 v31, s49, v177
s_waitcnt lgkmcnt(6)
v_mfma_f32_32x32x16_bf16 a[64:79], a[144:147], v[172:175], a[64:79]
ds_read_b64_tr_b16 a[132:133], v12 offset:34816
ds_read_b64_tr_b16 a[134:135], v12 offset:35328
s_cmp_eq_u32 s3, 1
s_cbranch_scc1 RPS4
s_add_u32 s81, s83, 379904
buffer_store_dwordx4 v[64:67], v23, s[20:23], s81 offen sc1
RPS4:
v_mfma_f32_32x32x16_bf16 a[80:95], a[148:151], v[172:175], a[80:95]
ds_read_b64_tr_b16 a[136:137], v13 offset:32768
ds_read_b64_tr_b16 a[138:139], v13 offset:33280
v_fma_f32 v28, v28, v24, v26
v_fma_f32 v29, v29, v24, v26
v_fma_f32 v30, v30, v24, v26
v_fma_f32 v31, v31, v24, v26
s_waitcnt lgkmcnt(6)
v_mfma_f32_32x32x16_bf16 a[96:111], a[152:155], v[172:175], a[96:111]
ds_read_b64_tr_b16 a[140:141], v13 offset:34816
ds_read_b64_tr_b16 a[142:143], v13 offset:35328
s_cmp_eq_u32 s3, 1
s_cbranch_scc1 RPS5
v_lshrrev_b32 v40, 5, v1
v_and_b32 v41, 15, v1
v_lshl_add_u32 v40, v40, 4, v41
v_lshlrev_b32 v40, 4, v40
s_add_u32 s81, s83, 380928
s_mov_b32 exec_lo, 0xffff
s_mov_b32 exec_hi, 0xffff
buffer_store_dwordx4 v[68:71], v40, s[20:23], s81 offen sc1
s_mov_b64 exec, -1
RPS5:
v_mfma_f32_32x32x16_bf16 a[112:127], a[156:159], v[172:175], a[112:127]
ds_read_b64_tr_b16 a[144:145], v15 offset:32768
ds_read_b64_tr_b16 a[146:147], v15 offset:33280
v_cvt_pk_bf16_f32 v176, v28, v29
v_cvt_pk_bf16_f32 v177, v30, v31
v_lshlrev_b32 v32, 16, v178
v_and_b32 v33, s49, v178
v_lshlrev_b32 v34, 16, v179
v_and_b32 v35, s49, v179
v_fma_f32 v32, v32, v24, v26
v_fma_f32 v33, v33, v24, v26
v_fma_f32 v34, v34, v24, v26
v_fma_f32 v35, v35, v24, v26
v_cvt_pk_bf16_f32 v178, v32, v33
v_cvt_pk_bf16_f32 v179, v34, v35
s_waitcnt lgkmcnt(6)
s_nop 0
v_mfma_f32_32x32x16_bf16 a[0:15], a[128:131], v[176:179], a[0:15]
ds_read_b64_tr_b16 a[148:149], v16 offset:32768
ds_read_b64_tr_b16 a[150:151], v16 offset:33280
v_lshlrev_b32 v28, 16, v180
v_and_b32 v29, s49, v180
v_lshlrev_b32 v30, 16, v181
v_and_b32 v31, s49, v181
v_mfma_f32_32x32x16_bf16 a[16:31], a[132:135], v[176:179], a[16:31]
ds_read_b64_tr_b16 a[152:153], v17 offset:32768
ds_read_b64_tr_b16 a[154:155], v17 offset:33280
v_fma_f32 v28, v28, v24, v26
v_fma_f32 v29, v29, v24, v26
v_fma_f32 v30, v30, v24, v26
v_fma_f32 v31, v31, v24, v26
s_waitcnt lgkmcnt(6)
v_mfma_f32_32x32x16_bf16 a[32:47], a[136:139], v[176:179], a[32:47]
ds_read_b64_tr_b16 a[156:157], v18 offset:32768
ds_read_b64_tr_b16 a[158:159], v18 offset:33280
v_cvt_pk_bf16_f32 v180, v28, v29
v_cvt_pk_bf16_f32 v181, v30, v31
v_lshlrev_b32 v32, 16, v182
v_and_b32 v33, s49, v182
v_mfma_f32_32x32x16_bf16 a[48:63], a[140:143], v[176:179], a[48:63]
ds_read_b64_tr_b16 a[128:129], v12 offset:40960
ds_read_b64_tr_b16 a[130:131], v12 offset:41472
v_lshlrev_b32 v34, 16, v183
v_and_b32 v35, s49, v183
v_fma_f32 v32, v32, v24, v26
v_fma_f32 v33, v33, v24, v26
s_waitcnt lgkmcnt(6)
v_mfma_f32_32x32x16_bf16 a[64:79], a[144:147], v[176:179], a[64:79]
ds_read_b64_tr_b16 a[132:133], v12 offset:43008
ds_read_b64_tr_b16 a[134:135], v12 offset:43520
v_fma_f32 v34, v34, v24, v26
v_fma_f32 v35, v35, v24, v26
v_cvt_pk_bf16_f32 v182, v32, v33
v_cvt_pk_bf16_f32 v183, v34, v35
v_mfma_f32_32x32x16_bf16 a[80:95], a[148:151], v[176:179], a[80:95]
ds_read_b64_tr_b16 a[136:137], v13 offset:40960
ds_read_b64_tr_b16 a[138:139], v13 offset:41472
s_waitcnt lgkmcnt(6)
v_mfma_f32_32x32x16_bf16 a[96:111], a[152:155], v[176:179], a[96:111]
ds_read_b64_tr_b16 a[140:141], v13 offset:43008
ds_read_b64_tr_b16 a[142:143], v13 offset:43520
v_mfma_f32_32x32x16_bf16 a[112:127], a[156:159], v[176:179], a[112:127]
ds_read_b64_tr_b16 a[144:145], v15 offset:40960
ds_read_b64_tr_b16 a[146:147], v15 offset:41472
s_waitcnt lgkmcnt(6)
v_mfma_f32_32x32x16_bf16 a[0:15], a[128:131], v[180:183], a[0:15]
ds_read_b64_tr_b16 a[148:149], v16 offset:40960
ds_read_b64_tr_b16 a[150:151], v16 offset:41472
v_lshlrev_b32 v28, 16, v184
v_and_b32 v29, s49, v184
v_lshlrev_b32 v30, 16, v185
v_and_b32 v31, s49, v185
v_mfma_f32_32x32x16_bf16 a[16:31], a[132:135], v[180:183], a[16:31]
ds_read_b64_tr_b16 a[152:153], v17 offset:40960
ds_read_b64_tr_b16 a[154:155], v17 offset:41472
v_fma_f32 v28, v28, v24, v26
v_fma_f32 v29, v29, v24, v26
v_fma_f32 v30, v30, v24, v26
v_fma_f32 v31, v31, v24, v26
s_waitcnt lgkmcnt(6)
v_mfma_f32_32x32x16_bf16 a[32:47], a[136:139], v[180:183], a[32:47]
ds_read_b64_tr_b16 a[156:157], v18 offset:40960
ds_read_b64_tr_b16 a[158:159], v18 offset:41472
v_cvt_pk_bf16_f32 v184, v28, v29
v_cvt_pk_bf16_f32 v185, v30, v31
v_lshlrev_b32 v32, 16, v186
v_and_b32 v33, s49, v186
v_mfma_f32_32x32x16_bf16 a[48:63], a[140:143], v[180:183], a[48:63]
ds_read_b64_tr_b16 a[128:129], v12 offset:49152
ds_read_b64_tr_b16 a[130:131], v12 offset:49664
v_lshlrev_b32 v34, 16, v187
v_and_b32 v35, s49, v187
v_fma_f32 v32, v32, v24, v26
v_fma_f32 v33, v33, v24, v26
s_waitcnt lgkmcnt(6)
v_mfma_f32_32x32x16_bf16 a[64:79], a[144:147], v[180:183], a[64:79]
ds_read_b64_tr_b16 a[132:133], v12 offset:51200
ds_read_b64_tr_b16 a[134:135], v12 offset:51712
v_fma_f32 v34, v34, v24, v26
v_fma_f32 v35, v35, v24, v26
v_cvt_pk_bf16_f32 v186, v32, v33
v_cvt_pk_bf16_f32 v187, v34, v35
v_mfma_f32_32x32x16_bf16 a[80:95], a[148:151], v[180:183], a[80:95]
ds_read_b64_tr_b16 a[136:137], v13 offset:49152
ds_read_b64_tr_b16 a[138:139], v13 offset:49664
s_waitcnt lgkmcnt(6)
v_mfma_f32_32x32x16_bf16 a[96:111], a[152:155], v[180:183], a[96:111]
ds_read_b64_tr_b16 a[140:141], v13 offset:51200
ds_read_b64_tr_b16 a[142:143], v13 offset:51712
v_mfma_f32_32x32x16_bf16 a[112:127], a[156:159], v[180:183], a[112:127]
ds_read_b64_tr_b16 a[144:145], v15 offset:49152
ds_read_b64_tr_b16 a[146:147], v15 offset:49664
s_waitcnt lgkmcnt(6)
v_mfma_f32_32x32x16_bf16 a[0:15], a[128:131], v[184:187], a[0:15]
ds_read_b64_tr_b16 a[148:149], v16 offset:49152
ds_read_b64_tr_b16 a[150:151], v16 offset:49664
v_lshlrev_b32 v28, 16, v188
v_and_b32 v29, s49, v188
v_lshlrev_b32 v30, 16, v189
v_and_b32 v31, s49, v189
v_mfma_f32_32x32x16_bf16 a[16:31], a[132:135], v[184:187], a[16:31]
ds_read_b64_tr_b16 a[152:153], v17 offset:49152
ds_read_b64_tr_b16 a[154:155], v17 offset:49664
v_fma_f32 v28, v28, v24, v26
v_fma_f32 v29, v29, v24, v26
v_fma_f32 v30, v30, v24, v26
v_fma_f32 v31, v31, v24, v26
s_waitcnt lgkmcnt(6)
v_mfma_f32_32x32x16_bf16 a[32:47], a[136:139], v[184:187], a[32:47]
ds_read_b64_tr_b16 a[156:157], v18 offset:49152
ds_read_b64_tr_b16 a[158:159], v18 offset:49664
v_cvt_pk_bf16_f32 v188, v28, v29
v_cvt_pk_bf16_f32 v189, v30, v31
v_lshlrev_b32 v32, 16, v190
v_and_b32 v33, s49, v190
v_mfma_f32_32x32x16_bf16 a[48:63], a[140:143], v[184:187], a[48:63]
ds_read_b64_tr_b16 a[128:129], v12 offset:57344
ds_read_b64_tr_b16 a[130:131], v12 offset:57856
v_lshlrev_b32 v34, 16, v191
v_and_b32 v35, s49, v191
v_fma_f32 v32, v32, v24, v26
v_fma_f32 v33, v33, v24, v26
s_waitcnt lgkmcnt(6)
v_mfma_f32_32x32x16_bf16 a[64:79], a[144:147], v[184:187], a[64:79]
ds_read_b64_tr_b16 a[132:133], v12 offset:59392
ds_read_b64_tr_b16 a[134:135], v12 offset:59904
v_fma_f32 v34, v34, v24, v26
v_fma_f32 v35, v35, v24, v26
v_cvt_pk_bf16_f32 v190, v32, v33
v_cvt_pk_bf16_f32 v191, v34, v35
v_mfma_f32_32x32x16_bf16 a[80:95], a[148:151], v[184:187], a[80:95]
ds_read_b64_tr_b16 a[136:137], v13 offset:57344
ds_read_b64_tr_b16 a[138:139], v13 offset:57856
s_waitcnt lgkmcnt(6)
v_mfma_f32_32x32x16_bf16 a[96:111], a[152:155], v[184:187], a[96:111]
ds_read_b64_tr_b16 a[140:141], v13 offset:59392
ds_read_b64_tr_b16 a[142:143], v13 offset:59904
v_mfma_f32_32x32x16_bf16 a[112:127], a[156:159], v[184:187], a[112:127]
ds_read_b64_tr_b16 a[144:145], v15 offset:57344
ds_read_b64_tr_b16 a[146:147], v15 offset:57856
s_waitcnt lgkmcnt(6)
v_mfma_f32_32x32x16_bf16 a[0:15], a[128:131], v[188:191], a[0:15]
ds_read_b64_tr_b16 a[148:149], v16 offset:57344
ds_read_b64_tr_b16 a[150:151], v16 offset:57856
v_lshlrev_b32 v28, 16, v192
v_and_b32 v29, s49, v192
v_lshlrev_b32 v30, 16, v193
v_and_b32 v31, s49, v193
v_mfma_f32_32x32x16_bf16 a[16:31], a[132:135], v[188:191], a[16:31]
ds_read_b64_tr_b16 a[152:153], v17 offset:57344
ds_read_b64_tr_b16 a[154:155], v17 offset:57856
v_fma_f32 v28, v28, v24, v26
v_fma_f32 v29, v29, v24, v26
v_fma_f32 v30, v30, v24, v26
v_fma_f32 v31, v31, v24, v26
s_waitcnt lgkmcnt(6)
v_mfma_f32_32x32x16_bf16 a[32:47], a[136:139], v[188:191], a[32:47]
ds_read_b64_tr_b16 a[156:157], v18 offset:57344
ds_read_b64_tr_b16 a[158:159], v18 offset:57856
v_cvt_pk_bf16_f32 v192, v28, v29
v_cvt_pk_bf16_f32 v193, v30, v31
v_lshlrev_b32 v32, 16, v194
v_and_b32 v33, s49, v194
v_mfma_f32_32x32x16_bf16 a[48:63], a[140:143], v[188:191], a[48:63]
s_waitcnt vmcnt(0)
s_barrier
ds_read_b64_tr_b16 a[128:129], v4 offset:0
ds_read_b64_tr_b16 a[130:131], v4 offset:512
s_add_u32 m0, s47, 0
s_nop 0
buffer_load_dwordx4 v19, s[12:15], s41 offen offset:0 lds
v_lshlrev_b32 v34, 16, v195
v_and_b32 v35, s49, v195
s_waitcnt lgkmcnt(6)
v_mfma_f32_32x32x16_bf16 a[64:79], a[144:147], v[188:191], a[64:79]
ds_read_b64_tr_b16 a[132:133], v4 offset:2048
ds_read_b64_tr_b16 a[134:135], v4 offset:2560
v_fma_f32 v32, v32, v24, v26
v_fma_f32 v33, v33, v24, v26
v_fma_f32 v34, v34, v24, v26
v_fma_f32 v35, v35, v24, v26
v_mfma_f32_32x32x16_bf16 a[80:95], a[148:151], v[188:191], a[80:95]
ds_read_b64_tr_b16 a[136:137], v5 offset:0
ds_read_b64_tr_b16 a[138:139], v5 offset:512
buffer_load_dwordx4 v20, s[24:27], s41 offen offset:1024 lds
s_add_u32 m0, s47, 2048
v_cvt_pk_bf16_f32 v194, v32, v33
v_cvt_pk_bf16_f32 v195, v34, v35
s_waitcnt lgkmcnt(6)
v_mfma_f32_32x32x16_bf16 a[96:111], a[152:155], v[188:191], a[96:111]
ds_read_b64_tr_b16 a[140:141], v5 offset:2048
ds_read_b64_tr_b16 a[142:143], v5 offset:2560
v_mfma_f32_32x32x16_bf16 a[112:127], a[156:159], v[188:191], a[112:127]
ds_read_b64_tr_b16 a[144:145], v7 offset:0
ds_read_b64_tr_b16 a[146:147], v7 offset:512
buffer_load_dwordx4 v2, s[28:31], s42 offen offset:0 lds
s_waitcnt lgkmcnt(6)
v_mfma_f32_32x32x16_bf16 a[0:15], a[128:131], v[192:195], a[0:15]
ds_read_b64_tr_b16 a[148:149], v8 offset:0
ds_read_b64_tr_b16 a[150:151], v8 offset:512
v_lshlrev_b32 v28, 16, v196
v_and_b32 v29, s49, v196
v_lshlrev_b32 v30, 16, v197
v_and_b32 v31, s49, v197
v_mfma_f32_32x32x16_bf16 a[16:31], a[132:135], v[192:195], a[16:31]
ds_read_b64_tr_b16 a[152:153], v9 offset:0
ds_read_b64_tr_b16 a[154:155], v9 offset:512
buffer_load_dwordx4 v3, s[28:31], s42 offen offset:1024 lds
s_add_u32 s41, s41, 110592
s_add_u32 s42, s42, s43
s_add_u32 m0, s47, 16384
s_waitcnt lgkmcnt(6)
v_mfma_f32_32x32x16_bf16 a[32:47], a[136:139], v[192:195], a[32:47]
ds_read_b64_tr_b16 a[156:157], v10 offset:0
ds_read_b64_tr_b16 a[158:159], v10 offset:512
v_fma_f32 v28, v28, v24, v26
v_fma_f32 v29, v29, v24, v26
v_fma_f32 v30, v30, v24, v26
v_fma_f32 v31, v31, v24, v26
v_mfma_f32_32x32x16_bf16 a[48:63], a[140:143], v[192:195], a[48:63]
ds_read_b64_tr_b16 a[128:129], v4 offset:8192
ds_read_b64_tr_b16 a[130:131], v4 offset:8704
buffer_load_dwordx4 v19, s[12:15], s41 offen offset:0 lds
v_cvt_pk_bf16_f32 v196, v28, v29
v_cvt_pk_bf16_f32 v197, v30, v31
v_lshlrev_b32 v32, 16, v198
s_waitcnt lgkmcnt(6)
v_mfma_f32_32x32x16_bf16 a[64:79], a[144:147], v[192:195], a[64:79]
ds_read_b64_tr_b16 a[132:133], v4 offset:10240
ds_read_b64_tr_b16 a[134:135], v4 offset:10752
v_and_b32 v33, s49, v198
v_lshlrev_b32 v34, 16, v199
v_and_b32 v35, s49, v199
v_fma_f32 v32, v32, v24, v26
v_mfma_f32_32x32x16_bf16 a[80:95], a[148:151], v[192:195], a[80:95]
ds_read_b64_tr_b16 a[136:137], v5 offset:8192
ds_read_b64_tr_b16 a[138:139], v5 offset:8704
buffer_load_dwordx4 v20, s[24:27], s41 offen offset:1024 lds
s_add_u32 m0, s47, 18432
v_fma_f32 v33, v33, v24, v26
v_fma_f32 v34, v34, v24, v26
s_waitcnt lgkmcnt(6)
v_mfma_f32_32x32x16_bf16 a[96:111], a[152:155], v[192:195], a[96:111]
ds_read_b64_tr_b16 a[140:141], v5 offset:10240
ds_read_b64_tr_b16 a[142:143], v5 offset:10752
v_fma_f32 v35, v35, v24, v26
v_cvt_pk_bf16_f32 v198, v32, v33
v_cvt_pk_bf16_f32 v199, v34, v35
v_mfma_f32_32x32x16_bf16 a[112:127], a[156:159], v[192:195], a[112:127]
ds_read_b64_tr_b16 a[144:145], v7 offset:8192
ds_read_b64_tr_b16 a[146:147], v7 offset:8704
buffer_load_dwordx4 v2, s[28:31], s42 offen offset:0 lds
s_waitcnt lgkmcnt(6)
v_mfma_f32_32x32x16_bf16 a[0:15], a[128:131], v[196:199], a[0:15]
ds_read_b64_tr_b16 a[148:149], v8 offset:8192
ds_read_b64_tr_b16 a[150:151], v8 offset:8704
v_lshlrev_b32 v28, 16, v200
v_and_b32 v29, s49, v200
v_lshlrev_b32 v30, 16, v201
v_and_b32 v31, s49, v201
v_mfma_f32_32x32x16_bf16 a[16:31], a[132:135], v[196:199], a[16:31]
ds_read_b64_tr_b16 a[152:153], v9 offset:8192
ds_read_b64_tr_b16 a[154:155], v9 offset:8704
buffer_load_dwordx4 v3, s[28:31], s42 offen offset:1024 lds
s_add_u32 s41, s41, 110592
s_add_u32 s42, s42, s43
s_cmp_ge_u32 s41, 2211840
s_cselect_b32 s41, 0, s41
s_cselect_b32 s42, 0, s42
s_add_u32 m0, s47, 32768
s_waitcnt lgkmcnt(6)
v_mfma_f32_32x32x16_bf16 a[32:47], a[136:139], v[196:199], a[32:47]
ds_read_b64_tr_b16 a[156:157], v10 offset:8192
ds_read_b64_tr_b16 a[158:159], v10 offset:8704
v_fma_f32 v28, v28, v24, v26
v_fma_f32 v29, v29, v24, v26
v_fma_f32 v30, v30, v24, v26
v_fma_f32 v31, v31, v24, v26
v_mfma_f32_32x32x16_bf16 a[48:63], a[140:143], v[196:199], a[48:63]
ds_read_b64_tr_b16 a[128:129], v4 offset:16384
ds_read_b64_tr_b16 a[130:131], v4 offset:16896
buffer_load_dwordx4 v19, s[12:15], s41 offen offset:0 lds
v_cvt_pk_bf16_f32 v200, v28, v29
v_cvt_pk_bf16_f32 v201, v30, v31
v_lshlrev_b32 v32, 16, v202
s_waitcnt lgkmcnt(6)
v_mfma_f32_32x32x16_bf16 a[64:79], a[144:147], v[196:199], a[64:79]
ds_read_b64_tr_b16 a[132:133], v4 offset:18432
ds_read_b64_tr_b16 a[134:135], v4 offset:18944
v_and_b32 v33, s49, v202
v_lshlrev_b32 v34, 16, v203
v_and_b32 v35, s49, v203
v_fma_f32 v32, v32, v24, v26
v_mfma_f32_32x32x16_bf16 a[80:95], a[148:151], v[196:199], a[80:95]
ds_read_b64_tr_b16 a[136:137], v5 offset:16384
ds_read_b64_tr_b16 a[138:139], v5 offset:16896
buffer_load_dwordx4 v20, s[24:27], s41 offen offset:1024 lds
s_add_u32 m0, s47, 34816
v_fma_f32 v33, v33, v24, v26
v_fma_f32 v34, v34, v24, v26
s_waitcnt lgkmcnt(6)
v_mfma_f32_32x32x16_bf16 a[96:111], a[152:155], v[196:199], a[96:111]
ds_read_b64_tr_b16 a[140:141], v5 offset:18432
ds_read_b64_tr_b16 a[142:143], v5 offset:18944
v_fma_f32 v35, v35, v24, v26
v_cvt_pk_bf16_f32 v202, v32, v33
v_cvt_pk_bf16_f32 v203, v34, v35
v_mfma_f32_32x32x16_bf16 a[112:127], a[156:159], v[196:199], a[112:127]
ds_read_b64_tr_b16 a[144:145], v7 offset:16384
ds_read_b64_tr_b16 a[146:147], v7 offset:16896
buffer_load_dwordx4 v2, s[28:31], s42 offen offset:0 lds
s_waitcnt lgkmcnt(6)
v_mfma_f32_32x32x16_bf16 a[0:15], a[128:131], v[200:203], a[0:15]
ds_read_b64_tr_b16 a[148:149], v8 offset:16384
ds_read_b64_tr_b16 a[150:151], v8 offset:16896
v_lshlrev_b32 v28, 16, v204
v_and_b32 v29, s49, v204
v_lshlrev_b32 v30, 16, v205
v_and_b32 v31, s49, v205
v_mfma_f32_32x32x16_bf16 a[16:31], a[132:135], v[200:203], a[16:31]
ds_read_b64_tr_b16 a[152:153], v9 offset:16384
ds_read_b64_tr_b16 a[154:155], v9 offset:16896
buffer_load_dwordx4 v3, s[28:31], s42 offen offset:1024 lds
s_add_u32 s41, s41, 110592
s_add_u32 s42, s42, s43
s_add_u32 m0, s47, 49152
s_waitcnt lgkmcnt(6)
v_mfma_f32_32x32x16_bf16 a[32:47], a[136:139], v[200:203], a[32:47]
ds_read_b64_tr_b16 a[156:157], v10 offset:16384
ds_read_b64_tr_b16 a[158:159], v10 offset:16896
v_fma_f32 v28, v28, v24, v26
v_fma_f32 v29, v29, v24, v26
v_fma_f32 v30, v30, v24, v26
v_fma_f32 v31, v31, v24, v26
v_mfma_f32_32x32x16_bf16 a[48:63], a[140:143], v[200:203], a[48:63]
ds_read_b64_tr_b16 a[128:129], v4 offset:24576
ds_read_b64_tr_b16 a[130:131], v4 offset:25088
buffer_load_dwordx4 v19, s[12:15], s41 offen offset:0 lds
v_cvt_pk_bf16_f32 v204, v28, v29
v_cvt_pk_bf16_f32 v205, v30, v31
v_lshlrev_b32 v32, 16, v206
s_waitcnt lgkmcnt(6)
v_mfma_f32_32x32x16_bf16 a[64:79], a[144:147], v[200:203], a[64:79]
ds_read_b64_tr_b16 a[132:133], v4 offset:26624
ds_read_b64_tr_b16 a[134:135], v4 offset:27136
v_and_b32 v33, s49, v206
v_lshlrev_b32 v34, 16, v207
v_and_b32 v35, s49, v207
v_fma_f32 v32, v32, v24, v26
v_mfma_f32_32x32x16_bf16 a[80:95], a[148:151], v[200:203], a[80:95]
ds_read_b64_tr_b16 a[136:137], v5 offset:24576
ds_read_b64_tr_b16 a[138:139], v5 offset:25088
buffer_load_dwordx4 v20, s[24:27], s41 offen offset:1024 lds
s_add_u32 m0, s47, 51200
v_fma_f32 v33, v33, v24, v26
v_fma_f32 v34, v34, v24, v26
s_waitcnt lgkmcnt(6)
v_mfma_f32_32x32x16_bf16 a[96:111], a[152:155], v[200:203], a[96:111]
ds_read_b64_tr_b16 a[140:141], v5 offset:26624
ds_read_b64_tr_b16 a[142:143], v5 offset:27136
v_fma_f32 v35, v35, v24, v26
v_cvt_pk_bf16_f32 v206, v32, v33
v_cvt_pk_bf16_f32 v207, v34, v35
v_mfma_f32_32x32x16_bf16 a[112:127], a[156:159], v[200:203], a[112:127]
ds_read_b64_tr_b16 a[144:145], v7 offset:24576
ds_read_b64_tr_b16 a[146:147], v7 offset:25088
buffer_load_dwordx4 v2, s[28:31], s42 offen offset:0 lds
s_waitcnt lgkmcnt(6)
v_mfma_f32_32x32x16_bf16 a[0:15], a[128:131], v[204:207], a[0:15]
ds_read_b64_tr_b16 a[148:149], v8 offset:24576
ds_read_b64_tr_b16 a[150:151], v8 offset:25088
v_lshlrev_b32 v28, 16, v208
v_and_b32 v29, s49, v208
v_lshlrev_b32 v30, 16, v209
v_and_b32 v31, s49, v209
v_mfma_f32_32x32x16_bf16 a[16:31], a[132:135], v[204:207], a[16:31]
ds_read_b64_tr_b16 a[152:153], v9 offset:24576
ds_read_b64_tr_b16 a[154:155], v9 offset:25088
buffer_load_dwordx4 v3, s[28:31], s42 offen offset:1024 lds
s_add_u32 s41, s41, 110592
s_add_u32 s42, s42, s43
s_cmp_ge_u32 s41, 2211840
s_cselect_b32 s41, 0, s41
s_cselect_b32 s42, 0, s42
s_waitcnt lgkmcnt(6)
v_mfma_f32_32x32x16_bf16 a[32:47], a[136:139], v[204:207], a[32:47]
ds_read_b64_tr_b16 a[156:157], v10 offset:24576
ds_read_b64_tr_b16 a[158:159], v10 offset:25088
v_fma_f32 v28, v28, v24, v26
v_fma_f32 v29, v29, v24, v26
v_fma_f32 v30, v30, v24, v26
v_fma_f32 v31, v31, v24, v26
v_mfma_f32_32x32x16_bf16 a[48:63], a[140:143], v[204:207], a[48:63]
ds_read_b64_tr_b16 a[128:129], v4 offset:32768
ds_read_b64_tr_b16 a[130:131], v4 offset:33280
v_cvt_pk_bf16_f32 v208, v28, v29
v_cvt_pk_bf16_f32 v209, v30, v31
v_lshlrev_b32 v32, 16, v210
v_and_b32 v33, s49, v210
s_waitcnt lgkmcnt(6)
v_mfma_f32_32x32x16_bf16 a[64:79], a[144:147], v[204:207], a[64:79]
ds_read_b64_tr_b16 a[132:133], v4 offset:34816
ds_read_b64_tr_b16 a[134:135], v4 offset:35328
v_lshlrev_b32 v34, 16, v211
v_and_b32 v35, s49, v211
v_fma_f32 v32, v32, v24, v26
v_fma_f32 v33, v33, v24, v26
v_mfma_f32_32x32x16_bf16 a[80:95], a[148:151], v[204:207], a[80:95]
ds_read_b64_tr_b16 a[136:137], v5 offset:32768
ds_read_b64_tr_b16 a[138:139], v5 offset:33280
v_fma_f32 v34, v34, v24, v26
v_fma_f32 v35, v35, v24, v26
v_cvt_pk_bf16_f32 v210, v32, v33
v_cvt_pk_bf16_f32 v211, v34, v35
s_waitcnt lgkmcnt(6)
v_mfma_f32_32x32x16_bf16 a[96:111], a[152:155], v[204:207], a[96:111]
ds_read_b64_tr_b16 a[140:141], v5 offset:34816
ds_read_b64_tr_b16 a[142:143], v5 offset:35328
v_mfma_f32_32x32x16_bf16 a[112:127], a[156:159], v[204:207], a[112:127]
ds_read_b64_tr_b16 a[144:145], v7 offset:32768
ds_read_b64_tr_b16 a[146:147], v7 offset:33280
s_waitcnt lgkmcnt(6)
v_mfma_f32_32x32x16_bf16 a[0:15], a[128:131], v[208:211], a[0:15]
ds_read_b64_tr_b16 a[148:149], v8 offset:32768
ds_read_b64_tr_b16 a[150:151], v8 offset:33280
v_lshlrev_b32 v28, 16, v212
v_and_b32 v29, s49, v212
v_lshlrev_b32 v30, 16, v213
v_and_b32 v31, s49, v213
v_mfma_f32_32x32x16_bf16 a[16:31], a[132:135], v[208:211], a[16:31]
ds_read_b64_tr_b16 a[152:153], v9 offset:32768
ds_read_b64_tr_b16 a[154:155], v9 offset:33280
v_fma_f32 v28, v28, v24, v26
v_fma_f32 v29, v29, v24, v26
v_fma_f32 v30, v30, v24, v26
v_fma_f32 v31, v31, v24, v26
s_waitcnt lgkmcnt(6)
v_mfma_f32_32x32x16_bf16 a[32:47], a[136:139], v[208:211], a[32:47]
ds_read_b64_tr_b16 a[156:157], v10 offset:32768
ds_read_b64_tr_b16 a[158:159], v10 offset:33280
v_cvt_pk_bf16_f32 v212, v28, v29
v_cvt_pk_bf16_f32 v213, v30, v31
v_lshlrev_b32 v32, 16, v214
v_and_b32 v33, s49, v214
v_mfma_f32_32x32x16_bf16 a[48:63], a[140:143], v[208:211], a[48:63]
ds_read_b64_tr_b16 a[128:129], v4 offset:40960
ds_read_b64_tr_b16 a[130:131], v4 offset:41472
v_lshlrev_b32 v34, 16, v215
v_and_b32 v35, s49, v215
v_fma_f32 v32, v32, v24, v26
v_fma_f32 v33, v33, v24, v26
s_waitcnt lgkmcnt(6)
v_mfma_f32_32x32x16_bf16 a[64:79], a[144:147], v[208:211], a[64:79]
ds_read_b64_tr_b16 a[132:133], v4 offset:43008
ds_read_b64_tr_b16 a[134:135], v4 offset:43520
v_fma_f32 v34, v34, v24, v26
v_fma_f32 v35, v35, v24, v26
v_cvt_pk_bf16_f32 v214, v32, v33
v_cvt_pk_bf16_f32 v215, v34, v35
v_mfma_f32_32x32x16_bf16 a[80:95], a[148:151], v[208:211], a[80:95]
ds_read_b64_tr_b16 a[136:137], v5 offset:40960
ds_read_b64_tr_b16 a[138:139], v5 offset:41472
s_waitcnt lgkmcnt(6)
v_mfma_f32_32x32x16_bf16 a[96:111], a[152:155], v[208:211], a[96:111]
ds_read_b64_tr_b16 a[140:141], v5 offset:43008
ds_read_b64_tr_b16 a[142:143], v5 offset:43520
v_mfma_f32_32x32x16_bf16 a[112:127], a[156:159], v[208:211], a[112:127]
ds_read_b64_tr_b16 a[144:145], v7 offset:40960
ds_read_b64_tr_b16 a[146:147], v7 offset:41472
s_waitcnt lgkmcnt(6)
v_mfma_f32_32x32x16_bf16 a[0:15], a[128:131], v[212:215], a[0:15]
ds_read_b64_tr_b16 a[148:149], v8 offset:40960
ds_read_b64_tr_b16 a[150:151], v8 offset:41472
v_lshlrev_b32 v28, 16, v216
v_and_b32 v29, s49, v216
v_lshlrev_b32 v30, 16, v217
v_and_b32 v31, s49, v217
v_mfma_f32_32x32x16_bf16 a[16:31], a[132:135], v[212:215], a[16:31]
ds_read_b64_tr_b16 a[152:153], v9 offset:40960
ds_read_b64_tr_b16 a[154:155], v9 offset:41472
v_fma_f32 v28, v28, v24, v26
v_fma_f32 v29, v29, v24, v26
v_fma_f32 v30, v30, v24, v26
v_fma_f32 v31, v31, v24, v26
s_waitcnt lgkmcnt(6)
v_mfma_f32_32x32x16_bf16 a[32:47], a[136:139], v[212:215], a[32:47]
ds_read_b64_tr_b16 a[156:157], v10 offset:40960
ds_read_b64_tr_b16 a[158:159], v10 offset:41472
v_cvt_pk_bf16_f32 v216, v28, v29
v_cvt_pk_bf16_f32 v217, v30, v31
v_lshlrev_b32 v32, 16, v218
v_and_b32 v33, s49, v218
v_mfma_f32_32x32x16_bf16 a[48:63], a[140:143], v[212:215], a[48:63]
ds_read_b64_tr_b16 a[128:129], v4 offset:49152
ds_read_b64_tr_b16 a[130:131], v4 offset:49664
v_lshlrev_b32 v34, 16, v219
v_and_b32 v35, s49, v219
v_fma_f32 v32, v32, v24, v26
v_fma_f32 v33, v33, v24, v26
s_waitcnt lgkmcnt(6)
v_mfma_f32_32x32x16_bf16 a[64:79], a[144:147], v[212:215], a[64:79]
ds_read_b64_tr_b16 a[132:133], v4 offset:51200
ds_read_b64_tr_b16 a[134:135], v4 offset:51712
v_fma_f32 v34, v34, v24, v26
v_fma_f32 v35, v35, v24, v26
v_cvt_pk_bf16_f32 v218, v32, v33
v_cvt_pk_bf16_f32 v219, v34, v35
v_mfma_f32_32x32x16_bf16 a[80:95], a[148:151], v[212:215], a[80:95]
ds_read_b64_tr_b16 a[136:137], v5 offset:49152
ds_read_b64_tr_b16 a[138:139], v5 offset:49664
s_waitcnt lgkmcnt(6)
v_mfma_f32_32x32x16_bf16 a[96:111], a[152:155], v[212:215], a[96:111]
ds_read_b64_tr_b16 a[140:141], v5 offset:51200
ds_read_b64_tr_b16 a[142:143], v5 offset:51712
v_mfma_f32_32x32x16_bf16 a[112:127], a[156:159], v[212:215], a[112:127]
ds_read_b64_tr_b16 a[144:145], v7 offset:49152
ds_read_b64_tr_b16 a[146:147], v7 offset:49664
s_waitcnt lgkmcnt(6)
v_mfma_f32_32x32x16_bf16 a[0:15], a[128:131], v[216:219], a[0:15]
ds_read_b64_tr_b16 a[148:149], v8 offset:49152
ds_read_b64_tr_b16 a[150:151], v8 offset:49664
v_lshlrev_b32 v28, 16, v220
v_and_b32 v29, s49, v220
v_lshlrev_b32 v30, 16, v221
v_and_b32 v31, s49, v221
v_mfma_f32_32x32x16_bf16 a[16:31], a[132:135], v[216:219], a[16:31]
ds_read_b64_tr_b16 a[152:153], v9 offset:49152
ds_read_b64_tr_b16 a[154:155], v9 offset:49664
v_fma_f32 v28, v28, v24, v26
v_fma_f32 v29, v29, v24, v26
v_fma_f32 v30, v30, v24, v26
v_fma_f32 v31, v31, v24, v26
s_waitcnt lgkmcnt(6)
v_mfma_f32_32x32x16_bf16 a[32:47], a[136:139], v[216:219], a[32:47]
ds_read_b64_tr_b16 a[156:157], v10 offset:49152
ds_read_b64_tr_b16 a[158:159], v10 offset:49664
v_cvt_pk_bf16_f32 v220, v28, v29
v_cvt_pk_bf16_f32 v221, v30, v31
v_lshlrev_b32 v32, 16, v222
v_and_b32 v33, s49, v222
v_mfma_f32_32x32x16_bf16 a[48:63], a[140:143], v[216:219], a[48:63]
ds_read_b64_tr_b16 a[128:129], v4 offset:57344
ds_read_b64_tr_b16 a[130:131], v4 offset:57856
v_lshlrev_b32 v34, 16, v223
v_and_b32 v35, s49, v223
v_fma_f32 v32, v32, v24, v26
v_fma_f32 v33, v33, v24, v26
s_waitcnt lgkmcnt(6)
v_mfma_f32_32x32x16_bf16 a[64:79], a[144:147], v[216:219], a[64:79]
ds_read_b64_tr_b16 a[132:133], v4 offset:59392
ds_read_b64_tr_b16 a[134:135], v4 offset:59904
v_fma_f32 v34, v34, v24, v26
v_fma_f32 v35, v35, v24, v26
v_cvt_pk_bf16_f32 v222, v32, v33
v_cvt_pk_bf16_f32 v223, v34, v35
v_mfma_f32_32x32x16_bf16 a[80:95], a[148:151], v[216:219], a[80:95]
ds_read_b64_tr_b16 a[136:137], v5 offset:57344
ds_read_b64_tr_b16 a[138:139], v5 offset:57856
s_waitcnt lgkmcnt(6)
v_mfma_f32_32x32x16_bf16 a[96:111], a[152:155], v[216:219], a[96:111]
ds_read_b64_tr_b16 a[140:141], v5 offset:59392
ds_read_b64_tr_b16 a[142:143], v5 offset:59904
v_mfma_f32_32x32x16_bf16 a[112:127], a[156:159], v[216:219], a[112:127]
ds_read_b64_tr_b16 a[144:145], v7 offset:57344
ds_read_b64_tr_b16 a[146:147], v7 offset:57856
s_waitcnt lgkmcnt(6)
v_mfma_f32_32x32x16_bf16 a[0:15], a[128:131], v[220:223], a[0:15]
ds_read_b64_tr_b16 a[148:149], v8 offset:57344
ds_read_b64_tr_b16 a[150:151], v8 offset:57856
v_lshlrev_b32 v28, 16, v224
v_and_b32 v29, s49, v224
v_lshlrev_b32 v30, 16, v225
v_and_b32 v31, s49, v225
v_mfma_f32_32x32x16_bf16 a[16:31], a[132:135], v[220:223], a[16:31]
ds_read_b64_tr_b16 a[152:153], v9 offset:57344
ds_read_b64_tr_b16 a[154:155], v9 offset:57856
v_fma_f32 v28, v28, v24, v26
v_fma_f32 v29, v29, v24, v26
v_fma_f32 v30, v30, v24, v26
v_fma_f32 v31, v31, v24, v26
s_waitcnt lgkmcnt(6)
v_mfma_f32_32x32x16_bf16 a[32:47], a[136:139], v[220:223], a[32:47]
ds_read_b64_tr_b16 a[156:157], v10 offset:57344
ds_read_b64_tr_b16 a[158:159], v10 offset:57856
v_cvt_pk_bf16_f32 v224, v28, v29
v_cvt_pk_bf16_f32 v225, v30, v31
v_lshlrev_b32 v32, 16, v226
v_and_b32 v33, s49, v226
v_mfma_f32_32x32x16_bf16 a[48:63], a[140:143], v[220:223], a[48:63]
s_waitcnt vmcnt(0)
s_barrier
ds_read_b64_tr_b16 a[128:129], v12 offset:0
ds_read_b64_tr_b16 a[130:131], v12 offset:512
v_add_u32 v19, s44, v21
s_add_u32 s52, s44, 29696
v_add_u32 v20, s52, v21
v_add_u32 v2, s45, v22
s_add_u32 m0, s48, 65536
s_nop 0
buffer_load_dwordx4 v19, s[8:11], s46 offen lds
s_waitcnt lgkmcnt(6)
v_mfma_f32_32x32x16_bf16 a[64:79], a[144:147], v[220:223], a[64:79]
ds_read_b64_tr_b16 a[132:133], v12 offset:2048
ds_read_b64_tr_b16 a[134:135], v12 offset:2560
v_lshlrev_b32 v34, 16, v227
v_and_b32 v35, s49, v227
v_fma_f32 v32, v32, v24, v26
v_fma_f32 v33, v33, v24, v26
v_mfma_f32_32x32x16_bf16 a[80:95], a[148:151], v[220:223], a[80:95]
ds_read_b64_tr_b16 a[136:137], v13 offset:0
ds_read_b64_tr_b16 a[138:139], v13 offset:512
buffer_load_dwordx4 v20, s[8:11], s46 offen offset:1024 lds
s_add_u32 m0, s48, 67584
v_fma_f32 v34, v34, v24, v26
v_fma_f32 v35, v35, v24, v26
s_waitcnt lgkmcnt(6)
v_mfma_f32_32x32x16_bf16 a[96:111], a[152:155], v[220:223], a[96:111]
ds_read_b64_tr_b16 a[140:141], v13 offset:2048
ds_read_b64_tr_b16 a[142:143], v13 offset:2560
v_cvt_pk_bf16_f32 v226, v32, v33
v_cvt_pk_bf16_f32 v227, v34, v35
v_mfma_f32_32x32x16_bf16 a[112:127], a[156:159], v[220:223], a[112:127]
ds_read_b64_tr_b16 a[144:145], v15 offset:0
ds_read_b64_tr_b16 a[146:147], v15 offset:512
buffer_load_dwordx4 v2, s[8:11], s46 offen lds
s_add_u32 s46, s46, 61440
s_add_u32 m0, s48, 68608
s_waitcnt lgkmcnt(6)
v_mfma_f32_32x32x16_bf16 a[0:15], a[128:131], v[224:227], a[0:15]
ds_read_b64_tr_b16 a[148:149], v16 offset:0
ds_read_b64_tr_b16 a[150:151], v16 offset:512
v_lshlrev_b32 v28, 16, v228
v_and_b32 v29, s49, v228
v_lshlrev_b32 v30, 16, v229
v_and_b32 v31, s49, v229
v_mfma_f32_32x32x16_bf16 a[16:31], a[132:135], v[224:227], a[16:31]
ds_read_b64_tr_b16 a[152:153], v17 offset:0
ds_read_b64_tr_b16 a[154:155], v17 offset:512
buffer_load_dwordx4 v19, s[8:11], s46 offen lds
v_fma_f32 v28, v28, v24, v26
v_fma_f32 v29, v29, v24, v26
v_fma_f32 v30, v30, v24, v26
s_waitcnt lgkmcnt(6)
v_mfma_f32_32x32x16_bf16 a[32:47], a[136:139], v[224:227], a[32:47]
ds_read_b64_tr_b16 a[156:157], v18 offset:0
ds_read_b64_tr_b16 a[158:159], v18 offset:512
v_fma_f32 v31, v31, v24, v26
v_cvt_pk_bf16_f32 v228, v28, v29
v_cvt_pk_bf16_f32 v229, v30, v31
v_lshlrev_b32 v32, 16, v230
v_mfma_f32_32x32x16_bf16 a[48:63], a[140:143], v[224:227], a[48:63]
ds_read_b64_tr_b16 a[128:129], v12 offset:8192
ds_read_b64_tr_b16 a[130:131], v12 offset:8704
buffer_load_dwordx4 v20, s[8:11], s46 offen offset:1024 lds
s_add_u32 m0, s48, 70656
v_and_b32 v33, s49, v230
v_lshlrev_b32 v34, 16, v231
s_waitcnt lgkmcnt(6)
v_mfma_f32_32x32x16_bf16 a[64:79], a[144:147], v[224:227], a[64:79]
ds_read_b64_tr_b16 a[132:133], v12 offset:10240
ds_read_b64_tr_b16 a[134:135], v12 offset:10752
v_and_b32 v35, s49, v231
v_fma_f32 v32, v32, v24, v26
v_fma_f32 v33, v33, v24, v26
v_fma_f32 v34, v34, v24, v26
v_mfma_f32_32x32x16_bf16 a[80:95], a[148:151], v[224:227], a[80:95]
ds_read_b64_tr_b16 a[136:137], v13 offset:8192
ds_read_b64_tr_b16 a[138:139], v13 offset:8704
buffer_load_dwordx4 v2, s[8:11], s46 offen lds
s_add_u32 s46, s46, 430080
s_cmp_ge_u32 s46, 2457600
s_cselect_b32 s52, 2457600, 0
s_sub_u32 s46, s46, s52
s_add_u32 m0, s48, 98304
s_waitcnt lgkmcnt(6)
v_mfma_f32_32x32x16_bf16 a[96:111], a[152:155], v[224:227], a[96:111]
ds_read_b64_tr_b16 a[140:141], v13 offset:10240
ds_read_b64_tr_b16 a[142:143], v13 offset:10752
v_fma_f32 v35, v35, v24, v26
v_cvt_pk_bf16_f32 v230, v32, v33
v_cvt_pk_bf16_f32 v231, v34, v35
v_mfma_f32_32x32x16_bf16 a[112:127], a[156:159], v[224:227], a[112:127]
ds_read_b64_tr_b16 a[144:145], v15 offset:8192
ds_read_b64_tr_b16 a[146:147], v15 offset:8704
buffer_load_dwordx4 v19, s[8:11], s46 offen lds
s_waitcnt lgkmcnt(6)
v_mfma_f32_32x32x16_bf16 a[0:15], a[128:131], v[228:231], a[0:15]
ds_read_b64_tr_b16 a[148:149], v16 offset:8192
ds_read_b64_tr_b16 a[150:151], v16 offset:8704
v_lshlrev_b32 v28, 16, v232
v_and_b32 v29, s49, v232
v_lshlrev_b32 v30, 16, v233
v_and_b32 v31, s49, v233
v_mfma_f32_32x32x16_bf16 a[16:31], a[132:135], v[228:231], a[16:31]
ds_read_b64_tr_b16 a[152:153], v17 offset:8192
ds_read_b64_tr_b16 a[154:155], v17 offset:8704
buffer_load_dwordx4 v20, s[8:11], s46 offen offset:1024 lds
s_add_u32 m0, s48, 100352
v_fma_f32 v28, v28, v24, v26
v_fma_f32 v29, v29, v24, v26
s_waitcnt lgkmcnt(6)
v_mfma_f32_32x32x16_bf16 a[32:47], a[136:139], v[228:231], a[32:47]
ds_read_b64_tr_b16 a[156:157], v18 offset:8192
ds_read_b64_tr_b16 a[158:159], v18 offset:8704
v_fma_f32 v30, v30, v24, v26
v_fma_f32 v31, v31, v24, v26
v_cvt_pk_bf16_f32 v232, v28, v29
v_cvt_pk_bf16_f32 v233, v30, v31
v_mfma_f32_32x32x16_bf16 a[48:63], a[140:143], v[228:231], a[48:63]
ds_read_b64_tr_b16 a[128:129], v12 offset:16384
ds_read_b64_tr_b16 a[130:131], v12 offset:16896
buffer_load_dwordx4 v2, s[8:11], s46 offen lds
s_add_u32 s46, s46, 61440
s_add_u32 m0, s48, 101376
v_lshlrev_b32 v32, 16, v234
s_waitcnt lgkmcnt(6)
v_mfma_f32_32x32x16_bf16 a[64:79], a[144:147], v[228:231], a[64:79]
ds_read_b64_tr_b16 a[132:133], v12 offset:18432
ds_read_b64_tr_b16 a[134:135], v12 offset:18944
v_and_b32 v33, s49, v234
v_lshlrev_b32 v34, 16, v235
v_and_b32 v35, s49, v235
v_fma_f32 v32, v32, v24, v26
v_mfma_f32_32x32x16_bf16 a[80:95], a[148:151], v[228:231], a[80:95]
ds_read_b64_tr_b16 a[136:137], v13 offset:16384
ds_read_b64_tr_b16 a[138:139], v13 offset:16896
buffer_load_dwordx4 v19, s[8:11], s46 offen lds
v_fma_f32 v33, v33, v24, v26
v_fma_f32 v34, v34, v24, v26
v_fma_f32 v35, v35, v24, v26
s_waitcnt lgkmcnt(6)
v_mfma_f32_32x32x16_bf16 a[96:111], a[152:155], v[228:231], a[96:111]
ds_read_b64_tr_b16 a[140:141], v13 offset:18432
ds_read_b64_tr_b16 a[142:143], v13 offset:18944
v_cvt_pk_bf16_f32 v234, v32, v33
v_cvt_pk_bf16_f32 v235, v34, v35
v_mfma_f32_32x32x16_bf16 a[112:127], a[156:159], v[228:231], a[112:127]
ds_read_b64_tr_b16 a[144:145], v15 offset:16384
ds_read_b64_tr_b16 a[146:147], v15 offset:16896
buffer_load_dwordx4 v20, s[8:11], s46 offen offset:1024 lds
s_add_u32 m0, s48, 103424
s_waitcnt lgkmcnt(6)
v_mfma_f32_32x32x16_bf16 a[0:15], a[128:131], v[232:235], a[0:15]
ds_read_b64_tr_b16 a[148:149], v16 offset:16384
ds_read_b64_tr_b16 a[150:151], v16 offset:16896
v_lshlrev_b32 v28, 16, v236
v_and_b32 v29, s49, v236
v_lshlrev_b32 v30, 16, v237
v_and_b32 v31, s49, v237
v_mfma_f32_32x32x16_bf16 a[16:31], a[132:135], v[232:235], a[16:31]
ds_read_b64_tr_b16 a[152:153], v17 offset:16384
ds_read_b64_tr_b16 a[154:155], v17 offset:16896
buffer_load_dwordx4 v2, s[8:11], s46 offen lds
s_add_u32 s46, s46, 430080
s_cmp_ge_u32 s46, 2457600
s_cselect_b32 s52, 2457600, 0
s_sub_u32 s46, s46, s52
s_waitcnt lgkmcnt(6)
v_mfma_f32_32x32x16_bf16 a[32:47], a[136:139], v[232:235], a[32:47]
ds_read_b64_tr_b16 a[156:157], v18 offset:16384
ds_read_b64_tr_b16 a[158:159], v18 offset:16896
v_fma_f32 v28, v28, v24, v26
v_fma_f32 v29, v29, v24, v26
v_fma_f32 v30, v30, v24, v26
v_fma_f32 v31, v31, v24, v26
v_mfma_f32_32x32x16_bf16 a[48:63], a[140:143], v[232:235], a[48:63]
ds_read_b64_tr_b16 a[128:129], v12 offset:24576
ds_read_b64_tr_b16 a[130:131], v12 offset:25088
v_cvt_pk_bf16_f32 v236, v28, v29
v_cvt_pk_bf16_f32 v237, v30, v31
v_lshlrev_b32 v32, 16, v238
v_and_b32 v33, s49, v238
s_waitcnt lgkmcnt(6)
v_mfma_f32_32x32x16_bf16 a[64:79], a[144:147], v[232:235], a[64:79]
ds_read_b64_tr_b16 a[132:133], v12 offset:26624
ds_read_b64_tr_b16 a[134:135], v12 offset:27136
v_lshlrev_b32 v34, 16, v239
v_and_b32 v35, s49, v239
v_fma_f32 v32, v32, v24, v26
v_fma_f32 v33, v33, v24, v26
v_mfma_f32_32x32x16_bf16 a[80:95], a[148:151], v[232:235], a[80:95]
ds_read_b64_tr_b16 a[136:137], v13 offset:24576
ds_read_b64_tr_b16 a[138:139], v13 offset:25088
v_fma_f32 v34, v34, v24, v26
v_fma_f32 v35, v35, v24, v26
v_cvt_pk_bf16_f32 v238, v32, v33
v_cvt_pk_bf16_f32 v239, v34, v35
s_waitcnt lgkmcnt(6)
v_mfma_f32_32x32x16_bf16 a[96:111], a[152:155], v[232:235], a[96:111]
ds_read_b64_tr_b16 a[140:141], v13 offset:26624
ds_read_b64_tr_b16 a[142:143], v13 offset:27136
v_mfma_f32_32x32x16_bf16 a[112:127], a[156:159], v[232:235], a[112:127]
ds_read_b64_tr_b16 a[144:145], v15 offset:24576
ds_read_b64_tr_b16 a[146:147], v15 offset:25088
s_waitcnt lgkmcnt(6)
v_mfma_f32_32x32x16_bf16 a[0:15], a[128:131], v[236:239], a[0:15]
ds_read_b64_tr_b16 a[148:149], v16 offset:24576
ds_read_b64_tr_b16 a[150:151], v16 offset:25088
v_lshlrev_b32 v28, 16, v240
v_and_b32 v29, s49, v240
v_lshlrev_b32 v30, 16, v241
v_and_b32 v31, s49, v241
v_mfma_f32_32x32x16_bf16 a[16:31], a[132:135], v[236:239], a[16:31]
ds_read_b64_tr_b16 a[152:153], v17 offset:24576
ds_read_b64_tr_b16 a[154:155], v17 offset:25088
v_fma_f32 v28, v28, v24, v26
v_fma_f32 v29, v29, v24, v26
v_fma_f32 v30, v30, v24, v26
v_fma_f32 v31, v31, v24, v26
s_waitcnt lgkmcnt(6)
v_mfma_f32_32x32x16_bf16 a[32:47], a[136:139], v[236:239], a[32:47]
ds_read_b64_tr_b16 a[156:157], v18 offset:24576
ds_read_b64_tr_b16 a[158:159], v18 offset:25088
v_cvt_pk_bf16_f32 v240, v28, v29
v_cvt_pk_bf16_f32 v241, v30, v31
v_lshlrev_b32 v32, 16, v242
v_and_b32 v33, s49, v242
v_mfma_f32_32x32x16_bf16 a[48:63], a[140:143], v[236:239], a[48:63]
ds_read_b64_tr_b16 a[128:129], v12 offset:32768
ds_read_b64_tr_b16 a[130:131], v12 offset:33280
v_lshlrev_b32 v34, 16, v243
v_and_b32 v35, s49, v243
v_fma_f32 v32, v32, v24, v26
v_fma_f32 v33, v33, v24, v26
s_waitcnt lgkmcnt(6)
v_mfma_f32_32x32x16_bf16 a[64:79], a[144:147], v[236:239], a[64:79]
ds_read_b64_tr_b16 a[132:133], v12 offset:34816
ds_read_b64_tr_b16 a[134:135], v12 offset:35328
v_fma_f32 v34, v34, v24, v26
v_fma_f32 v35, v35, v24, v26
v_cvt_pk_bf16_f32 v242, v32, v33
v_cvt_pk_bf16_f32 v243, v34, v35
v_mfma_f32_32x32x16_bf16 a[80:95], a[148:151], v[236:239], a[80:95]
ds_read_b64_tr_b16 a[136:137], v13 offset:32768
ds_read_b64_tr_b16 a[138:139], v13 offset:33280
s_waitcnt lgkmcnt(6)
v_mfma_f32_32x32x16_bf16 a[96:111], a[152:155], v[236:239], a[96:111]
ds_read_b64_tr_b16 a[140:141], v13 offset:34816
ds_read_b64_tr_b16 a[142:143], v13 offset:35328
v_mfma_f32_32x32x16_bf16 a[112:127], a[156:159], v[236:239], a[112:127]
ds_read_b64_tr_b16 a[144:145], v15 offset:32768
ds_read_b64_tr_b16 a[146:147], v15 offset:33280
s_waitcnt lgkmcnt(6)
v_mfma_f32_32x32x16_bf16 a[0:15], a[128:131], v[240:243], a[0:15]
ds_read_b64_tr_b16 a[148:149], v16 offset:32768
ds_read_b64_tr_b16 a[150:151], v16 offset:33280
v_lshlrev_b32 v28, 16, v244
v_and_b32 v29, s49, v244
v_lshlrev_b32 v30, 16, v245
v_and_b32 v31, s49, v245
v_mfma_f32_32x32x16_bf16 a[16:31], a[132:135], v[240:243], a[16:31]
ds_read_b64_tr_b16 a[152:153], v17 offset:32768
ds_read_b64_tr_b16 a[154:155], v17 offset:33280
v_fma_f32 v28, v28, v24, v26
v_fma_f32 v29, v29, v24, v26
v_fma_f32 v30, v30, v24, v26
v_fma_f32 v31, v31, v24, v26
s_waitcnt lgkmcnt(6)
v_mfma_f32_32x32x16_bf16 a[32:47], a[136:139], v[240:243], a[32:47]
ds_read_b64_tr_b16 a[156:157], v18 offset:32768
ds_read_b64_tr_b16 a[158:159], v18 offset:33280
v_cvt_pk_bf16_f32 v244, v28, v29
v_cvt_pk_bf16_f32 v245, v30, v31
v_lshlrev_b32 v32, 16, v246
v_and_b32 v33, s49, v246
v_mfma_f32_32x32x16_bf16 a[48:63], a[140:143], v[240:243], a[48:63]
ds_read_b64_tr_b16 a[128:129], v12 offset:40960
ds_read_b64_tr_b16 a[130:131], v12 offset:41472
v_lshlrev_b32 v34, 16, v247
v_and_b32 v35, s49, v247
v_fma_f32 v32, v32, v24, v26
v_fma_f32 v33, v33, v24, v26
s_waitcnt lgkmcnt(6)
v_mfma_f32_32x32x16_bf16 a[64:79], a[144:147], v[240:243], a[64:79]
ds_read_b64_tr_b16 a[132:133], v12 offset:43008
ds_read_b64_tr_b16 a[134:135], v12 offset:43520
v_fma_f32 v34, v34, v24, v26
v_fma_f32 v35, v35, v24, v26
v_cvt_pk_bf16_f32 v246, v32, v33
v_cvt_pk_bf16_f32 v247, v34, v35
v_mfma_f32_32x32x16_bf16 a[80:95], a[148:151], v[240:243], a[80:95]
ds_read_b64_tr_b16 a[136:137], v13 offset:40960
ds_read_b64_tr_b16 a[138:139], v13 offset:41472
s_waitcnt lgkmcnt(6)
v_mfma_f32_32x32x16_bf16 a[96:111], a[152:155], v[240:243], a[96:111]
ds_read_b64_tr_b16 a[140:141], v13 offset:43008
ds_read_b64_tr_b16 a[142:143], v13 offset:43520
v_mfma_f32_32x32x16_bf16 a[112:127], a[156:159], v[240:243], a[112:127]
ds_read_b64_tr_b16 a[144:145], v15 offset:40960
ds_read_b64_tr_b16 a[146:147], v15 offset:41472
s_waitcnt lgkmcnt(6)
v_mfma_f32_32x32x16_bf16 a[0:15], a[128:131], v[244:247], a[0:15]
ds_read_b64_tr_b16 a[148:149], v16 offset:40960
ds_read_b64_tr_b16 a[150:151], v16 offset:41472
v_lshlrev_b32 v28, 16, v248
v_and_b32 v29, s49, v248
v_lshlrev_b32 v30, 16, v249
v_and_b32 v31, s49, v249
v_mfma_f32_32x32x16_bf16 a[16:31], a[132:135], v[244:247], a[16:31]
ds_read_b64_tr_b16 a[152:153], v17 offset:40960
ds_read_b64_tr_b16 a[154:155], v17 offset:41472
v_fma_f32 v28, v28, v24, v26
v_fma_f32 v29, v29, v24, v26
v_fma_f32 v30, v30, v24, v26
v_fma_f32 v31, v31, v24, v26
s_waitcnt lgkmcnt(6)
v_mfma_f32_32x32x16_bf16 a[32:47], a[136:139], v[244:247], a[32:47]
ds_read_b64_tr_b16 a[156:157], v18 offset:40960
ds_read_b64_tr_b16 a[158:159], v18 offset:41472
v_cvt_pk_bf16_f32 v248, v28, v29
v_cvt_pk_bf16_f32 v249, v30, v31
v_lshlrev_b32 v32, 16, v250
v_and_b32 v33, s49, v250
v_mfma_f32_32x32x16_bf16 a[48:63], a[140:143], v[244:247], a[48:63]
ds_read_b64_tr_b16 a[128:129], v12 offset:49152
ds_read_b64_tr_b16 a[130:131], v12 offset:49664
v_lshlrev_b32 v34, 16, v251
v_and_b32 v35, s49, v251
v_fma_f32 v32, v32, v24, v26
v_fma_f32 v33, v33, v24, v26
s_waitcnt lgkmcnt(6)
v_mfma_f32_32x32x16_bf16 a[64:79], a[144:147], v[244:247], a[64:79]
ds_read_b64_tr_b16 a[132:133], v12 offset:51200
ds_read_b64_tr_b16 a[134:135], v12 offset:51712
v_fma_f32 v34, v34, v24, v26
v_fma_f32 v35, v35, v24, v26
v_cvt_pk_bf16_f32 v250, v32, v33
v_cvt_pk_bf16_f32 v251, v34, v35
v_mfma_f32_32x32x16_bf16 a[80:95], a[148:151], v[244:247], a[80:95]
ds_read_b64_tr_b16 a[136:137], v13 offset:49152
ds_read_b64_tr_b16 a[138:139], v13 offset:49664
s_waitcnt lgkmcnt(6)
v_mfma_f32_32x32x16_bf16 a[96:111], a[152:155], v[244:247], a[96:111]
ds_read_b64_tr_b16 a[140:141], v13 offset:51200
ds_read_b64_tr_b16 a[142:143], v13 offset:51712
v_mfma_f32_32x32x16_bf16 a[112:127], a[156:159], v[244:247], a[112:127]
ds_read_b64_tr_b16 a[144:145], v15 offset:49152
ds_read_b64_tr_b16 a[146:147], v15 offset:49664
s_waitcnt lgkmcnt(6)
v_mfma_f32_32x32x16_bf16 a[0:15], a[128:131], v[248:251], a[0:15]
ds_read_b64_tr_b16 a[148:149], v16 offset:49152
ds_read_b64_tr_b16 a[150:151], v16 offset:49664
v_lshlrev_b32 v28, 16, v252
v_and_b32 v29, s49, v252
v_lshlrev_b32 v30, 16, v253
v_and_b32 v31, s49, v253
v_mfma_f32_32x32x16_bf16 a[16:31], a[132:135], v[248:251], a[16:31]
ds_read_b64_tr_b16 a[152:153], v17 offset:49152
ds_read_b64_tr_b16 a[154:155], v17 offset:49664
v_fma_f32 v28, v28, v24, v26
v_fma_f32 v29, v29, v24, v26
v_fma_f32 v30, v30, v24, v26
v_fma_f32 v31, v31, v24, v26
s_waitcnt lgkmcnt(6)
v_mfma_f32_32x32x16_bf16 a[32:47], a[136:139], v[248:251], a[32:47]
ds_read_b64_tr_b16 a[156:157], v18 offset:49152
ds_read_b64_tr_b16 a[158:159], v18 offset:49664
v_cvt_pk_bf16_f32 v252, v28, v29
v_cvt_pk_bf16_f32 v253, v30, v31
v_lshlrev_b32 v32, 16, v254
v_and_b32 v33, s49, v254
v_mfma_f32_32x32x16_bf16 a[48:63], a[140:143], v[248:251], a[48:63]
ds_read_b64_tr_b16 a[128:129], v12 offset:57344
ds_read_b64_tr_b16 a[130:131], v12 offset:57856
v_lshlrev_b32 v34, 16, v255
v_and_b32 v35, s49, v255
v_fma_f32 v32, v32, v24, v26
v_fma_f32 v33, v33, v24, v26
s_waitcnt lgkmcnt(6)
v_mfma_f32_32x32x16_bf16 a[64:79], a[144:147], v[248:251], a[64:79]
ds_read_b64_tr_b16 a[132:133], v12 offset:59392
ds_read_b64_tr_b16 a[134:135], v12 offset:59904
v_fma_f32 v34, v34, v24, v26
v_fma_f32 v35, v35, v24, v26
v_cvt_pk_bf16_f32 v254, v32, v33
v_cvt_pk_bf16_f32 v255, v34, v35
v_mfma_f32_32x32x16_bf16 a[80:95], a[148:151], v[248:251], a[80:95]
ds_read_b64_tr_b16 a[136:137], v13 offset:57344
ds_read_b64_tr_b16 a[138:139], v13 offset:57856
s_waitcnt lgkmcnt(6)
v_mfma_f32_32x32x16_bf16 a[96:111], a[152:155], v[248:251], a[96:111]
ds_read_b64_tr_b16 a[140:141], v13 offset:59392
ds_read_b64_tr_b16 a[142:143], v13 offset:59904
v_mfma_f32_32x32x16_bf16 a[112:127], a[156:159], v[248:251], a[112:127]
ds_read_b64_tr_b16 a[144:145], v15 offset:57344
ds_read_b64_tr_b16 a[146:147], v15 offset:57856
s_waitcnt lgkmcnt(6)
v_mfma_f32_32x32x16_bf16 a[0:15], a[128:131], v[252:255], a[0:15]
ds_read_b64_tr_b16 a[148:149], v16 offset:57344
ds_read_b64_tr_b16 a[150:151], v16 offset:57856
v_mfma_f32_32x32x16_bf16 a[16:31], a[132:135], v[252:255], a[16:31]
ds_read_b64_tr_b16 a[152:153], v17 offset:57344
ds_read_b64_tr_b16 a[154:155], v17 offset:57856
s_waitcnt lgkmcnt(6)
v_mfma_f32_32x32x16_bf16 a[32:47], a[136:139], v[252:255], a[32:47]
ds_read_b64_tr_b16 a[156:157], v18 offset:57344
ds_read_b64_tr_b16 a[158:159], v18 offset:57856
v_mfma_f32_32x32x16_bf16 a[48:63], a[140:143], v[252:255], a[48:63]
s_waitcnt vmcnt(0)
s_barrier
ds_read_b64_tr_b16 a[128:129], v4 offset:0
ds_read_b64_tr_b16 a[130:131], v4 offset:512
s_add_u32 m0, s48, 0
s_nop 0
buffer_load_dwordx4 v19, s[8:11], s46 offen lds
s_waitcnt lgkmcnt(6)
v_mfma_f32_32x32x16_bf16 a[64:79], a[144:147], v[252:255], a[64:79]
ds_read_b64_tr_b16 a[132:133], v5 offset:0
ds_read_b64_tr_b16 a[134:135], v5 offset:512
v_mfma_f32_32x32x16_bf16 a[80:95], a[148:151], v[252:255], a[80:95]
ds_read_b64_tr_b16 a[136:137], v6 offset:0
ds_read_b64_tr_b16 a[138:139], v6 offset:512
buffer_load_dwordx4 v20, s[8:11], s46 offen offset:1024 lds
s_add_u32 m0, s48, 2048
s_waitcnt lgkmcnt(6)
v_mfma_f32_32x32x16_bf16 a[96:111], a[152:155], v[252:255], a[96:111]
ds_read_b64_tr_b16 a[140:141], v4 offset:3072
ds_read_b64_tr_b16 a[142:143], v4 offset:3584
v_mfma_f32_32x32x16_bf16 a[112:127], a[156:159], v[252:255], a[112:127]
ds_read_b64_tr_b16 a[144:145], v5 offset:3072
ds_read_b64_tr_b16 a[146:147], v5 offset:3584
buffer_load_dwordx4 v2, s[8:11], s46 offen lds
s_add_u32 s46, s46, 61440
s_add_u32 m0, s48, 3072
s_waitcnt lgkmcnt(6)
v_mfma_f32_32x32x16_bf16 v[48:63], a[128:131], v[96:99], 0
ds_read_b64_tr_b16 a[148:149], v6 offset:3072
ds_read_b64_tr_b16 a[150:151], v6 offset:3584
v_mfma_f32_32x32x16_bf16 v[64:79], a[132:135], v[96:99], 0
ds_read_b64_tr_b16 a[152:153], v4 offset:6144
ds_read_b64_tr_b16 a[154:155], v4 offset:6656
buffer_load_dwordx4 v19, s[8:11], s46 offen lds
v_accvgpr_read_b32 v28, a0
v_accvgpr_read_b32 v29, a1
v_accvgpr_read_b32 v30, a2
v_accvgpr_read_b32 v31, a3
v_exp_f32 v28, -v28
s_waitcnt lgkmcnt(6)
v_mfma_f32_32x32x16_bf16 v[80:95], a[136:139], v[96:99], 0
ds_read_b64_tr_b16 a[156:157], v5 offset:6144
ds_read_b64_tr_b16 a[158:159], v5 offset:6656
v_exp_f32 v29, -v29
v_exp_f32 v30, -v30
v_exp_f32 v31, -v31
v_mfma_f32_32x32x16_bf16 v[48:63], a[140:143], v[100:103], v[48:63]
ds_read_b64_tr_b16 a[128:129], v6 offset:6144
ds_read_b64_tr_b16 a[130:131], v6 offset:6656
buffer_load_dwordx4 v20, s[8:11], s46 offen offset:1024 lds
s_add_u32 m0, s48, 5120
v_accvgpr_read_b32 v32, a16
v_accvgpr_read_b32 v33, a17
v_accvgpr_read_b32 v34, a18
v_accvgpr_read_b32 v35, a19
s_waitcnt lgkmcnt(6)
v_mfma_f32_32x32x16_bf16 v[64:79], a[144:147], v[100:103], v[64:79]
ds_read_b64_tr_b16 a[132:133], v4 offset:9216
ds_read_b64_tr_b16 a[134:135], v4 offset:9728
v_fma_f32 v28, v28, s63, s63
v_fma_f32 v29, v29, s63, s63
v_fma_f32 v30, v30, s63, s63
v_fma_f32 v31, v31, s63, s63
v_rcp_f32 v28, v28
v_mfma_f32_32x32x16_bf16 v[80:95], a[148:151], v[100:103], v[80:95]
ds_read_b64_tr_b16 a[136:137], v5 offset:9216
ds_read_b64_tr_b16 a[138:139], v5 offset:9728
buffer_load_dwordx4 v2, s[8:11], s46 offen lds
s_add_u32 s46, s46, 430080
s_cmp_ge_u32 s46, 2457600
s_cselect_b32 s52, 2457600, 0
s_sub_u32 s46, s46, s52
s_add_u32 m0, s48, 32768
s_waitcnt lgkmcnt(6)
v_mfma_f32_32x32x16_bf16 v[48:63], a[152:155], v[104:107], v[48:63]
ds_read_b64_tr_b16 a[140:141], v6 offset:9216
ds_read_b64_tr_b16 a[142:143], v6 offset:9728
v_rcp_f32 v29, v29
v_rcp_f32 v30, v30
v_rcp_f32 v31, v31
v_mfma_f32_32x32x16_bf16 v[64:79], a[156:159], v[104:107], v[64:79]
ds_read_b64_tr_b16 a[144:145], v4 offset:12288
ds_read_b64_tr_b16 a[146:147], v4 offset:12800
buffer_load_dwordx4 v19, s[8:11], s46 offen lds
v_mul_f32 v28, v28, v32
v_mul_f32 v29, v29, v33
v_mul_f32 v30, v30, v34
v_mul_f32 v31, v31, v35
v_cvt_pk_bf16_f32 v36, v28, v29
s_waitcnt lgkmcnt(6)
v_mfma_f32_32x32x16_bf16 v[80:95], a[128:131], v[104:107], v[80:95]
ds_read_b64_tr_b16 a[148:149], v5 offset:12288
ds_read_b64_tr_b16 a[150:151], v5 offset:12800
v_cvt_pk_bf16_f32 v37, v30, v31
v_accvgpr_read_b32 v28, a4
v_accvgpr_read_b32 v29, a5
v_accvgpr_read_b32 v30, a6
v_accvgpr_read_b32 v31, a7
v_exp_f32 v28, -v28
v_mfma_f32_32x32x16_bf16 v[48:63], a[132:135], v[108:111], v[48:63]
ds_read_b64_tr_b16 a[152:153], v6 offset:12288
ds_read_b64_tr_b16 a[154:155], v6 offset:12800
buffer_load_dwordx4 v20, s[8:11], s46 offen offset:1024 lds
s_add_u32 m0, s48, 34816
v_exp_f32 v29, -v29
v_exp_f32 v30, -v30
s_waitcnt lgkmcnt(6)
v_mfma_f32_32x32x16_bf16 v[64:79], a[136:139], v[108:111], v[64:79]
ds_read_b64_tr_b16 a[156:157], v4 offset:15360
ds_read_b64_tr_b16 a[158:159], v4 offset:15872
v_exp_f32 v31, -v31
v_accvgpr_read_b32 v32, a20
v_accvgpr_read_b32 v33, a21
v_accvgpr_read_b32 v34, a22
v_accvgpr_read_b32 v35, a23
v_mfma_f32_32x32x16_bf16 v[80:95], a[140:143], v[108:111], v[80:95]
ds_read_b64_tr_b16 a[128:129], v5 offset:15360
ds_read_b64_tr_b16 a[130:131], v5 offset:15872
buffer_load_dwordx4 v2, s[8:11], s46 offen lds
s_add_u32 s46, s46, 61440
s_add_u32 m0, s48, 35840
v_fma_f32 v28, v28, s63, s63
v_fma_f32 v29, v29, s63, s63
v_fma_f32 v30, v30, s63, s63
s_waitcnt lgkmcnt(6)
v_mfma_f32_32x32x16_bf16 v[48:63], a[144:147], v[112:115], v[48:63]
ds_read_b64_tr_b16 a[132:133], v6 offset:15360
ds_read_b64_tr_b16 a[134:135], v6 offset:15872
v_fma_f32 v31, v31, s63, s63
v_rcp_f32 v28, v28
v_rcp_f32 v29, v29
v_rcp_f32 v30, v30
v_mfma_f32_32x32x16_bf16 v[64:79], a[148:151], v[112:115], v[64:79]
ds_read_b64_tr_b16 a[136:137], v4 offset:18432
ds_read_b64_tr_b16 a[138:139], v4 offset:18944
buffer_load_dwordx4 v19, s[8:11], s46 offen lds
v_rcp_f32 v31, v31
v_mul_f32 v28, v28, v32
v_mul_f32 v29, v29, v33
v_mul_f32 v30, v30, v34
s_waitcnt lgkmcnt(6)
v_mfma_f32_32x32x16_bf16 v[80:95], a[152:155], v[112:115], v[80:95]
ds_read_b64_tr_b16 a[140:141], v5 offset:18432
ds_read_b64_tr_b16 a[142:143], v5 offset:18944
v_mul_f32 v31, v31, v35
v_cvt_pk_bf16_f32 v38, v28, v29
v_cvt_pk_bf16_f32 v39, v30, v31
buffer_store_dwordx4 v[36:39], v23, s[20:23], s53 offen offset:0 sc1
v_accvgpr_read_b32 v28, a8
v_accvgpr_read_b32 v29, a9
v_mfma_f32_32x32x16_bf16 v[48:63], a[156:159], v[116:119], v[48:63]
ds_read_b64_tr_b16 a[144:145], v6 offset:18432
ds_read_b64_tr_b16 a[146:147], v6 offset:18944
buffer_load_dwordx4 v20, s[8:11], s46 offen offset:1024 lds
s_add_u32 m0, s48, 37888
v_accvgpr_read_b32 v30, a10
v_accvgpr_read_b32 v31, a11
v_exp_f32 v28, -v28
s_waitcnt lgkmcnt(6)
v_mfma_f32_32x32x16_bf16 v[64:79], a[128:131], v[116:119], v[64:79]
ds_read_b64_tr_b16 a[148:149], v4 offset:21504
ds_read_b64_tr_b16 a[150:151], v4 offset:22016
v_exp_f32 v29, -v29
v_exp_f32 v30, -v30
v_exp_f32 v31, -v31
v_mfma_f32_32x32x16_bf16 v[80:95], a[132:135], v[116:119], v[80:95]
ds_read_b64_tr_b16 a[152:153], v5 offset:21504
ds_read_b64_tr_b16 a[154:155], v5 offset:22016
buffer_load_dwordx4 v2, s[8:11], s46 offen lds
s_add_u32 s46, s46, 430080
s_cmp_ge_u32 s46, 2457600
s_cselect_b32 s52, 2457600, 0
s_sub_u32 s46, s46, s52
v_accvgpr_read_b32 v32, a24
s_waitcnt lgkmcnt(6)
v_mfma_f32_32x32x16_bf16 v[48:63], a[136:139], v[120:123], v[48:63]
ds_read_b64_tr_b16 a[156:157], v6 offset:21504
ds_read_b64_tr_b16 a[158:159], v6 offset:22016
v_accvgpr_read_b32 v33, a25
v_accvgpr_read_b32 v34, a26
v_accvgpr_read_b32 v35, a27
v_fma_f32 v28, v28, s63, s63
v_fma_f32 v29, v29, s63, s63
v_fma_f32 v30, v30, s63, s63
v_mfma_f32_32x32x16_bf16 v[64:79], a[140:143], v[120:123], v[64:79]
ds_read_b64_tr_b16 a[128:129], v4 offset:32768
ds_read_b64_tr_b16 a[130:131], v4 offset:33280
v_fma_f32 v31, v31, s63, s63
v_rcp_f32 v28, v28
v_rcp_f32 v29, v29
v_rcp_f32 v30, v30
s_waitcnt lgkmcnt(6)
v_mfma_f32_32x32x16_bf16 v[80:95], a[144:147], v[120:123], v[80:95]
ds_read_b64_tr_b16 a[132:133], v5 offset:32768
ds_read_b64_tr_b16 a[134:135], v5 offset:33280
v_rcp_f32 v31, v31
v_mul_f32 v28, v28, v32
v_mul_f32 v29, v29, v33
v_mul_f32 v30, v30, v34
v_mul_f32 v31, v31, v35
v_mfma_f32_32x32x16_bf16 v[48:63], a[148:151], v[124:127], v[48:63]
ds_read_b64_tr_b16 a[136:137], v6 offset:32768
ds_read_b64_tr_b16 a[138:139], v6 offset:33280
v_cvt_pk_bf16_f32 v40, v28, v29
v_cvt_pk_bf16_f32 v41, v30, v31
v_accvgpr_read_b32 v28, a12
v_accvgpr_read_b32 v29, a13
v_accvgpr_read_b32 v30, a14
v_accvgpr_read_b32 v31, a15
s_waitcnt lgkmcnt(6)
v_mfma_f32_32x32x16_bf16 v[64:79], a[152:155], v[124:127], v[64:79]
ds_read_b64_tr_b16 a[140:141], v4 offset:35840
ds_read_b64_tr_b16 a[142:143], v4 offset:36352
v_exp_f32 v28, -v28
v_exp_f32 v29, -v29
v_exp_f32 v30, -v30
v_mfma_f32_32x32x16_bf16 v[80:95], a[156:159], v[124:127], v[80:95]
ds_read_b64_tr_b16 a[144:145], v5 offset:35840
ds_read_b64_tr_b16 a[146:147], v5 offset:36352
v_exp_f32 v31, -v31
v_accvgpr_read_b32 v32, a28
v_accvgpr_read_b32 v33, a29
v_accvgpr_read_b32 v34, a30
v_accvgpr_read_b32 v35, a31
s_waitcnt lgkmcnt(6)
v_mfma_f32_32x32x16_bf16 v[48:63], a[128:131], v[128:131], v[48:63]
ds_read_b64_tr_b16 a[148:149], v6 offset:35840
ds_read_b64_tr_b16 a[150:151], v6 offset:36352
v_fma_f32 v28, v28, s63, s63
v_fma_f32 v29, v29, s63, s63
v_fma_f32 v30, v30, s63, s63
v_fma_f32 v31, v31, s63, s63
v_rcp_f32 v28, v28
v_mfma_f32_32x32x16_bf16 v[64:79], a[132:135], v[128:131], v[64:79]
ds_read_b64_tr_b16 a[152:153], v4 offset:38912
ds_read_b64_tr_b16 a[154:155], v4 offset:39424
v_rcp_f32 v29, v29
v_rcp_f32 v30, v30
v_rcp_f32 v31, v31
s_waitcnt lgkmcnt(6)
v_mfma_f32_32x32x16_bf16 v[80:95], a[136:139], v[128:131], v[80:95]
ds_read_b64_tr_b16 a[156:157], v5 offset:38912
ds_read_b64_tr_b16 a[158:159], v5 offset:39424
v_mul_f32 v28, v28, v32
v_mul_f32 v29, v29, v33
v_mul_f32 v30, v30, v34
v_mul_f32 v31, v31, v35
v_cvt_pk_bf16_f32 v42, v28, v29
v_cvt_pk_bf16_f32 v43, v30, v31
v_mfma_f32_32x32x16_bf16 v[48:63], a[140:143], v[132:135], v[48:63]
ds_read_b64_tr_b16 a[128:129], v6 offset:38912
ds_read_b64_tr_b16 a[130:131], v6 offset:39424
buffer_store_dwordx4 v[40:43], v23, s[20:23], s53 offen offset:1024 sc1
v_accvgpr_read_b32 v28, a32
v_accvgpr_read_b32 v29, a33
v_accvgpr_read_b32 v30, a34
v_accvgpr_read_b32 v31, a35
v_exp_f32 v28, -v28
s_waitcnt lgkmcnt(6)
v_mfma_f32_32x32x16_bf16 v[64:79], a[144:147], v[132:135], v[64:79]
ds_read_b64_tr_b16 a[132:133], v4 offset:41984
ds_read_b64_tr_b16 a[134:135], v4 offset:42496
v_exp_f32 v29, -v29
v_exp_f32 v30, -v30
v_exp_f32 v31, -v31
v_mfma_f32_32x32x16_bf16 v[80:95], a[148:151], v[132:135], v[80:95]
ds_read_b64_tr_b16 a[136:137], v5 offset:41984
ds_read_b64_tr_b16 a[138:139], v5 offset:42496
v_accvgpr_read_b32 v32, a48
v_accvgpr_read_b32 v33, a49
v_accvgpr_read_b32 v34, a50
v_accvgpr_read_b32 v35, a51
v_fma_f32 v28, v28, s63, s63
v_fma_f32 v29, v29, s63, s63
s_waitcnt lgkmcnt(6)
v_mfma_f32_32x32x16_bf16 v[48:63], a[152:155], v[136:139], v[48:63]
ds_read_b64_tr_b16 a[140:141], v6 offset:41984
ds_read_b64_tr_b16 a[142:143], v6 offset:42496
v_fma_f32 v30, v30, s63, s63
v_fma_f32 v31, v31, s63, s63
v_rcp_f32 v28, v28
v_rcp_f32 v29, v29
v_mfma_f32_32x32x16_bf16 v[64:79], a[156:159], v[136:139], v[64:79]
ds_read_b64_tr_b16 a[144:145], v4 offset:45056
ds_read_b64_tr_b16 a[146:147], v4 offset:45568
v_rcp_f32 v30, v30
v_rcp_f32 v31, v31
v_mul_f32 v28, v28, v32
v_mul_f32 v29, v29, v33
s_waitcnt lgkmcnt(6)
v_mfma_f32_32x32x16_bf16 v[80:95], a[128:131], v[136:139], v[80:95]
ds_read_b64_tr_b16 a[148:149], v5 offset:45056
ds_read_b64_tr_b16 a[150:151], v5 offset:45568
v_mul_f32 v30, v30, v34
v_mul_f32 v31, v31, v35
v_cvt_pk_bf16_f32 v36, v28, v29
v_cvt_pk_bf16_f32 v37, v30, v31
v_accvgpr_read_b32 v28, a36
v_accvgpr_read_b32 v29, a37
v_mfma_f32_32x32x16_bf16 v[48:63], a[132:135], v[140:143], v[48:63]
ds_read_b64_tr_b16 a[152:153], v6 offset:45056
ds_read_b64_tr_b16 a[154:155], v6 offset:45568
v_accvgpr_read_b32 v30, a38
v_accvgpr_read_b32 v31, a39
v_exp_f32 v28, -v28
v_exp_f32 v29, -v29
s_waitcnt lgkmcnt(6)
v_mfma_f32_32x32x16_bf16 v[64:79], a[136:139], v[140:143], v[64:79]
ds_read_b64_tr_b16 a[156:157], v4 offset:48128
ds_read_b64_tr_b16 a[158:159], v4 offset:48640
v_exp_f32 v30, -v30
v_exp_f32 v31, -v31
v_accvgpr_read_b32 v32, a52
v_accvgpr_read_b32 v33, a53
v_mfma_f32_32x32x16_bf16 v[80:95], a[140:143], v[140:143], v[80:95]
ds_read_b64_tr_b16 a[128:129], v5 offset:48128
ds_read_b64_tr_b16 a[130:131], v5 offset:48640
v_accvgpr_read_b32 v34, a54
v_accvgpr_read_b32 v35, a55
v_fma_f32 v28, v28, s63, s63
v_fma_f32 v29, v29, s63, s63
v_fma_f32 v30, v30, s63, s63
v_fma_f32 v31, v31, s63, s63
s_waitcnt lgkmcnt(6)
v_mfma_f32_32x32x16_bf16 v[48:63], a[144:147], v[144:147], v[48:63]
ds_read_b64_tr_b16 a[132:133], v6 offset:48128
ds_read_b64_tr_b16 a[134:135], v6 offset:48640
v_rcp_f32 v28, v28
v_rcp_f32 v29, v29
v_rcp_f32 v30, v30
v_mfma_f32_32x32x16_bf16 v[64:79], a[148:151], v[144:147], v[64:79]
ds_read_b64_tr_b16 a[136:137], v4 offset:51200
ds_read_b64_tr_b16 a[138:139], v4 offset:51712
v_rcp_f32 v31, v31
v_mul_f32 v28, v28, v32
v_mul_f32 v29, v29, v33
v_mul_f32 v30, v30, v34
v_mul_f32 v31, v31, v35
s_waitcnt lgkmcnt(6)
v_mfma_f32_32x32x16_bf16 v[80:95], a[152:155], v[144:147], v[80:95]
ds_read_b64_tr_b16 a[140:141], v5 offset:51200
ds_read_b64_tr_b16 a[142:143], v5 offset:51712
v_cvt_pk_bf16_f32 v38, v28, v29
v_cvt_pk_bf16_f32 v39, v30, v31
buffer_store_dwordx4 v[36:39], v23, s[20:23], s54 offen offset:0 sc1
v_accvgpr_read_b32 v28, a40
v_accvgpr_read_b32 v29, a41
v_accvgpr_read_b32 v30, a42
v_mfma_f32_32x32x16_bf16 v[48:63], a[156:159], v[148:151], v[48:63]
ds_read_b64_tr_b16 a[144:145], v6 offset:51200
ds_read_b64_tr_b16 a[146:147], v6 offset:51712
v_accvgpr_read_b32 v31, a43
v_exp_f32 v28, -v28
v_exp_f32 v29, -v29
v_exp_f32 v30, -v30
s_waitcnt lgkmcnt(6)
v_mfma_f32_32x32x16_bf16 v[64:79], a[128:131], v[148:151], v[64:79]
ds_read_b64_tr_b16 a[148:149], v4 offset:54272
ds_read_b64_tr_b16 a[150:151], v4 offset:54784
v_exp_f32 v31, -v31
v_accvgpr_read_b32 v32, a56
v_accvgpr_read_b32 v33, a57
v_accvgpr_read_b32 v34, a58
v_accvgpr_read_b32 v35, a59
v_mfma_f32_32x32x16_bf16 v[80:95], a[132:135], v[148:151], v[80:95]
ds_read_b64_tr_b16 a[152:153], v5 offset:54272
ds_read_b64_tr_b16 a[154:155], v5 offset:54784
v_fma_f32 v28, v28, s63, s63
v_fma_f32 v29, v29, s63, s63
v_fma_f32 v30, v30, s63, s63
v_fma_f32 v31, v31, s63, s63
v_rcp_f32 v28, v28
s_waitcnt lgkmcnt(6)
v_mfma_f32_32x32x16_bf16 v[48:63], a[136:139], v[152:155], v[48:63]
ds_read_b64_tr_b16 a[156:157], v6 offset:54272
ds_read_b64_tr_b16 a[158:159], v6 offset:54784
v_rcp_f32 v29, v29
v_rcp_f32 v30, v30
v_rcp_f32 v31, v31
v_mfma_f32_32x32x16_bf16 v[64:79], a[140:143], v[152:155], v[64:79]
s_waitcnt vmcnt(2)
s_barrier
ds_read_b64_tr_b16 a[128:129], v12 offset:0
ds_read_b64_tr_b16 a[130:131], v12 offset:512
s_add_u32 m0, s48, 65536
s_nop 0
buffer_load_dwordx4 v19, s[8:11], s46 offen lds
v_mul_f32 v28, v28, v32
v_mul_f32 v29, v29, v33
v_mul_f32 v30, v30, v34
v_mul_f32 v31, v31, v35
s_waitcnt lgkmcnt(6)
v_mfma_f32_32x32x16_bf16 v[80:95], a[144:147], v[152:155], v[80:95]
ds_read_b64_tr_b16 a[132:133], v13 offset:0
ds_read_b64_tr_b16 a[134:135], v13 offset:512
v_cvt_pk_bf16_f32 v40, v28, v29
v_cvt_pk_bf16_f32 v41, v30, v31
v_accvgpr_read_b32 v28, a44
v_accvgpr_read_b32 v29, a45
v_accvgpr_read_b32 v30, a46
v_accvgpr_read_b32 v31, a47
v_mfma_f32_32x32x16_bf16 v[48:63], a[148:151], v[156:159], v[48:63]
ds_read_b64_tr_b16 a[136:137], v14 offset:0
ds_read_b64_tr_b16 a[138:139], v14 offset:512
buffer_load_dwordx4 v20, s[8:11], s46 offen offset:1024 lds
s_add_u32 m0, s48, 67584
v_exp_f32 v28, -v28
v_exp_f32 v29, -v29
s_waitcnt lgkmcnt(6)
v_mfma_f32_32x32x16_bf16 v[64:79], a[152:155], v[156:159], v[64:79]
ds_read_b64_tr_b16 a[140:141], v12 offset:3072
ds_read_b64_tr_b16 a[142:143], v12 offset:3584
v_exp_f32 v30, -v30
v_exp_f32 v31, -v31
v_accvgpr_read_b32 v32, a60
v_accvgpr_read_b32 v33, a61
v_mfma_f32_32x32x16_bf16 v[80:95], a[156:159], v[156:159], v[80:95]
ds_read_b64_tr_b16 a[144:145], v13 offset:3072
ds_read_b64_tr_b16 a[146:147], v13 offset:3584
buffer_load_dwordx4 v2, s[8:11], s46 offen lds
s_add_u32 s46, s46, 61440
s_add_u32 m0, s48, 68608
v_accvgpr_read_b32 v34, a62
v_accvgpr_read_b32 v35, a63
v_fma_f32 v28, v28, s63, s63
s_waitcnt lgkmcnt(6)
v_mfma_f32_32x32x16_bf16 v[48:63], a[128:131], v[160:163], v[48:63]
ds_read_b64_tr_b16 a[148:149], v14 offset:3072
ds_read_b64_tr_b16 a[150:151], v14 offset:3584
v_fma_f32 v29, v29, s63, s63
v_fma_f32 v30, v30, s63, s63
v_fma_f32 v31, v31, s63, s63
v_rcp_f32 v28, v28
v_rcp_f32 v29, v29
v_mfma_f32_32x32x16_bf16 v[64:79], a[132:135], v[160:163], v[64:79]
ds_read_b64_tr_b16 a[152:153], v12 offset:6144
ds_read_b64_tr_b16 a[154:155], v12 offset:6656
buffer_load_dwordx4 v19, s[8:11], s46 offen lds
v_rcp_f32 v30, v30
v_rcp_f32 v31, v31
v_mul_f32 v28, v28, v32
s_waitcnt lgkmcnt(6)
v_mfma_f32_32x32x16_bf16 v[80:95], a[136:139], v[160:163], v[80:95]
ds_read_b64_tr_b16 a[156:157], v13 offset:6144
ds_read_b64_tr_b16 a[158:159], v13 offset:6656
v_mul_f32 v29, v29, v33
v_mul_f32 v30, v30, v34
v_mul_f32 v31, v31, v35
v_cvt_pk_bf16_f32 v42, v28, v29
v_cvt_pk_bf16_f32 v43, v30, v31
buffer_store_dwordx4 v[40:43], v23, s[20:23], s54 offen offset:1024 sc1
v_mfma_f32_32x32x16_bf16 v[48:63], a[140:143], v[164:167], v[48:63]
ds_read_b64_tr_b16 a[128:129], v14 offset:6144
ds_read_b64_tr_b16 a[130:131], v14 offset:6656
buffer_load_dwordx4 v20, s[8:11], s46 offen offset:1024 lds
s_add_u32 m0, s48, 70656
v_accvgpr_read_b32 v28, a64
v_accvgpr_read_b32 v29, a65
v_accvgpr_read_b32 v30, a66
v_accvgpr_read_b32 v31, a67
s_waitcnt lgkmcnt(6)
v_mfma_f32_32x32x16_bf16 v[64:79], a[144:147], v[164:167], v[64:79]
ds_read_b64_tr_b16 a[132:133], v12 offset:9216
ds_read_b64_tr_b16 a[134:135], v12 offset:9728
v_exp_f32 v28, -v28
v_exp_f32 v29, -v29
v_exp_f32 v30, -v30
v_mfma_f32_32x32x16_bf16 v[80:95], a[148:151], v[164:167], v[80:95]
ds_read_b64_tr_b16 a[136:137], v13 offset:9216
ds_read_b64_tr_b16 a[138:139], v13 offset:9728
buffer_load_dwordx4 v2, s[8:11], s46 offen lds
s_add_u32 s46, s46, 430080
s_cmp_ge_u32 s46, 2457600
s_cselect_b32 s52, 2457600, 0
s_sub_u32 s46, s46, s52
v_exp_f32 v31, -v31
s_waitcnt lgkmcnt(6)
v_mfma_f32_32x32x16_bf16 v[48:63], a[152:155], v[168:171], v[48:63]
ds_read_b64_tr_b16 a[140:141], v14 offset:9216
ds_read_b64_tr_b16 a[142:143], v14 offset:9728
v_accvgpr_read_b32 v32, a80
v_accvgpr_read_b32 v33, a81
v_accvgpr_read_b32 v34, a82
v_accvgpr_read_b32 v35, a83
v_fma_f32 v28, v28, s63, s63
v_fma_f32 v29, v29, s63, s63
v_mfma_f32_32x32x16_bf16 v[64:79], a[156:159], v[168:171], v[64:79]
ds_read_b64_tr_b16 a[144:145], v12 offset:12288
ds_read_b64_tr_b16 a[146:147], v12 offset:12800
v_fma_f32 v30, v30, s63, s63
v_fma_f32 v31, v31, s63, s63
v_rcp_f32 v28, v28
v_rcp_f32 v29, v29
s_waitcnt lgkmcnt(6)
v_mfma_f32_32x32x16_bf16 v[80:95], a[128:131], v[168:171], v[80:95]
ds_read_b64_tr_b16 a[148:149], v13 offset:12288
ds_read_b64_tr_b16 a[150:151], v13 offset:12800
v_rcp_f32 v30, v30
v_rcp_f32 v31, v31
v_mul_f32 v28, v28, v32
v_mul_f32 v29, v29, v33
v_mfma_f32_32x32x16_bf16 v[48:63], a[132:135], v[172:175], v[48:63]
ds_read_b64_tr_b16 a[152:153], v14 offset:12288
ds_read_b64_tr_b16 a[154:155], v14 offset:12800
v_mul_f32 v30, v30, v34
v_mul_f32 v31, v31, v35
v_cvt_pk_bf16_f32 v36, v28, v29
v_cvt_pk_bf16_f32 v37, v30, v31
v_accvgpr_read_b32 v28, a68
v_accvgpr_read_b32 v29, a69
s_waitcnt lgkmcnt(6)
v_mfma_f32_32x32x16_bf16 v[64:79], a[136:139], v[172:175], v[64:79]
ds_read_b64_tr_b16 a[156:157], v12 offset:15360
ds_read_b64_tr_b16 a[158:159], v12 offset:15872
v_accvgpr_read_b32 v30, a70
v_accvgpr_read_b32 v31, a71
v_exp_f32 v28, -v28
v_exp_f32 v29, -v29
v_mfma_f32_32x32x16_bf16 v[80:95], a[140:143], v[172:175], v[80:95]
ds_read_b64_tr_b16 a[128:129], v13 offset:15360
ds_read_b64_tr_b16 a[130:131], v13 offset:15872
v_exp_f32 v30, -v30
v_exp_f32 v31, -v31
v_accvgpr_read_b32 v32, a84
v_accvgpr_read_b32 v33, a85
s_cmp_lg_u32 s35, 0
s_cbranch_scc1 K1_VARB
s_waitcnt lgkmcnt(6)
v_mfma_f32_32x32x16_bf16 v[48:63], a[144:147], v[176:179], v[48:63]
ds_read_b64_tr_b16 a[132:133], v14 offset:15360
ds_read_b64_tr_b16 a[134:135], v14 offset:15872
v_accvgpr_read_b32 v34, a86
v_accvgpr_read_b32 v35, a87
v_fma_f32 v28, v28, s63, s63
v_fma_f32 v29, v29, s63, s63
v_fma_f32 v30, v30, s63, s63
v_fma_f32 v31, v31, s63, s63
v_mfma_f32_32x32x16_bf16 v[64:79], a[148:151], v[176:179], v[64:79]
ds_read_b64_tr_b16 a[136:137], v12 offset:18432
ds_read_b64_tr_b16 a[138:139], v12 offset:18944
v_rcp_f32 v28, v28
v_rcp_f32 v29, v29
v_rcp_f32 v30, v30
s_waitcnt lgkmcnt(6)
v_mfma_f32_32x32x16_bf16 v[80:95], a[152:155], v[176:179], v[80:95]
ds_read_b64_tr_b16 a[140:141], v13 offset:18432
ds_read_b64_tr_b16 a[142:143], v13 offset:18944
v_rcp_f32 v31, v31
v_mul_f32 v28, v28, v32
v_mul_f32 v29, v29, v33
v_mul_f32 v30, v30, v34
v_mul_f32 v31, v31, v35
v_mfma_f32_32x32x16_bf16 v[48:63], a[156:159], v[180:183], v[48:63]
ds_read_b64_tr_b16 a[144:145], v14 offset:18432
ds_read_b64_tr_b16 a[146:147], v14 offset:18944
v_cvt_pk_bf16_f32 v38, v28, v29
v_cvt_pk_bf16_f32 v39, v30, v31
buffer_store_dwordx4 v[36:39], v23, s[20:23], s55 offen offset:0 sc1
v_accvgpr_read_b32 v28, a72
v_accvgpr_read_b32 v29, a73
v_accvgpr_read_b32 v30, a74
s_waitcnt lgkmcnt(6)
v_mfma_f32_32x32x16_bf16 v[64:79], a[128:131], v[180:183], v[64:79]
ds_read_b64_tr_b16 a[148:149], v12 offset:21504
ds_read_b64_tr_b16 a[150:151], v12 offset:22016
v_accvgpr_read_b32 v31, a75
v_exp_f32 v28, -v28
v_exp_f32 v29, -v29
v_exp_f32 v30, -v30
v_mfma_f32_32x32x16_bf16 v[80:95], a[132:135], v[180:183], v[80:95]
ds_read_b64_tr_b16 a[152:153], v13 offset:21504
ds_read_b64_tr_b16 a[154:155], v13 offset:22016
v_exp_f32 v31, -v31
v_accvgpr_read_b32 v32, a88
v_accvgpr_read_b32 v33, a89
v_accvgpr_read_b32 v34, a90
v_accvgpr_read_b32 v35, a91
s_waitcnt lgkmcnt(6)
v_mfma_f32_32x32x16_bf16 v[48:63], a[136:139], v[184:187], v[48:63]
ds_read_b64_tr_b16 a[156:157], v14 offset:21504
ds_read_b64_tr_b16 a[158:159], v14 offset:22016
v_fma_f32 v28, v28, s63, s63
v_fma_f32 v29, v29, s63, s63
v_fma_f32 v30, v30, s63, s63
v_fma_f32 v31, v31, s63, s63
v_rcp_f32 v28, v28
v_mfma_f32_32x32x16_bf16 v[64:79], a[140:143], v[184:187], v[64:79]
ds_read_b64_tr_b16 a[128:129], v12 offset:32768
ds_read_b64_tr_b16 a[130:131], v12 offset:33280
v_rcp_f32 v29, v29
v_rcp_f32 v30, v30
v_rcp_f32 v31, v31
s_waitcnt lgkmcnt(6)
v_mfma_f32_32x32x16_bf16 v[80:95], a[144:147], v[184:187], v[80:95]
ds_read_b64_tr_b16 a[132:133], v13 offset:32768
ds_read_b64_tr_b16 a[134:135], v13 offset:33280
v_mul_f32 v28, v28, v32
v_mul_f32 v29, v29, v33
v_mul_f32 v30, v30, v34
v_mul_f32 v31, v31, v35
v_cvt_pk_bf16_f32 v40, v28, v29
v_cvt_pk_bf16_f32 v41, v30, v31
v_mfma_f32_32x32x16_bf16 v[48:63], a[148:151], v[188:191], v[48:63]
ds_read_b64_tr_b16 a[136:137], v14 offset:32768
ds_read_b64_tr_b16 a[138:139], v14 offset:33280
v_accvgpr_read_b32 v28, a76
v_accvgpr_read_b32 v29, a77
v_accvgpr_read_b32 v30, a78
v_accvgpr_read_b32 v31, a79
v_exp_f32 v28, -v28
s_waitcnt lgkmcnt(6)
v_mfma_f32_32x32x16_bf16 v[64:79], a[152:155], v[188:191], v[64:79]
ds_read_b64_tr_b16 a[140:141], v12 offset:35840
ds_read_b64_tr_b16 a[142:143], v12 offset:36352
v_exp_f32 v29, -v29
v_exp_f32 v30, -v30
v_exp_f32 v31, -v31
v_mfma_f32_32x32x16_bf16 v[80:95], a[156:159], v[188:191], v[80:95]
ds_read_b64_tr_b16 a[144:145], v13 offset:35840
ds_read_b64_tr_b16 a[146:147], v13 offset:36352
v_accvgpr_read_b32 v32, a92
v_accvgpr_read_b32 v33, a93
v_accvgpr_read_b32 v34, a94
v_accvgpr_read_b32 v35, a95
v_fma_f32 v28, v28, s63, s63
v_fma_f32 v29, v29, s63, s63
s_waitcnt lgkmcnt(6)
v_mfma_f32_32x32x16_bf16 v[48:63], a[128:131], v[192:195], v[48:63]
ds_read_b64_tr_b16 a[148:149], v14 offset:35840
ds_read_b64_tr_b16 a[150:151], v14 offset:36352
v_fma_f32 v30, v30, s63, s63
v_fma_f32 v31, v31, s63, s63
v_rcp_f32 v28, v28
v_rcp_f32 v29, v29
v_mfma_f32_32x32x16_bf16 v[64:79], a[132:135], v[192:195], v[64:79]
ds_read_b64_tr_b16 a[152:153], v12 offset:38912
ds_read_b64_tr_b16 a[154:155], v12 offset:39424
v_rcp_f32 v30, v30
v_rcp_f32 v31, v31
v_mul_f32 v28, v28, v32
v_mul_f32 v29, v29, v33
s_waitcnt lgkmcnt(6)
v_mfma_f32_32x32x16_bf16 v[80:95], a[136:139], v[192:195], v[80:95]
ds_read_b64_tr_b16 a[156:157], v13 offset:38912
ds_read_b64_tr_b16 a[158:159], v13 offset:39424
v_mul_f32 v30, v30, v34
v_mul_f32 v31, v31, v35
v_cvt_pk_bf16_f32 v42, v28, v29
v_cvt_pk_bf16_f32 v43, v30, v31
buffer_store_dwordx4 v[40:43], v23, s[20:23], s55 offen offset:1024 sc1
v_accvgpr_read_b32 v28, a96
v_mfma_f32_32x32x16_bf16 v[48:63], a[140:143], v[196:199], v[48:63]
ds_read_b64_tr_b16 a[128:129], v14 offset:38912
ds_read_b64_tr_b16 a[130:131], v14 offset:39424
v_accvgpr_read_b32 v29, a97
v_accvgpr_read_b32 v30, a98
v_accvgpr_read_b32 v31, a99
v_exp_f32 v28, -v28
v_exp_f32 v29, -v29
s_waitcnt lgkmcnt(6)
v_mfma_f32_32x32x16_bf16 v[64:79], a[144:147], v[196:199], v[64:79]
ds_read_b64_tr_b16 a[132:133], v12 offset:41984
ds_read_b64_tr_b16 a[134:135], v12 offset:42496
v_exp_f32 v30, -v30
v_exp_f32 v31, -v31
v_accvgpr_read_b32 v32, a112
v_accvgpr_read_b32 v33, a113
v_mfma_f32_32x32x16_bf16 v[80:95], a[148:151], v[196:199], v[80:95]
ds_read_b64_tr_b16 a[136:137], v13 offset:41984
ds_read_b64_tr_b16 a[138:139], v13 offset:42496
v_accvgpr_read_b32 v34, a114
v_accvgpr_read_b32 v35, a115
v_fma_f32 v28, v28, s63, s63
v_fma_f32 v29, v29, s63, s63
v_fma_f32 v30, v30, s63, s63
v_fma_f32 v31, v31, s63, s63
s_waitcnt lgkmcnt(6)
v_mfma_f32_32x32x16_bf16 v[48:63], a[152:155], v[200:203], v[48:63]
ds_read_b64_tr_b16 a[140:141], v14 offset:41984
ds_read_b64_tr_b16 a[142:143], v14 offset:42496
v_rcp_f32 v28, v28
v_rcp_f32 v29, v29
v_rcp_f32 v30, v30
v_mfma_f32_32x32x16_bf16 v[64:79], a[156:159], v[200:203], v[64:79]
ds_read_b64_tr_b16 a[144:145], v12 offset:45056
ds_read_b64_tr_b16 a[146:147], v12 offset:45568
v_rcp_f32 v31, v31
v_mul_f32 v28, v28, v32
v_mul_f32 v29, v29, v33
v_mul_f32 v30, v30, v34
v_mul_f32 v31, v31, v35
s_waitcnt lgkmcnt(6)
v_mfma_f32_32x32x16_bf16 v[80:95], a[128:131], v[200:203], v[80:95]
ds_read_b64_tr_b16 a[148:149], v13 offset:45056
ds_read_b64_tr_b16 a[150:151], v13 offset:45568
v_cvt_pk_bf16_f32 v36, v28, v29
v_cvt_pk_bf16_f32 v37, v30, v31
v_accvgpr_read_b32 v28, a100
v_accvgpr_read_b32 v29, a101
v_accvgpr_read_b32 v30, a102
v_accvgpr_read_b32 v31, a103
v_mfma_f32_32x32x16_bf16 v[48:63], a[132:135], v[204:207], v[48:63]
ds_read_b64_tr_b16 a[152:153], v14 offset:45056
ds_read_b64_tr_b16 a[154:155], v14 offset:45568
v_exp_f32 v28, -v28
v_exp_f32 v29, -v29
v_exp_f32 v30, -v30
s_waitcnt lgkmcnt(6)
v_mfma_f32_32x32x16_bf16 v[64:79], a[136:139], v[204:207], v[64:79]
ds_read_b64_tr_b16 a[156:157], v12 offset:48128
ds_read_b64_tr_b16 a[158:159], v12 offset:48640
v_exp_f32 v31, -v31
v_accvgpr_read_b32 v32, a116
v_accvgpr_read_b32 v33, a117
v_accvgpr_read_b32 v34, a118
v_accvgpr_read_b32 v35, a119
v_mfma_f32_32x32x16_bf16 v[80:95], a[140:143], v[204:207], v[80:95]
ds_read_b64_tr_b16 a[128:129], v13 offset:48128
ds_read_b64_tr_b16 a[130:131], v13 offset:48640
v_fma_f32 v28, v28, s63, s63
v_fma_f32 v29, v29, s63, s63
v_fma_f32 v30, v30, s63, s63
v_fma_f32 v31, v31, s63, s63
v_rcp_f32 v28, v28
s_waitcnt lgkmcnt(6)
v_mfma_f32_32x32x16_bf16 v[48:63], a[144:147], v[208:211], v[48:63]
ds_read_b64_tr_b16 a[132:133], v14 offset:48128
ds_read_b64_tr_b16 a[134:135], v14 offset:48640
v_rcp_f32 v29, v29
v_rcp_f32 v30, v30
v_rcp_f32 v31, v31
v_mfma_f32_32x32x16_bf16 v[64:79], a[148:151], v[208:211], v[64:79]
ds_read_b64_tr_b16 a[136:137], v12 offset:51200
ds_read_b64_tr_b16 a[138:139], v12 offset:51712
v_mul_f32 v28, v28, v32
v_mul_f32 v29, v29, v33
v_mul_f32 v30, v30, v34
v_mul_f32 v31, v31, v35
v_cvt_pk_bf16_f32 v38, v28, v29
v_cvt_pk_bf16_f32 v39, v30, v31
s_waitcnt lgkmcnt(6)
v_mfma_f32_32x32x16_bf16 v[80:95], a[152:155], v[208:211], v[80:95]
ds_read_b64_tr_b16 a[140:141], v13 offset:51200
ds_read_b64_tr_b16 a[142:143], v13 offset:51712
buffer_store_dwordx4 v[36:39], v23, s[20:23], s56 offen offset:0 sc1
v_accvgpr_read_b32 v28, a104
v_accvgpr_read_b32 v29, a105
v_accvgpr_read_b32 v30, a106
v_accvgpr_read_b32 v31, a107
v_exp_f32 v28, -v28
v_mfma_f32_32x32x16_bf16 v[48:63], a[156:159], v[212:215], v[48:63]
ds_read_b64_tr_b16 a[144:145], v14 offset:51200
ds_read_b64_tr_b16 a[146:147], v14 offset:51712
v_exp_f32 v29, -v29
v_exp_f32 v30, -v30
v_exp_f32 v31, -v31
s_waitcnt lgkmcnt(6)
v_mfma_f32_32x32x16_bf16 v[64:79], a[128:131], v[212:215], v[64:79]
ds_read_b64_tr_b16 a[148:149], v12 offset:54272
ds_read_b64_tr_b16 a[150:151], v12 offset:54784
v_accvgpr_read_b32 v32, a120
v_accvgpr_read_b32 v33, a121
v_accvgpr_read_b32 v34, a122
v_accvgpr_read_b32 v35, a123
v_fma_f32 v28, v28, s63, s63
v_fma_f32 v29, v29, s63, s63
v_mfma_f32_32x32x16_bf16 v[80:95], a[132:135], v[212:215], v[80:95]
ds_read_b64_tr_b16 a[152:153], v13 offset:54272
ds_read_b64_tr_b16 a[154:155], v13 offset:54784
v_fma_f32 v30, v30, s63, s63
v_fma_f32 v31, v31, s63, s63
v_rcp_f32 v28, v28
v_rcp_f32 v29, v29
s_waitcnt lgkmcnt(6)
v_mfma_f32_32x32x16_bf16 v[48:63], a[136:139], v[216:219], v[48:63]
ds_read_b64_tr_b16 a[156:157], v14 offset:54272
ds_read_b64_tr_b16 a[158:159], v14 offset:54784
v_rcp_f32 v30, v30
v_rcp_f32 v31, v31
v_mul_f32 v28, v28, v32
v_mul_f32 v29, v29, v33
v_mfma_f32_32x32x16_bf16 v[64:79], a[140:143], v[216:219], v[64:79]
s_waitcnt vmcnt(3)
s_barrier
ds_read_b64_tr_b16 a[128:129], v4 offset:0
ds_read_b64_tr_b16 a[130:131], v4 offset:512
v_mul_f32 v30, v30, v34
v_mul_f32 v31, v31, v35
v_cvt_pk_bf16_f32 v40, v28, v29
v_cvt_pk_bf16_f32 v41, v30, v31
v_accvgpr_read_b32 v28, a108
v_accvgpr_read_b32 v29, a109
s_waitcnt lgkmcnt(6)
v_mfma_f32_32x32x16_bf16 v[80:95], a[144:147], v[216:219], v[80:95]
ds_read_b64_tr_b16 a[132:133], v4 offset:3072
ds_read_b64_tr_b16 a[134:135], v4 offset:3584
v_accvgpr_read_b32 v30, a110
v_accvgpr_read_b32 v31, a111
v_exp_f32 v28, -v28
v_exp_f32 v29, -v29
v_mfma_f32_32x32x16_bf16 v[48:63], a[148:151], v[220:223], v[48:63]
ds_read_b64_tr_b16 a[136:137], v4 offset:6144
ds_read_b64_tr_b16 a[138:139], v4 offset:6656
v_exp_f32 v30, -v30
v_exp_f32 v31, -v31
v_accvgpr_read_b32 v32, a124
v_accvgpr_read_b32 v33, a125
s_waitcnt lgkmcnt(6)
v_mfma_f32_32x32x16_bf16 v[64:79], a[152:155], v[220:223], v[64:79]
ds_read_b64_tr_b16 a[140:141], v4 offset:9216
ds_read_b64_tr_b16 a[142:143], v4 offset:9728
v_accvgpr_read_b32 v34, a126
v_accvgpr_read_b32 v35, a127
v_fma_f32 v28, v28, s63, s63
v_fma_f32 v29, v29, s63, s63
v_fma_f32 v30, v30, s63, s63
v_fma_f32 v31, v31, s63, s63
v_mfma_f32_32x32x16_bf16 v[80:95], a[156:159], v[220:223], v[80:95]
ds_read_b64_tr_b16 a[144:145], v4 offset:12288
ds_read_b64_tr_b16 a[146:147], v4 offset:12800
v_rcp_f32 v28, v28
v_rcp_f32 v29, v29
v_rcp_f32 v30, v30
s_waitcnt lgkmcnt(6)
v_mfma_f32_32x32x16_bf16 v[48:63], a[128:131], v[224:227], v[48:63]
ds_read_b64_tr_b16 a[148:149], v4 offset:15360
ds_read_b64_tr_b16 a[150:151], v4 offset:15872
v_rcp_f32 v31, v31
v_mul_f32 v28, v28, v32
v_mul_f32 v29, v29, v33
v_mul_f32 v30, v30, v34
v_mul_f32 v31, v31, v35
v_mfma_f32_32x32x16_bf16 v[48:63], a[132:135], v[228:231], v[48:63]
ds_read_b64_tr_b16 a[152:153], v4 offset:18432
ds_read_b64_tr_b16 a[154:155], v4 offset:18944
v_cvt_pk_bf16_f32 v42, v28, v29
v_cvt_pk_bf16_f32 v43, v30, v31
buffer_store_dwordx4 v[40:43], v23, s[20:23], s56 offen offset:1024 sc1
s_waitcnt lgkmcnt(6)
v_mfma_f32_32x32x16_bf16 v[48:63], a[136:139], v[232:235], v[48:63]
ds_read_b64_tr_b16 a[156:157], v4 offset:21504
ds_read_b64_tr_b16 a[158:159], v4 offset:22016
v_mfma_f32_32x32x16_bf16 v[48:63], a[140:143], v[236:239], v[48:63]
ds_read_b64_tr_b16 a[128:129], v5 offset:0
ds_read_b64_tr_b16 a[130:131], v5 offset:512
s_waitcnt lgkmcnt(6)
v_mfma_f32_32x32x16_bf16 v[48:63], a[144:147], v[240:243], v[48:63]
ds_read_b64_tr_b16 a[132:133], v5 offset:3072
ds_read_b64_tr_b16 a[134:135], v5 offset:3584
v_mfma_f32_32x32x16_bf16 v[48:63], a[148:151], v[244:247], v[48:63]
ds_read_b64_tr_b16 a[136:137], v5 offset:6144
ds_read_b64_tr_b16 a[138:139], v5 offset:6656
s_waitcnt lgkmcnt(6)
v_mfma_f32_32x32x16_bf16 v[48:63], a[152:155], v[248:251], v[48:63]
ds_read_b64_tr_b16 a[140:141], v5 offset:9216
ds_read_b64_tr_b16 a[142:143], v5 offset:9728
v_mfma_f32_32x32x16_bf16 v[48:63], a[156:159], v[252:255], v[48:63]
ds_read_b64_tr_b16 a[144:145], v5 offset:12288
ds_read_b64_tr_b16 a[146:147], v5 offset:12800
s_waitcnt lgkmcnt(6)
v_mfma_f32_32x32x16_bf16 v[64:79], a[128:131], v[224:227], v[64:79]
ds_read_b64_tr_b16 a[148:149], v5 offset:15360
ds_read_b64_tr_b16 a[150:151], v5 offset:15872
v_mfma_f32_32x32x16_bf16 v[64:79], a[132:135], v[228:231], v[64:79]
ds_read_b64_tr_b16 a[152:153], v5 offset:18432
ds_read_b64_tr_b16 a[154:155], v5 offset:18944
s_waitcnt lgkmcnt(6)
v_mfma_f32_32x32x16_bf16 v[64:79], a[136:139], v[232:235], v[64:79]
ds_read_b64_tr_b16 a[156:157], v5 offset:21504
ds_read_b64_tr_b16 a[158:159], v5 offset:22016
v_cvt_pk_bf16_f32 v48, v48, v49
v_cvt_pk_bf16_f32 v49, v50, v51
s_add_u32 s51, s59, 0
buffer_store_dwordx2 v[48:49], v25, s[20:23], s51 offen sc1
v_cvt_pk_bf16_f32 v52, v52, v53
v_cvt_pk_bf16_f32 v53, v54, v55
v_mfma_f32_32x32x16_bf16 v[64:79], a[140:143], v[236:239], v[64:79]
ds_read_b64_tr_b16 a[128:129], v6 offset:0
ds_read_b64_tr_b16 a[130:131], v6 offset:512
s_add_u32 s51, s59, 32768
buffer_store_dwordx2 v[52:53], v25, s[20:23], s51 offen sc1
v_cvt_pk_bf16_f32 v56, v56, v57
v_cvt_pk_bf16_f32 v57, v58, v59
s_add_u32 s51, s59, 65536
buffer_store_dwordx2 v[56:57], v25, s[20:23], s51 offen sc1
s_waitcnt lgkmcnt(6)
v_mfma_f32_32x32x16_bf16 v[64:79], a[144:147], v[240:243], v[64:79]
ds_read_b64_tr_b16 a[132:133], v6 offset:3072
ds_read_b64_tr_b16 a[134:135], v6 offset:3584
v_cvt_pk_bf16_f32 v60, v60, v61
v_cvt_pk_bf16_f32 v61, v62, v63
s_add_u32 s51, s59, 98304
buffer_store_dwordx2 v[60:61], v25, s[20:23], s51 offen sc1
v_mfma_f32_32x32x16_bf16 v[64:79], a[148:151], v[244:247], v[64:79]
ds_read_b64_tr_b16 a[136:137], v6 offset:6144
ds_read_b64_tr_b16 a[138:139], v6 offset:6656
s_waitcnt lgkmcnt(6)
v_mfma_f32_32x32x16_bf16 v[64:79], a[152:155], v[248:251], v[64:79]
ds_read_b64_tr_b16 a[140:141], v6 offset:9216
ds_read_b64_tr_b16 a[142:143], v6 offset:9728
v_mfma_f32_32x32x16_bf16 v[64:79], a[156:159], v[252:255], v[64:79]
ds_read_b64_tr_b16 a[144:145], v6 offset:12288
ds_read_b64_tr_b16 a[146:147], v6 offset:12800
s_waitcnt lgkmcnt(6)
v_mfma_f32_32x32x16_bf16 v[80:95], a[128:131], v[224:227], v[80:95]
ds_read_b64_tr_b16 a[148:149], v6 offset:15360
ds_read_b64_tr_b16 a[150:151], v6 offset:15872
v_mfma_f32_32x32x16_bf16 v[80:95], a[132:135], v[228:231], v[80:95]
ds_read_b64_tr_b16 a[152:153], v6 offset:18432
ds_read_b64_tr_b16 a[154:155], v6 offset:18944
s_waitcnt lgkmcnt(6)
v_mfma_f32_32x32x16_bf16 v[80:95], a[136:139], v[232:235], v[80:95]
ds_read_b64_tr_b16 a[156:157], v6 offset:21504
ds_read_b64_tr_b16 a[158:159], v6 offset:22016
v_cvt_pk_bf16_f32 v64, v64, v65
v_cvt_pk_bf16_f32 v65, v66, v67
s_add_u32 s51, s60, 0
buffer_store_dwordx2 v[64:65], v25, s[20:23], s51 offen sc1
v_cvt_pk_bf16_f32 v68, v68, v69
v_cvt_pk_bf16_f32 v69, v70, v71
v_mfma_f32_32x32x16_bf16 v[80:95], a[140:143], v[236:239], v[80:95]
s_add_u32 s51, s60, 32768
buffer_store_dwordx2 v[68:69], v25, s[20:23], s51 offen sc1
v_cvt_pk_bf16_f32 v72, v72, v73
v_cvt_pk_bf16_f32 v73, v74, v75
s_add_u32 s51, s60, 65536
buffer_store_dwordx2 v[72:73], v25, s[20:23], s51 offen sc1
s_waitcnt lgkmcnt(4)
v_mfma_f32_32x32x16_bf16 v[80:95], a[144:147], v[240:243], v[80:95]
v_cvt_pk_bf16_f32 v76, v76, v77
v_cvt_pk_bf16_f32 v77, v78, v79
s_add_u32 s51, s60, 98304
buffer_store_dwordx2 v[76:77], v25, s[20:23], s51 offen sc1
v_mfma_f32_32x32x16_bf16 v[80:95], a[148:151], v[244:247], v[80:95]
s_waitcnt lgkmcnt(0)
v_mfma_f32_32x32x16_bf16 v[80:95], a[152:155], v[248:251], v[80:95]
v_mfma_f32_32x32x16_bf16 v[80:95], a[156:159], v[252:255], v[80:95]
s_nop 11
v_cvt_pk_bf16_f32 v80, v80, v81
v_cvt_pk_bf16_f32 v81, v82, v83
s_add_u32 s51, s61, 0
buffer_store_dwordx2 v[80:81], v25, s[20:23], s51 offen sc1
v_cvt_pk_bf16_f32 v84, v84, v85
v_cvt_pk_bf16_f32 v85, v86, v87
s_add_u32 s51, s61, 32768
buffer_store_dwordx2 v[84:85], v25, s[20:23], s51 offen sc1
v_cvt_pk_bf16_f32 v88, v88, v89
v_cvt_pk_bf16_f32 v89, v90, v91
s_add_u32 s51, s61, 65536
buffer_store_dwordx2 v[88:89], v25, s[20:23], s51 offen sc1
v_cvt_pk_bf16_f32 v92, v92, v93
v_cvt_pk_bf16_f32 v93, v94, v95
s_add_u32 s51, s61, 98304
buffer_store_dwordx2 v[92:93], v25, s[20:23], s51 offen sc1
s_endpgm
K1_VARB:
s_waitcnt lgkmcnt(6)
v_mfma_f32_32x32x16_bf16 v[48:63], a[144:147], v[176:179], v[48:63]
ds_read_b64_tr_b16 a[132:133], v14 offset:15360
ds_read_b64_tr_b16 a[134:135], v14 offset:15872
v_accvgpr_read_b32 v34, a86
v_accvgpr_read_b32 v35, a87
v_fma_f32 v28, v28, s63, s63
v_fma_f32 v29, v29, s63, s63
v_fma_f32 v30, v30, s63, s63
v_fma_f32 v31, v31, s63, s63
v_mfma_f32_32x32x16_bf16 v[64:79], a[148:151], v[176:179], v[64:79]
ds_read_b64_tr_b16 a[136:137], v12 offset:18432
ds_read_b64_tr_b16 a[138:139], v12 offset:18944
v_rcp_f32 v28, v28
v_rcp_f32 v29, v29
v_rcp_f32 v30, v30
s_waitcnt lgkmcnt(6)
v_mfma_f32_32x32x16_bf16 v[80:95], a[152:155], v[176:179], v[80:95]
ds_read_b64_tr_b16 a[140:141], v13 offset:18432
ds_read_b64_tr_b16 a[142:143], v13 offset:18944
v_rcp_f32 v31, v31
v_mul_f32 v28, v28, v32
v_mul_f32 v29, v29, v33
v_mul_f32 v30, v30, v34
v_mul_f32 v31, v31, v35
v_mfma_f32_32x32x16_bf16 v[48:63], a[156:159], v[180:183], v[48:63]
ds_read_b64_tr_b16 a[144:145], v14 offset:18432
ds_read_b64_tr_b16 a[146:147], v14 offset:18944
v_cvt_pk_bf16_f32 v38, v28, v29
v_cvt_pk_bf16_f32 v39, v30, v31
buffer_store_dwordx4 v[36:39], v23, s[20:23], s55 offen offset:0 sc1
v_accvgpr_read_b32 v28, a72
v_accvgpr_read_b32 v29, a73
v_accvgpr_read_b32 v30, a74
s_waitcnt lgkmcnt(6)
v_mfma_f32_32x32x16_bf16 v[64:79], a[128:131], v[180:183], v[64:79]
ds_read_b64_tr_b16 a[148:149], v12 offset:21504
ds_read_b64_tr_b16 a[150:151], v12 offset:22016
v_accvgpr_read_b32 v31, a75
v_exp_f32 v28, -v28
v_exp_f32 v29, -v29
v_exp_f32 v30, -v30
v_mfma_f32_32x32x16_bf16 v[80:95], a[132:135], v[180:183], v[80:95]
ds_read_b64_tr_b16 a[152:153], v13 offset:21504
ds_read_b64_tr_b16 a[154:155], v13 offset:22016
v_exp_f32 v31, -v31
v_accvgpr_read_b32 v32, a88
v_accvgpr_read_b32 v33, a89
v_accvgpr_read_b32 v34, a90
v_accvgpr_read_b32 v35, a91
s_waitcnt lgkmcnt(6)
v_mfma_f32_32x32x16_bf16 v[48:63], a[136:139], v[184:187], v[48:63]
ds_read_b64_tr_b16 a[156:157], v14 offset:21504
ds_read_b64_tr_b16 a[158:159], v14 offset:22016
v_fma_f32 v28, v28, s63, s63
v_fma_f32 v29, v29, s63, s63
v_fma_f32 v30, v30, s63, s63
v_fma_f32 v31, v31, s63, s63
v_rcp_f32 v28, v28
v_mfma_f32_32x32x16_bf16 v[64:79], a[140:143], v[184:187], v[64:79]
ds_read_b64_tr_b16 a[128:129], v12 offset:32768
ds_read_b64_tr_b16 a[130:131], v12 offset:33280
v_rcp_f32 v29, v29
v_rcp_f32 v30, v30
v_rcp_f32 v31, v31
s_waitcnt lgkmcnt(6)
v_mfma_f32_32x32x16_bf16 v[80:95], a[144:147], v[184:187], v[80:95]
ds_read_b64_tr_b16 a[132:133], v13 offset:32768
ds_read_b64_tr_b16 a[134:135], v13 offset:33280
v_mul_f32 v28, v28, v32
v_mul_f32 v29, v29, v33
v_mul_f32 v30, v30, v34
v_mul_f32 v31, v31, v35
v_cvt_pk_bf16_f32 v40, v28, v29
v_cvt_pk_bf16_f32 v41, v30, v31
v_mfma_f32_32x32x16_bf16 v[48:63], a[148:151], v[188:191], v[48:63]
ds_read_b64_tr_b16 a[136:137], v14 offset:32768
ds_read_b64_tr_b16 a[138:139], v14 offset:33280
v_accvgpr_read_b32 v28, a76
v_accvgpr_read_b32 v29, a77
v_accvgpr_read_b32 v30, a78
v_accvgpr_read_b32 v31, a79
v_exp_f32 v28, -v28
s_waitcnt lgkmcnt(6)
v_mfma_f32_32x32x16_bf16 v[64:79], a[152:155], v[188:191], v[64:79]
ds_read_b64_tr_b16 a[140:141], v12 offset:35840
ds_read_b64_tr_b16 a[142:143], v12 offset:36352
v_exp_f32 v29, -v29
v_exp_f32 v30, -v30
v_exp_f32 v31, -v31
v_mfma_f32_32x32x16_bf16 v[80:95], a[156:159], v[188:191], v[80:95]
ds_read_b64_tr_b16 a[144:145], v13 offset:35840
ds_read_b64_tr_b16 a[146:147], v13 offset:36352
v_accvgpr_read_b32 v32, a92
v_accvgpr_read_b32 v33, a93
v_accvgpr_read_b32 v34, a94
v_accvgpr_read_b32 v35, a95
v_fma_f32 v28, v28, s63, s63
v_fma_f32 v29, v29, s63, s63
s_waitcnt lgkmcnt(6)
v_mfma_f32_32x32x16_bf16 v[48:63], a[128:131], v[192:195], v[48:63]
ds_read_b64_tr_b16 a[148:149], v14 offset:35840
ds_read_b64_tr_b16 a[150:151], v14 offset:36352
v_fma_f32 v30, v30, s63, s63
v_fma_f32 v31, v31, s63, s63
v_rcp_f32 v28, v28
v_rcp_f32 v29, v29
v_mfma_f32_32x32x16_bf16 v[64:79], a[132:135], v[192:195], v[64:79]
ds_read_b64_tr_b16 a[152:153], v12 offset:38912
ds_read_b64_tr_b16 a[154:155], v12 offset:39424
v_rcp_f32 v30, v30
v_rcp_f32 v31, v31
v_mul_f32 v28, v28, v32
v_mul_f32 v29, v29, v33
s_waitcnt lgkmcnt(6)
v_mfma_f32_32x32x16_bf16 v[80:95], a[136:139], v[192:195], v[80:95]
ds_read_b64_tr_b16 a[156:157], v13 offset:38912
ds_read_b64_tr_b16 a[158:159], v13 offset:39424
v_mul_f32 v30, v30, v34
v_mul_f32 v31, v31, v35
v_cvt_pk_bf16_f32 v42, v28, v29
v_cvt_pk_bf16_f32 v43, v30, v31
buffer_store_dwordx4 v[40:43], v23, s[20:23], s55 offen offset:1024 sc1
v_accvgpr_read_b32 v28, a96
v_mfma_f32_32x32x16_bf16 v[48:63], a[140:143], v[196:199], v[48:63]
ds_read_b64_tr_b16 a[128:129], v14 offset:38912
ds_read_b64_tr_b16 a[130:131], v14 offset:39424
v_accvgpr_read_b32 v29, a97
v_accvgpr_read_b32 v30, a98
v_accvgpr_read_b32 v31, a99
v_cvt_pk_bf16_f32 v36, v28, v29
v_cvt_pk_bf16_f32 v37, v30, v31
s_add_u32 s51, s57, 0
s_waitcnt lgkmcnt(6)
v_mfma_f32_32x32x16_bf16 v[64:79], a[144:147], v[196:199], v[64:79]
ds_read_b64_tr_b16 a[132:133], v12 offset:41984
ds_read_b64_tr_b16 a[134:135], v12 offset:42496
buffer_store_dwordx2 v[36:37], v25, s[20:23], s51 offen sc1
v_accvgpr_read_b32 v32, a100
v_accvgpr_read_b32 v33, a101
v_accvgpr_read_b32 v34, a102
v_accvgpr_read_b32 v35, a103
v_cvt_pk_bf16_f32 v38, v32, v33
v_mfma_f32_32x32x16_bf16 v[80:95], a[148:151], v[196:199], v[80:95]
ds_read_b64_tr_b16 a[136:137], v13 offset:41984
ds_read_b64_tr_b16 a[138:139], v13 offset:42496
v_cvt_pk_bf16_f32 v39, v34, v35
s_add_u32 s51, s57, 32768
buffer_store_dwordx2 v[38:39], v25, s[20:23], s51 offen sc1
v_accvgpr_read_b32 v28, a104
v_accvgpr_read_b32 v29, a105
v_accvgpr_read_b32 v30, a106
s_waitcnt lgkmcnt(6)
v_mfma_f32_32x32x16_bf16 v[48:63], a[152:155], v[200:203], v[48:63]
ds_read_b64_tr_b16 a[140:141], v14 offset:41984
ds_read_b64_tr_b16 a[142:143], v14 offset:42496
v_accvgpr_read_b32 v31, a107
v_cvt_pk_bf16_f32 v40, v28, v29
v_cvt_pk_bf16_f32 v41, v30, v31
s_add_u32 s51, s57, 65536
buffer_store_dwordx2 v[40:41], v25, s[20:23], s51 offen sc1
v_accvgpr_read_b32 v32, a108
v_mfma_f32_32x32x16_bf16 v[64:79], a[156:159], v[200:203], v[64:79]
ds_read_b64_tr_b16 a[144:145], v12 offset:45056
ds_read_b64_tr_b16 a[146:147], v12 offset:45568
v_accvgpr_read_b32 v33, a109
v_accvgpr_read_b32 v34, a110
v_accvgpr_read_b32 v35, a111
v_cvt_pk_bf16_f32 v42, v32, v33
v_cvt_pk_bf16_f32 v43, v34, v35
s_add_u32 s51, s57, 98304
s_waitcnt lgkmcnt(6)
v_mfma_f32_32x32x16_bf16 v[80:95], a[128:131], v[200:203], v[80:95]
ds_read_b64_tr_b16 a[148:149], v13 offset:45056
ds_read_b64_tr_b16 a[150:151], v13 offset:45568
buffer_store_dwordx2 v[42:43], v25, s[20:23], s51 offen sc1
v_accvgpr_read_b32 v28, a112
v_accvgpr_read_b32 v29, a113
v_accvgpr_read_b32 v30, a114
v_accvgpr_read_b32 v31, a115
v_cvt_pk_bf16_f32 v36, v28, v29
v_mfma_f32_32x32x16_bf16 v[48:63], a[132:135], v[204:207], v[48:63]
ds_read_b64_tr_b16 a[152:153], v14 offset:45056
ds_read_b64_tr_b16 a[154:155], v14 offset:45568
v_cvt_pk_bf16_f32 v37, v30, v31
s_add_u32 s51, s58, 0
buffer_store_dwordx2 v[36:37], v25, s[20:23], s51 offen sc1
v_accvgpr_read_b32 v32, a116
v_accvgpr_read_b32 v33, a117
v_accvgpr_read_b32 v34, a118
s_waitcnt lgkmcnt(6)
v_mfma_f32_32x32x16_bf16 v[64:79], a[136:139], v[204:207], v[64:79]
ds_read_b64_tr_b16 a[156:157], v12 offset:48128
ds_read_b64_tr_b16 a[158:159], v12 offset:48640
v_accvgpr_read_b32 v35, a119
v_cvt_pk_bf16_f32 v38, v32, v33
v_cvt_pk_bf16_f32 v39, v34, v35
s_add_u32 s51, s58, 32768
buffer_store_dwordx2 v[38:39], v25, s[20:23], s51 offen sc1
v_accvgpr_read_b32 v28, a120
v_mfma_f32_32x32x16_bf16 v[80:95], a[140:143], v[204:207], v[80:95]
ds_read_b64_tr_b16 a[128:129], v13 offset:48128
ds_read_b64_tr_b16 a[130:131], v13 offset:48640
v_accvgpr_read_b32 v29, a121
v_accvgpr_read_b32 v30, a122
v_accvgpr_read_b32 v31, a123
v_cvt_pk_bf16_f32 v40, v28, v29
v_cvt_pk_bf16_f32 v41, v30, v31
s_add_u32 s51, s58, 65536
s_waitcnt lgkmcnt(6)
v_mfma_f32_32x32x16_bf16 v[48:63], a[144:147], v[208:211], v[48:63]
ds_read_b64_tr_b16 a[132:133], v14 offset:48128
ds_read_b64_tr_b16 a[134:135], v14 offset:48640
buffer_store_dwordx2 v[40:41], v25, s[20:23], s51 offen sc1
v_accvgpr_read_b32 v32, a124
v_accvgpr_read_b32 v33, a125
v_accvgpr_read_b32 v34, a126
v_accvgpr_read_b32 v35, a127
v_cvt_pk_bf16_f32 v42, v32, v33
v_mfma_f32_32x32x16_bf16 v[64:79], a[148:151], v[208:211], v[64:79]
ds_read_b64_tr_b16 a[136:137], v12 offset:51200
ds_read_b64_tr_b16 a[138:139], v12 offset:51712
v_cvt_pk_bf16_f32 v43, v34, v35
s_add_u32 s51, s58, 98304
buffer_store_dwordx2 v[42:43], v25, s[20:23], s51 offen sc1
s_waitcnt lgkmcnt(6)
v_mfma_f32_32x32x16_bf16 v[80:95], a[152:155], v[208:211], v[80:95]
ds_read_b64_tr_b16 a[140:141], v13 offset:51200
ds_read_b64_tr_b16 a[142:143], v13 offset:51712
v_mfma_f32_32x32x16_bf16 v[48:63], a[156:159], v[212:215], v[48:63]
ds_read_b64_tr_b16 a[144:145], v14 offset:51200
ds_read_b64_tr_b16 a[146:147], v14 offset:51712
s_waitcnt lgkmcnt(6)
v_mfma_f32_32x32x16_bf16 v[64:79], a[128:131], v[212:215], v[64:79]
ds_read_b64_tr_b16 a[148:149], v12 offset:54272
ds_read_b64_tr_b16 a[150:151], v12 offset:54784
v_mfma_f32_32x32x16_bf16 v[80:95], a[132:135], v[212:215], v[80:95]
ds_read_b64_tr_b16 a[152:153], v13 offset:54272
ds_read_b64_tr_b16 a[154:155], v13 offset:54784
s_waitcnt lgkmcnt(6)
v_mfma_f32_32x32x16_bf16 v[48:63], a[136:139], v[216:219], v[48:63]
ds_read_b64_tr_b16 a[156:157], v14 offset:54272
ds_read_b64_tr_b16 a[158:159], v14 offset:54784
v_mfma_f32_32x32x16_bf16 v[64:79], a[140:143], v[216:219], v[64:79]
s_waitcnt vmcnt(10)
s_barrier
ds_read_b64_tr_b16 a[128:129], v4 offset:0
ds_read_b64_tr_b16 a[130:131], v4 offset:512
s_waitcnt lgkmcnt(6)
v_mfma_f32_32x32x16_bf16 v[80:95], a[144:147], v[216:219], v[80:95]
ds_read_b64_tr_b16 a[132:133], v4 offset:3072
ds_read_b64_tr_b16 a[134:135], v4 offset:3584
v_mfma_f32_32x32x16_bf16 v[48:63], a[148:151], v[220:223], v[48:63]
ds_read_b64_tr_b16 a[136:137], v4 offset:6144
ds_read_b64_tr_b16 a[138:139], v4 offset:6656
s_waitcnt lgkmcnt(6)
v_mfma_f32_32x32x16_bf16 v[64:79], a[152:155], v[220:223], v[64:79]
ds_read_b64_tr_b16 a[140:141], v4 offset:9216
ds_read_b64_tr_b16 a[142:143], v4 offset:9728
v_mfma_f32_32x32x16_bf16 v[80:95], a[156:159], v[220:223], v[80:95]
ds_read_b64_tr_b16 a[144:145], v4 offset:12288
ds_read_b64_tr_b16 a[146:147], v4 offset:12800
s_waitcnt lgkmcnt(6)
v_mfma_f32_32x32x16_bf16 v[48:63], a[128:131], v[224:227], v[48:63]
ds_read_b64_tr_b16 a[148:149], v4 offset:15360
ds_read_b64_tr_b16 a[150:151], v4 offset:15872
v_mfma_f32_32x32x16_bf16 v[48:63], a[132:135], v[228:231], v[48:63]
ds_read_b64_tr_b16 a[152:153], v4 offset:18432
ds_read_b64_tr_b16 a[154:155], v4 offset:18944
s_waitcnt lgkmcnt(6)
v_mfma_f32_32x32x16_bf16 v[48:63], a[136:139], v[232:235], v[48:63]
ds_read_b64_tr_b16 a[156:157], v4 offset:21504
ds_read_b64_tr_b16 a[158:159], v4 offset:22016
v_mfma_f32_32x32x16_bf16 v[48:63], a[140:143], v[236:239], v[48:63]
ds_read_b64_tr_b16 a[128:129], v5 offset:0
ds_read_b64_tr_b16 a[130:131], v5 offset:512
s_waitcnt lgkmcnt(6)
v_mfma_f32_32x32x16_bf16 v[48:63], a[144:147], v[240:243], v[48:63]
ds_read_b64_tr_b16 a[132:133], v5 offset:3072
ds_read_b64_tr_b16 a[134:135], v5 offset:3584
v_mfma_f32_32x32x16_bf16 v[48:63], a[148:151], v[244:247], v[48:63]
ds_read_b64_tr_b16 a[136:137], v5 offset:6144
ds_read_b64_tr_b16 a[138:139], v5 offset:6656
s_waitcnt lgkmcnt(6)
v_mfma_f32_32x32x16_bf16 v[48:63], a[152:155], v[248:251], v[48:63]
ds_read_b64_tr_b16 a[140:141], v5 offset:9216
ds_read_b64_tr_b16 a[142:143], v5 offset:9728
v_mfma_f32_32x32x16_bf16 v[48:63], a[156:159], v[252:255], v[48:63]
ds_read_b64_tr_b16 a[144:145], v5 offset:12288
ds_read_b64_tr_b16 a[146:147], v5 offset:12800
s_waitcnt lgkmcnt(6)
v_mfma_f32_32x32x16_bf16 v[64:79], a[128:131], v[224:227], v[64:79]
ds_read_b64_tr_b16 a[148:149], v5 offset:15360
ds_read_b64_tr_b16 a[150:151], v5 offset:15872
v_mfma_f32_32x32x16_bf16 v[64:79], a[132:135], v[228:231], v[64:79]
ds_read_b64_tr_b16 a[152:153], v5 offset:18432
ds_read_b64_tr_b16 a[154:155], v5 offset:18944
s_waitcnt lgkmcnt(6)
v_mfma_f32_32x32x16_bf16 v[64:79], a[136:139], v[232:235], v[64:79]
ds_read_b64_tr_b16 a[156:157], v5 offset:21504
ds_read_b64_tr_b16 a[158:159], v5 offset:22016
v_cvt_pk_bf16_f32 v48, v48, v49
v_cvt_pk_bf16_f32 v49, v50, v51
s_add_u32 s51, s59, 0
buffer_store_dwordx2 v[48:49], v25, s[20:23], s51 offen sc1
v_cvt_pk_bf16_f32 v52, v52, v53
v_cvt_pk_bf16_f32 v53, v54, v55
v_mfma_f32_32x32x16_bf16 v[64:79], a[140:143], v[236:239], v[64:79]
ds_read_b64_tr_b16 a[128:129], v6 offset:0
ds_read_b64_tr_b16 a[130:131], v6 offset:512
s_add_u32 s51, s59, 32768
buffer_store_dwordx2 v[52:53], v25, s[20:23], s51 offen sc1
v_cvt_pk_bf16_f32 v56, v56, v57
v_cvt_pk_bf16_f32 v57, v58, v59
s_add_u32 s51, s59, 65536
buffer_store_dwordx2 v[56:57], v25, s[20:23], s51 offen sc1
s_waitcnt lgkmcnt(6)
v_mfma_f32_32x32x16_bf16 v[64:79], a[144:147], v[240:243], v[64:79]
ds_read_b64_tr_b16 a[132:133], v6 offset:3072
ds_read_b64_tr_b16 a[134:135], v6 offset:3584
v_cvt_pk_bf16_f32 v60, v60, v61
v_cvt_pk_bf16_f32 v61, v62, v63
s_add_u32 s51, s59, 98304
buffer_store_dwordx2 v[60:61], v25, s[20:23], s51 offen sc1
v_mfma_f32_32x32x16_bf16 v[64:79], a[148:151], v[244:247], v[64:79]
ds_read_b64_tr_b16 a[136:137], v6 offset:6144
ds_read_b64_tr_b16 a[138:139], v6 offset:6656
s_waitcnt lgkmcnt(6)
v_mfma_f32_32x32x16_bf16 v[64:79], a[152:155], v[248:251], v[64:79]
ds_read_b64_tr_b16 a[140:141], v6 offset:9216
ds_read_b64_tr_b16 a[142:143], v6 offset:9728
v_mfma_f32_32x32x16_bf16 v[64:79], a[156:159], v[252:255], v[64:79]
ds_read_b64_tr_b16 a[144:145], v6 offset:12288
ds_read_b64_tr_b16 a[146:147], v6 offset:12800
s_waitcnt lgkmcnt(6)
v_mfma_f32_32x32x16_bf16 v[80:95], a[128:131], v[224:227], v[80:95]
ds_read_b64_tr_b16 a[148:149], v6 offset:15360
ds_read_b64_tr_b16 a[150:151], v6 offset:15872
v_mfma_f32_32x32x16_bf16 v[80:95], a[132:135], v[228:231], v[80:95]
ds_read_b64_tr_b16 a[152:153], v6 offset:18432
ds_read_b64_tr_b16 a[154:155], v6 offset:18944
s_waitcnt lgkmcnt(6)
v_mfma_f32_32x32x16_bf16 v[80:95], a[136:139], v[232:235], v[80:95]
ds_read_b64_tr_b16 a[156:157], v6 offset:21504
ds_read_b64_tr_b16 a[158:159], v6 offset:22016
v_cvt_pk_bf16_f32 v64, v64, v65
v_cvt_pk_bf16_f32 v65, v66, v67
s_add_u32 s51, s60, 0
buffer_store_dwordx2 v[64:65], v25, s[20:23], s51 offen sc1
v_cvt_pk_bf16_f32 v68, v68, v69
v_cvt_pk_bf16_f32 v69, v70, v71
v_mfma_f32_32x32x16_bf16 v[80:95], a[140:143], v[236:239], v[80:95]
s_add_u32 s51, s60, 32768
buffer_store_dwordx2 v[68:69], v25, s[20:23], s51 offen sc1
v_cvt_pk_bf16_f32 v72, v72, v73
v_cvt_pk_bf16_f32 v73, v74, v75
s_add_u32 s51, s60, 65536
buffer_store_dwordx2 v[72:73], v25, s[20:23], s51 offen sc1
s_waitcnt lgkmcnt(4)
v_mfma_f32_32x32x16_bf16 v[80:95], a[144:147], v[240:243], v[80:95]
v_cvt_pk_bf16_f32 v76, v76, v77
v_cvt_pk_bf16_f32 v77, v78, v79
s_add_u32 s51, s60, 98304
buffer_store_dwordx2 v[76:77], v25, s[20:23], s51 offen sc1
v_mfma_f32_32x32x16_bf16 v[80:95], a[148:151], v[244:247], v[80:95]
s_waitcnt lgkmcnt(0)
v_mfma_f32_32x32x16_bf16 v[80:95], a[152:155], v[248:251], v[80:95]
v_mfma_f32_32x32x16_bf16 v[80:95], a[156:159], v[252:255], v[80:95]
s_nop 11
v_cvt_pk_bf16_f32 v80, v80, v81
v_cvt_pk_bf16_f32 v81, v82, v83
s_add_u32 s51, s61, 0
buffer_store_dwordx2 v[80:81], v25, s[20:23], s51 offen sc1
v_cvt_pk_bf16_f32 v84, v84, v85
v_cvt_pk_bf16_f32 v85, v86, v87
s_add_u32 s51, s61, 32768
buffer_store_dwordx2 v[84:85], v25, s[20:23], s51 offen sc1
v_cvt_pk_bf16_f32 v88, v88, v89
v_cvt_pk_bf16_f32 v89, v90, v91
s_add_u32 s51, s61, 65536
buffer_store_dwordx2 v[88:89], v25, s[20:23], s51 offen sc1
v_cvt_pk_bf16_f32 v92, v92, v93
v_cvt_pk_bf16_f32 v93, v94, v95
s_add_u32 s51, s61, 98304
buffer_store_dwordx2 v[92:93], v25, s[20:23], s51 offen sc1
s_endpgm
K1_END:

s_endpgm
.section .rodata,"a"
.p2align 6
.amdhsa_kernel k1_kernel
  .amdhsa_next_free_vgpr 512
  .amdhsa_next_free_sgpr 102
  .amdhsa_accum_offset 256
  .amdhsa_group_segment_fixed_size 0
  .amdhsa_kernarg_size 80
  .amdhsa_user_sgpr_count 2
  .amdhsa_user_sgpr_kernarg_segment_ptr 1
  .amdhsa_system_sgpr_workgroup_id_x 1
.end_amdhsa_kernel
.text
.globl k2_kernel
.p2align 8
.type k2_kernel,@function
k2_kernel:
s_cmp_ge_u32 s2, 256
s_cbranch_scc1 K2_END
s_load_dwordx2 s[62:63], s[0:1], 0
s_load_dwordx2 s[64:65], s[0:1], 16
s_load_dwordx4 s[68:71], s[0:1], 48
s_load_dwordx2 s[66:67], s[0:1], 72
v_and_b32 v1, 63, v0
v_lshrrev_b32 v2, 6, v0
s_nop 0
v_readfirstlane_b32 s32, v2
s_and_b32 s37, s2, 7
s_lshr_b32 s38, s2, 3
s_lshl_b32 s35, s37, 2
s_and_b32 s39, s38, 3
s_add_u32 s35, s35, s39
s_lshr_b32 s36, s38, 2
s_lshr_b32 s33, s37, 1
s_lshl_b32 s33, s33, 3
s_and_b32 s39, s38, 7
s_add_u32 s33, s33, s39
s_and_b32 s34, s37, 1
s_lshl_b32 s34, s34, 2
s_lshr_b32 s31, s38, 3
s_add_u32 s34, s34, s31
s_mul_i32 s31, s31, 7
s_mul_i32 s39, s39, 3
s_add_u32 s31, s31, s39
s_cmp_ge_u32 s31, 27
s_cselect_b32 s39, 27, 0
s_sub_u32 s31, s31, s39
s_cmp_ge_u32 s31, 27
s_cselect_b32 s39, 27, 0
s_sub_u32 s31, s31, s39
s_waitcnt lgkmcnt(0)
s_mov_b32 s16, s66
s_and_b32 s17, s67, 0xffff
s_mov_b32 s18, 25165824
s_mov_b32 s19, 0x20000
s_getpc_b64 s[86:87]
K2_PFB:
s_lshr_b32 s37, s2, 3
s_lshl_b32 s37, s37, 3
s_add_u32 s37, s37, s32
s_lshl_b32 s37, s37, 7
s_min_u32 s37, s37, TEXT_END-K2_PFB-4
v_mov_b32 v3, s37
s_mov_b64 exec, 1
global_load_dword v0, v3, s[86:87]
s_mov_b64 exec, -1
s_cmp_ge_u32 s32, 4
s_cbranch_scc1 K2_T
s_mul_i32 s37, s34, 148
s_mul_i32 s38, s32, 27
s_add_u32 s37, s37, s38
s_mul_i32 s41, s37, 2560
s_add_u32 s41, s41, 20971520
s_mul_i32 s42, s33, 221184
s_lshl_b32 s38, s38, 10
s_add_u32 s42, s42, s38
s_add_u32 s42, s42, 8388608
v_lshlrev_b32 v2, 4, v1
v_add_u32 v3, 110592, v2
v_lshrrev_b32 v12, 5, v1
v_and_b32 v13, 15, v1
v_lshl_add_u32 v14, v12, 4, v13
v_lshlrev_b32 v14, 4, v14
v_bfe_u32 v15, v1, 4, 1
v_mul_u32_u24 v15, 2560, v15
v_add_u32 v4, v14, v15
buffer_load_dwordx4 a[0:3], v2, s[16:19], s41 offen
buffer_load_dwordx4 v[52:55], v2, s[16:19], s42 offen
buffer_load_dwordx4 v[56:59], v3, s[16:19], s42 offen
buffer_load_dwordx4 a[4:7], v2, s[16:19], s41 offen offset:1024
buffer_load_dwordx4 v[38:41], v4, s[16:19], s41 offen offset:2048
s_add_u32 s41, s41, 2560
s_add_u32 s42, s42, 1024
s_barrier
buffer_load_dwordx4 a[8:11], v2, s[16:19], s41 offen
buffer_load_dwordx4 v[60:63], v2, s[16:19], s42 offen
buffer_load_dwordx4 v[64:67], v3, s[16:19], s42 offen
buffer_load_dwordx4 a[12:15], v2, s[16:19], s41 offen offset:1024
s_add_u32 s41, s41, 2560
s_add_u32 s42, s42, 1024
buffer_load_dwordx4 a[16:19], v2, s[16:19], s41 offen
buffer_load_dwordx4 v[68:71], v2, s[16:19], s42 offen
buffer_load_dwordx4 v[72:75], v3, s[16:19], s42 offen
buffer_load_dwordx4 a[20:23], v2, s[16:19], s41 offen offset:1024
buffer_load_dwordx4 v[42:45], v4, s[16:19], s41 offen offset:2048
s_add_u32 s41, s41, 2560
s_add_u32 s42, s42, 1024
s_mov_b32 s4, s62
s_and_b32 s5, s63, 0xffff
s_mov_b32 s6, 2621440
s_mov_b32 s7, 0x20000
s_mov_b32 s20, s70
s_and_b32 s21, s71, 0xffff
s_mov_b32 s22, 2621440
s_mov_b32 s23, 0x20000
s_mul_i32 s40, s32, 28160
v_add_u32 v10, s40, v2
v_add_u32 v11, s40, v14
v_and_b32 v13, 31, v1
v_mul_u32_u24 v14, 80, v13
v_lshl_add_u32 v14, v12, 3, v14
s_add_u32 s37, s40, 25600
v_add_u32 v9, s37, v14
v_lshlrev_b32 v15, 3, v13
v_lshl_add_u32 v5, v12, 8, v15
s_mov_b32 s50, 0x0000ffff
s_mov_b32 s51, 0x0000ffff
s_mov_b32 s52, 0xffff0000
s_mov_b32 s53, 0xffff0000
v_add_u32 v12, 0, v1
v_min_u32 v12, 159, v12
v_mul_u32_u24 v13, 13108, v12
v_lshrrev_b32 v13, 16, v13
v_mul_u32_u24 v14, 5, v13
v_sub_u32 v14, v12, v14
v_mul_u32_u24 v13, 1280, v13
v_lshl_add_u32 v6, v14, 4, v13
v_add_u32 v12, 64, v1
v_min_u32 v12, 159, v12
v_mul_u32_u24 v13, 13108, v12
v_lshrrev_b32 v13, 16, v13
v_mul_u32_u24 v14, 5, v13
v_sub_u32 v14, v12, v14
v_mul_u32_u24 v13, 1280, v13
v_lshl_add_u32 v7, v14, 4, v13
v_add_u32 v12, 128, v1
v_min_u32 v12, 159, v12
v_mul_u32_u24 v13, 13108, v12
v_lshrrev_b32 v13, 16, v13
v_mul_u32_u24 v14, 5, v13
v_sub_u32 v14, v12, v14
v_mul_u32_u24 v13, 1280, v13
v_lshl_add_u32 v8, v14, 4, v13
s_lshr_b32 s37, s32, 1
s_lshl_b32 s38, s33, 1
s_add_u32 s37, s37, s38
s_mul_i32 s47, s37, 40960
s_mul_i32 s37, s34, 160
s_add_u32 s47, s47, s37
s_and_b32 s37, s32, 1
s_mul_i32 s37, s37, 80
s_add_u32 s47, s47, s37
s_mul_i32 s37, s34, 148
s_mul_i32 s38, s32, 10
s_add_u32 s37, s37, s38
s_add_u32 s37, s37, 108
s_mul_i32 s49, s37, 2560
s_add_u32 s49, s49, 20971520
s_waitcnt vmcnt(9)
buffer_load_dwordx4 a[24:27], v2, s[16:19], s41 offen
buffer_load_dwordx4 v[76:79], v2, s[16:19], s42 offen
buffer_load_dwordx4 v[80:83], v3, s[16:19], s42 offen
buffer_load_dwordx4 a[28:31], v2, s[16:19], s41 offen offset:1024
s_add_u32 s41, s41, 2560
s_add_u32 s42, s42, 1024
v_cndmask_b32 v12, 0, v38, s[50:51]
v_cndmask_b32 v13, 0, v39, s[50:51]
v_cndmask_b32 v14, 0, v40, s[50:51]
v_cndmask_b32 v15, 0, v41, s[50:51]
v_mfma_f32_32x32x16_bf16 v[96:111], a[0:3], v[52:55], 0
v_mfma_f32_32x32x16_bf16 v[144:159], a[0:3], v[56:59], 0
v_mfma_f32_32x32x16_bf16 v[112:127], a[4:7], v[52:55], 0
v_mfma_f32_32x32x16_bf16 v[160:175], a[4:7], v[56:59], 0
v_mfma_f32_32x32x16_bf16 v[128:143], v[12:15], v[52:55], 0
v_mfma_f32_32x32x16_bf16 v[176:191], v[12:15], v[56:59], 0
s_waitcnt vmcnt(9)
buffer_load_dwordx4 a[0:3], v2, s[16:19], s41 offen
buffer_load_dwordx4 v[52:55], v2, s[16:19], s42 offen
buffer_load_dwordx4 v[56:59], v3, s[16:19], s42 offen
buffer_load_dwordx4 a[4:7], v2, s[16:19], s41 offen offset:1024
buffer_load_dwordx4 v[46:49], v4, s[16:19], s41 offen offset:2048
s_add_u32 s41, s41, 2560
s_add_u32 s42, s42, 1024
s_add_u32 m0, s40, 0
s_nop 0
buffer_load_dwordx4 v2, s[16:19], s49 offen offset:0 lds
buffer_load_dwordx4 v2, s[16:19], s49 offen offset:1024 lds
v_cndmask_b32 v16, 0, v38, s[52:53]
v_cndmask_b32 v17, 0, v39, s[52:53]
v_cndmask_b32 v18, 0, v40, s[52:53]
v_cndmask_b32 v19, 0, v41, s[52:53]
v_mfma_f32_32x32x16_bf16 v[96:111], a[8:11], v[60:63], v[96:111]
v_mfma_f32_32x32x16_bf16 v[144:159], a[8:11], v[64:67], v[144:159]
v_mfma_f32_32x32x16_bf16 v[112:127], a[12:15], v[60:63], v[112:127]
v_mfma_f32_32x32x16_bf16 v[160:175], a[12:15], v[64:67], v[160:175]
v_mfma_f32_32x32x16_bf16 v[128:143], v[16:19], v[60:63], v[128:143]
v_mfma_f32_32x32x16_bf16 v[176:191], v[16:19], v[64:67], v[176:191]
s_waitcnt vmcnt(11)
buffer_load_dwordx4 a[8:11], v2, s[16:19], s41 offen
buffer_load_dwordx4 v[60:63], v2, s[16:19], s42 offen
buffer_load_dwordx4 v[64:67], v3, s[16:19], s42 offen
buffer_load_dwordx4 a[12:15], v2, s[16:19], s41 offen offset:1024
s_add_u32 s41, s41, 2560
s_add_u32 s42, s42, 1024
buffer_load_dwordx4 v2, s[16:19], s49 offen offset:2048 lds
buffer_load_dwordx4 v2, s[16:19], s49 offen offset:3072 lds
v_cndmask_b32 v12, 0, v42, s[50:51]
v_cndmask_b32 v13, 0, v43, s[50:51]
v_cndmask_b32 v14, 0, v44, s[50:51]
v_cndmask_b32 v15, 0, v45, s[50:51]
v_mfma_f32_32x32x16_bf16 v[96:111], a[16:19], v[68:71], v[96:111]
v_mfma_f32_32x32x16_bf16 v[144:159], a[16:19], v[72:75], v[144:159]
v_mfma_f32_32x32x16_bf16 v[112:127], a[20:23], v[68:71], v[112:127]
v_mfma_f32_32x32x16_bf16 v[160:175], a[20:23], v[72:75], v[160:175]
v_mfma_f32_32x32x16_bf16 v[128:143], v[12:15], v[68:71], v[128:143]
v_mfma_f32_32x32x16_bf16 v[176:191], v[12:15], v[72:75], v[176:191]
s_waitcnt vmcnt(13)
buffer_load_dwordx4 a[16:19], v2, s[16:19], s41 offen
buffer_load_dwordx4 v[68:71], v2, s[16:19], s42 offen
buffer_load_dwordx4 v[72:75], v3, s[16:19], s42 offen
buffer_load_dwordx4 a[20:23], v2, s[16:19], s41 offen offset:1024
buffer_load_dwordx4 v[38:41], v4, s[16:19], s41 offen offset:2048
s_add_u32 s41, s41, 2560
s_add_u32 s42, s42, 1024
s_add_u32 m0, s40, 4096
s_add_u32 s49, s49, 4096
buffer_load_dwordx4 v2, s[16:19], s49 offen offset:0 lds
buffer_load_dwordx4 v2, s[16:19], s49 offen offset:1024 lds
v_cndmask_b32 v16, 0, v42, s[52:53]
v_cndmask_b32 v17, 0, v43, s[52:53]
v_cndmask_b32 v18, 0, v44, s[52:53]
v_cndmask_b32 v19, 0, v45, s[52:53]
v_mfma_f32_32x32x16_bf16 v[96:111], a[24:27], v[76:79], v[96:111]
v_mfma_f32_32x32x16_bf16 v[144:159], a[24:27], v[80:83], v[144:159]
v_mfma_f32_32x32x16_bf16 v[112:127], a[28:31], v[76:79], v[112:127]
v_mfma_f32_32x32x16_bf16 v[160:175], a[28:31], v[80:83], v[160:175]
v_mfma_f32_32x32x16_bf16 v[128:143], v[16:19], v[76:79], v[128:143]
v_mfma_f32_32x32x16_bf16 v[176:191], v[16:19], v[80:83], v[176:191]
s_waitcnt vmcnt(15)
buffer_load_dwordx4 a[24:27], v2, s[16:19], s41 offen
buffer_load_dwordx4 v[76:79], v2, s[16:19], s42 offen
buffer_load_dwordx4 v[80:83], v3, s[16:19], s42 offen
buffer_load_dwordx4 a[28:31], v2, s[16:19], s41 offen offset:1024
s_add_u32 s41, s41, 2560
s_add_u32 s42, s42, 1024
buffer_load_dwordx4 v2, s[16:19], s49 offen offset:2048 lds
buffer_load_dwordx4 v2, s[16:19], s49 offen offset:3072 lds
v_cndmask_b32 v12, 0, v46, s[50:51]
v_cndmask_b32 v13, 0, v47, s[50:51]
v_cndmask_b32 v14, 0, v48, s[50:51]
v_cndmask_b32 v15, 0, v49, s[50:51]
v_mfma_f32_32x32x16_bf16 v[96:111], a[0:3], v[52:55], v[96:111]
v_mfma_f32_32x32x16_bf16 v[144:159], a[0:3], v[56:59], v[144:159]
v_mfma_f32_32x32x16_bf16 v[112:127], a[4:7], v[52:55], v[112:127]
v_mfma_f32_32x32x16_bf16 v[160:175], a[4:7], v[56:59], v[160:175]
v_mfma_f32_32x32x16_bf16 v[128:143], v[12:15], v[52:55], v[128:143]
v_mfma_f32_32x32x16_bf16 v[176:191], v[12:15], v[56:59], v[176:191]
s_waitcnt vmcnt(15)
buffer_load_dwordx4 a[0:3], v2, s[16:19], s41 offen
buffer_load_dwordx4 v[52:55], v2, s[16:19], s42 offen
buffer_load_dwordx4 v[56:59], v3, s[16:19], s42 offen
buffer_load_dwordx4 a[4:7], v2, s[16:19], s41 offen offset:1024
buffer_load_dwordx4 v[42:45], v4, s[16:19], s41 offen offset:2048
s_add_u32 s41, s41, 2560
s_add_u32 s42, s42, 1024
s_add_u32 m0, s40, 8192
s_add_u32 s49, s49, 4096
buffer_load_dwordx4 v2, s[16:19], s49 offen offset:0 lds
buffer_load_dwordx4 v2, s[16:19], s49 offen offset:1024 lds
v_cndmask_b32 v16, 0, v46, s[52:53]
v_cndmask_b32 v17, 0, v47, s[52:53]
v_cndmask_b32 v18, 0, v48, s[52:53]
v_cndmask_b32 v19, 0, v49, s[52:53]
v_mfma_f32_32x32x16_bf16 v[96:111], a[8:11], v[60:63], v[96:111]
v_mfma_f32_32x32x16_bf16 v[144:159], a[8:11], v[64:67], v[144:159]
v_mfma_f32_32x32x16_bf16 v[112:127], a[12:15], v[60:63], v[112:127]
v_mfma_f32_32x32x16_bf16 v[160:175], a[12:15], v[64:67], v[160:175]
v_mfma_f32_32x32x16_bf16 v[128:143], v[16:19], v[60:63], v[128:143]
v_mfma_f32_32x32x16_bf16 v[176:191], v[16:19], v[64:67], v[176:191]
s_waitcnt vmcnt(15)
buffer_load_dwordx4 a[8:11], v2, s[16:19], s41 offen
buffer_load_dwordx4 v[60:63], v2, s[16:19], s42 offen
buffer_load_dwordx4 v[64:67], v3, s[16:19], s42 offen
buffer_load_dwordx4 a[12:15], v2, s[16:19], s41 offen offset:1024
s_add_u32 s41, s41, 2560
s_add_u32 s42, s42, 1024
buffer_load_dwordx4 v2, s[16:19], s49 offen offset:2048 lds
buffer_load_dwordx4 v2, s[16:19], s49 offen offset:3072 lds
buffer_load_dwordx4 v[84:87], v6, s[4:7], s47 offen
buffer_load_dwordx4 v[88:91], v7, s[4:7], s47 offen
buffer_load_dwordx4 v[92:95], v8, s[4:7], s47 offen
v_cndmask_b32 v12, 0, v38, s[50:51]
v_cndmask_b32 v13, 0, v39, s[50:51]
v_cndmask_b32 v14, 0, v40, s[50:51]
v_cndmask_b32 v15, 0, v41, s[50:51]
v_mfma_f32_32x32x16_bf16 v[96:111], a[16:19], v[68:71], v[96:111]
v_mfma_f32_32x32x16_bf16 v[144:159], a[16:19], v[72:75], v[144:159]
v_mfma_f32_32x32x16_bf16 v[112:127], a[20:23], v[68:71], v[112:127]
v_mfma_f32_32x32x16_bf16 v[160:175], a[20:23], v[72:75], v[160:175]
v_mfma_f32_32x32x16_bf16 v[128:143], v[12:15], v[68:71], v[128:143]
v_mfma_f32_32x32x16_bf16 v[176:191], v[12:15], v[72:75], v[176:191]
s_waitcnt vmcnt(18)
buffer_load_dwordx4 a[16:19], v2, s[16:19], s41 offen
buffer_load_dwordx4 v[68:71], v2, s[16:19], s42 offen
buffer_load_dwordx4 v[72:75], v3, s[16:19], s42 offen
buffer_load_dwordx4 a[20:23], v2, s[16:19], s41 offen offset:1024
buffer_load_dwordx4 v[46:49], v4, s[16:19], s41 offen offset:2048
s_add_u32 s41, s41, 2560
s_add_u32 s42, s42, 1024
s_add_u32 m0, s40, 12288
s_add_u32 s49, s49, 4096
buffer_load_dwordx4 v2, s[16:19], s49 offen offset:0 lds
buffer_load_dwordx4 v2, s[16:19], s49 offen offset:1024 lds
v_cndmask_b32 v16, 0, v38, s[52:53]
v_cndmask_b32 v17, 0, v39, s[52:53]
v_cndmask_b32 v18, 0, v40, s[52:53]
v_cndmask_b32 v19, 0, v41, s[52:53]
v_mfma_f32_32x32x16_bf16 v[96:111], a[24:27], v[76:79], v[96:111]
v_mfma_f32_32x32x16_bf16 v[144:159], a[24:27], v[80:83], v[144:159]
v_mfma_f32_32x32x16_bf16 v[112:127], a[28:31], v[76:79], v[112:127]
v_mfma_f32_32x32x16_bf16 v[160:175], a[28:31], v[80:83], v[160:175]
v_mfma_f32_32x32x16_bf16 v[128:143], v[16:19], v[76:79], v[128:143]
v_mfma_f32_32x32x16_bf16 v[176:191], v[16:19], v[80:83], v[176:191]
s_waitcnt vmcnt(18)
buffer_load_dwordx4 a[24:27], v2, s[16:19], s41 offen
buffer_load_dwordx4 v[76:79], v2, s[16:19], s42 offen
buffer_load_dwordx4 v[80:83], v3, s[16:19], s42 offen
buffer_load_dwordx4 a[28:31], v2, s[16:19], s41 offen offset:1024
s_add_u32 s41, s41, 2560
s_add_u32 s42, s42, 1024
buffer_load_dwordx4 v2, s[16:19], s49 offen offset:2048 lds
buffer_load_dwordx4 v2, s[16:19], s49 offen offset:3072 lds
v_cndmask_b32 v12, 0, v42, s[50:51]
v_cndmask_b32 v13, 0, v43, s[50:51]
v_cndmask_b32 v14, 0, v44, s[50:51]
v_cndmask_b32 v15, 0, v45, s[50:51]
v_mfma_f32_32x32x16_bf16 v[96:111], a[0:3], v[52:55], v[96:111]
v_mfma_f32_32x32x16_bf16 v[144:159], a[0:3], v[56:59], v[144:159]
v_mfma_f32_32x32x16_bf16 v[112:127], a[4:7], v[52:55], v[112:127]
v_mfma_f32_32x32x16_bf16 v[160:175], a[4:7], v[56:59], v[160:175]
v_mfma_f32_32x32x16_bf16 v[128:143], v[12:15], v[52:55], v[128:143]
v_mfma_f32_32x32x16_bf16 v[176:191], v[12:15], v[56:59], v[176:191]
s_waitcnt vmcnt(18)
buffer_load_dwordx4 a[0:3], v2, s[16:19], s41 offen
buffer_load_dwordx4 v[52:55], v2, s[16:19], s42 offen
buffer_load_dwordx4 v[56:59], v3, s[16:19], s42 offen
buffer_load_dwordx4 a[4:7], v2, s[16:19], s41 offen offset:1024
buffer_load_dwordx4 v[38:41], v4, s[16:19], s41 offen offset:2048
s_add_u32 s41, s41, 2560
s_add_u32 s42, s42, 1024
s_add_u32 m0, s40, 16384
s_add_u32 s49, s49, 4096
buffer_load_dwordx4 v2, s[16:19], s49 offen offset:0 lds
buffer_load_dwordx4 v2, s[16:19], s49 offen offset:1024 lds
v_cndmask_b32 v16, 0, v42, s[52:53]
v_cndmask_b32 v17, 0, v43, s[52:53]
v_cndmask_b32 v18, 0, v44, s[52:53]
v_cndmask_b32 v19, 0, v45, s[52:53]
v_mfma_f32_32x32x16_bf16 v[96:111], a[8:11], v[60:63], v[96:111]
v_mfma_f32_32x32x16_bf16 v[144:159], a[8:11], v[64:67], v[144:159]
v_mfma_f32_32x32x16_bf16 v[112:127], a[12:15], v[60:63], v[112:127]
v_mfma_f32_32x32x16_bf16 v[160:175], a[12:15], v[64:67], v[160:175]
v_mfma_f32_32x32x16_bf16 v[128:143], v[16:19], v[60:63], v[128:143]
v_mfma_f32_32x32x16_bf16 v[176:191], v[16:19], v[64:67], v[176:191]
s_waitcnt vmcnt(15)
buffer_load_dwordx4 a[8:11], v2, s[16:19], s41 offen
buffer_load_dwordx4 v[60:63], v2, s[16:19], s42 offen
buffer_load_dwordx4 v[64:67], v3, s[16:19], s42 offen
buffer_load_dwordx4 a[12:15], v2, s[16:19], s41 offen offset:1024
s_add_u32 s41, s41, 2560
s_add_u32 s42, s42, 1024
buffer_load_dwordx4 v2, s[16:19], s49 offen offset:2048 lds
buffer_load_dwordx4 v2, s[16:19], s49 offen offset:3072 lds
v_cndmask_b32 v12, 0, v46, s[50:51]
v_cndmask_b32 v13, 0, v47, s[50:51]
v_cndmask_b32 v14, 0, v48, s[50:51]
v_cndmask_b32 v15, 0, v49, s[50:51]
v_mfma_f32_32x32x16_bf16 v[96:111], a[16:19], v[68:71], v[96:111]
v_mfma_f32_32x32x16_bf16 v[144:159], a[16:19], v[72:75], v[144:159]
v_mfma_f32_32x32x16_bf16 v[112:127], a[20:23], v[68:71], v[112:127]
v_mfma_f32_32x32x16_bf16 v[160:175], a[20:23], v[72:75], v[160:175]
v_mfma_f32_32x32x16_bf16 v[128:143], v[12:15], v[68:71], v[128:143]
v_mfma_f32_32x32x16_bf16 v[176:191], v[12:15], v[72:75], v[176:191]
s_waitcnt vmcnt(15)
buffer_load_dwordx4 a[16:19], v2, s[16:19], s41 offen
buffer_load_dwordx4 v[68:71], v2, s[16:19], s42 offen
buffer_load_dwordx4 v[72:75], v3, s[16:19], s42 offen
buffer_load_dwordx4 a[20:23], v2, s[16:19], s41 offen offset:1024
buffer_load_dwordx4 v[42:45], v4, s[16:19], s41 offen offset:2048
s_add_u32 s41, s41, 2560
s_add_u32 s42, s42, 1024
s_add_u32 m0, s40, 20480
s_add_u32 s49, s49, 4096
buffer_load_dwordx4 v2, s[16:19], s49 offen offset:0 lds
buffer_load_dwordx4 v2, s[16:19], s49 offen offset:1024 lds
v_cndmask_b32 v16, 0, v46, s[52:53]
v_cndmask_b32 v17, 0, v47, s[52:53]
v_cndmask_b32 v18, 0, v48, s[52:53]
v_cndmask_b32 v19, 0, v49, s[52:53]
v_mfma_f32_32x32x16_bf16 v[96:111], a[24:27], v[76:79], v[96:111]
v_mfma_f32_32x32x16_bf16 v[144:159], a[24:27], v[80:83], v[144:159]
v_mfma_f32_32x32x16_bf16 v[112:127], a[28:31], v[76:79], v[112:127]
v_mfma_f32_32x32x16_bf16 v[160:175], a[28:31], v[80:83], v[160:175]
v_mfma_f32_32x32x16_bf16 v[128:143], v[16:19], v[76:79], v[128:143]
v_mfma_f32_32x32x16_bf16 v[176:191], v[16:19], v[80:83], v[176:191]
s_waitcnt vmcnt(15)
buffer_load_dwordx4 a[24:27], v2, s[16:19], s41 offen
buffer_load_dwordx4 v[76:79], v2, s[16:19], s42 offen
buffer_load_dwordx4 v[80:83], v3, s[16:19], s42 offen
buffer_load_dwordx4 a[28:31], v2, s[16:19], s41 offen offset:1024
s_add_u32 s41, s41, 2560
s_add_u32 s42, s42, 1024
buffer_load_dwordx4 v2, s[16:19], s49 offen offset:2048 lds
buffer_load_dwordx4 v2, s[16:19], s49 offen offset:3072 lds
ds_write_b128 v10, v[84:87] offset:25600
ds_write_b128 v10, v[88:91] offset:26624
s_mov_b32 exec_hi, 0
ds_write_b128 v10, v[92:95] offset:27648
s_mov_b64 exec, -1
v_cndmask_b32 v12, 0, v38, s[50:51]
v_cndmask_b32 v13, 0, v39, s[50:51]
v_cndmask_b32 v14, 0, v40, s[50:51]
v_cndmask_b32 v15, 0, v41, s[50:51]
v_mfma_f32_32x32x16_bf16 v[96:111], a[0:3], v[52:55], v[96:111]
v_mfma_f32_32x32x16_bf16 v[144:159], a[0:3], v[56:59], v[144:159]
v_mfma_f32_32x32x16_bf16 v[112:127], a[4:7], v[52:55], v[112:127]
v_mfma_f32_32x32x16_bf16 v[160:175], a[4:7], v[56:59], v[160:175]
v_mfma_f32_32x32x16_bf16 v[128:143], v[12:15], v[52:55], v[128:143]
v_mfma_f32_32x32x16_bf16 v[176:191], v[12:15], v[56:59], v[176:191]
s_waitcnt vmcnt(15)
buffer_load_dwordx4 a[0:3], v2, s[16:19], s41 offen
buffer_load_dwordx4 v[52:55], v2, s[16:19], s42 offen
buffer_load_dwordx4 v[56:59], v3, s[16:19], s42 offen
buffer_load_dwordx4 a[4:7], v2, s[16:19], s41 offen offset:1024
buffer_load_dwordx4 v[46:49], v4, s[16:19], s41 offen offset:2048
s_add_u32 s41, s41, 2560
s_add_u32 s42, s42, 1024
s_add_u32 m0, s40, 24576
s_add_u32 s49, s49, 4096
buffer_load_dwordx4 v2, s[16:19], s49 offen offset:0 lds
ds_read_b64 v[28:29], v9 offset:0
ds_read_b64 v[30:31], v9 offset:16
ds_read_b64 v[32:33], v9 offset:32
ds_read_b64 v[34:35], v9 offset:48
ds_read_b64 v[36:37], v9 offset:64
v_cndmask_b32 v16, 0, v38, s[52:53]
v_cndmask_b32 v17, 0, v39, s[52:53]
v_cndmask_b32 v18, 0, v40, s[52:53]
v_cndmask_b32 v19, 0, v41, s[52:53]
v_mfma_f32_32x32x16_bf16 v[96:111], a[8:11], v[60:63], v[96:111]
v_mfma_f32_32x32x16_bf16 v[144:159], a[8:11], v[64:67], v[144:159]
v_mfma_f32_32x32x16_bf16 v[112:127], a[12:15], v[60:63], v[112:127]
v_mfma_f32_32x32x16_bf16 v[160:175], a[12:15], v[64:67], v[160:175]
v_mfma_f32_32x32x16_bf16 v[128:143], v[16:19], v[60:63], v[128:143]
v_mfma_f32_32x32x16_bf16 v[176:191], v[16:19], v[64:67], v[176:191]
s_waitcnt vmcnt(14)
buffer_load_dwordx4 a[8:11], v2, s[16:19], s41 offen
buffer_load_dwordx4 v[60:63], v2, s[16:19], s42 offen
buffer_load_dwordx4 v[64:67], v3, s[16:19], s42 offen
buffer_load_dwordx4 a[12:15], v2, s[16:19], s41 offen offset:1024
s_add_u32 s41, s41, 2560
s_add_u32 s42, s42, 1024
v_cndmask_b32 v12, 0, v42, s[50:51]
v_cndmask_b32 v13, 0, v43, s[50:51]
v_cndmask_b32 v14, 0, v44, s[50:51]
v_cndmask_b32 v15, 0, v45, s[50:51]
v_mfma_f32_32x32x16_bf16 v[96:111], a[16:19], v[68:71], v[96:111]
v_mfma_f32_32x32x16_bf16 v[144:159], a[16:19], v[72:75], v[144:159]
v_mfma_f32_32x32x16_bf16 v[112:127], a[20:23], v[68:71], v[112:127]
v_mfma_f32_32x32x16_bf16 v[160:175], a[20:23], v[72:75], v[160:175]
v_mfma_f32_32x32x16_bf16 v[128:143], v[12:15], v[68:71], v[128:143]
v_mfma_f32_32x32x16_bf16 v[176:191], v[12:15], v[72:75], v[176:191]
s_waitcnt vmcnt(12)
buffer_load_dwordx4 a[16:19], v2, s[16:19], s41 offen
buffer_load_dwordx4 v[68:71], v2, s[16:19], s42 offen
buffer_load_dwordx4 v[72:75], v3, s[16:19], s42 offen
buffer_load_dwordx4 a[20:23], v2, s[16:19], s41 offen offset:1024
buffer_load_dwordx4 v[38:41], v4, s[16:19], s41 offen offset:2048
s_add_u32 s41, s41, 2560
s_add_u32 s42, s42, 1024
v_cndmask_b32 v16, 0, v42, s[52:53]
v_cndmask_b32 v17, 0, v43, s[52:53]
v_cndmask_b32 v18, 0, v44, s[52:53]
v_cndmask_b32 v19, 0, v45, s[52:53]
v_mfma_f32_32x32x16_bf16 v[96:111], a[24:27], v[76:79], v[96:111]
v_mfma_f32_32x32x16_bf16 v[144:159], a[24:27], v[80:83], v[144:159]
v_mfma_f32_32x32x16_bf16 v[112:127], a[28:31], v[76:79], v[112:127]
v_mfma_f32_32x32x16_bf16 v[160:175], a[28:31], v[80:83], v[160:175]
v_mfma_f32_32x32x16_bf16 v[128:143], v[16:19], v[76:79], v[128:143]
v_mfma_f32_32x32x16_bf16 v[176:191], v[16:19], v[80:83], v[176:191]
s_waitcnt vmcnt(10)
buffer_load_dwordx4 a[24:27], v2, s[16:19], s41 offen
buffer_load_dwordx4 v[76:79], v2, s[16:19], s42 offen
buffer_load_dwordx4 v[80:83], v3, s[16:19], s42 offen
buffer_load_dwordx4 a[28:31], v2, s[16:19], s41 offen offset:1024
s_add_u32 s41, s41, 2560
s_add_u32 s42, s42, 1024
v_cndmask_b32 v12, 0, v46, s[50:51]
v_cndmask_b32 v13, 0, v47, s[50:51]
v_cndmask_b32 v14, 0, v48, s[50:51]
v_cndmask_b32 v15, 0, v49, s[50:51]
v_mfma_f32_32x32x16_bf16 v[96:111], a[0:3], v[52:55], v[96:111]
v_mfma_f32_32x32x16_bf16 v[144:159], a[0:3], v[56:59], v[144:159]
v_mfma_f32_32x32x16_bf16 v[112:127], a[4:7], v[52:55], v[112:127]
v_mfma_f32_32x32x16_bf16 v[160:175], a[4:7], v[56:59], v[160:175]
v_mfma_f32_32x32x16_bf16 v[128:143], v[12:15], v[52:55], v[128:143]
v_mfma_f32_32x32x16_bf16 v[176:191], v[12:15], v[56:59], v[176:191]
s_waitcnt vmcnt(9)
buffer_load_dwordx4 a[0:3], v2, s[16:19], s41 offen
buffer_load_dwordx4 v[52:55], v2, s[16:19], s42 offen
buffer_load_dwordx4 v[56:59], v3, s[16:19], s42 offen
buffer_load_dwordx4 a[4:7], v2, s[16:19], s41 offen offset:1024
buffer_load_dwordx4 v[42:45], v4, s[16:19], s41 offen offset:2048
s_add_u32 s41, s41, 2560
s_add_u32 s42, s42, 1024
v_cndmask_b32 v16, 0, v46, s[52:53]
v_cndmask_b32 v17, 0, v47, s[52:53]
v_cndmask_b32 v18, 0, v48, s[52:53]
v_cndmask_b32 v19, 0, v49, s[52:53]
v_mfma_f32_32x32x16_bf16 v[96:111], a[8:11], v[60:63], v[96:111]
v_mfma_f32_32x32x16_bf16 v[144:159], a[8:11], v[64:67], v[144:159]
v_mfma_f32_32x32x16_bf16 v[112:127], a[12:15], v[60:63], v[112:127]
v_mfma_f32_32x32x16_bf16 v[160:175], a[12:15], v[64:67], v[160:175]
v_mfma_f32_32x32x16_bf16 v[128:143], v[16:19], v[60:63], v[128:143]
v_mfma_f32_32x32x16_bf16 v[176:191], v[16:19], v[64:67], v[176:191]
s_waitcnt vmcnt(9)
buffer_load_dwordx4 a[8:11], v2, s[16:19], s41 offen
buffer_load_dwordx4 v[60:63], v2, s[16:19], s42 offen
buffer_load_dwordx4 v[64:67], v3, s[16:19], s42 offen
buffer_load_dwordx4 a[12:15], v2, s[16:19], s41 offen offset:1024
s_add_u32 s41, s41, 2560
s_add_u32 s42, s42, 1024
v_cndmask_b32 v12, 0, v38, s[50:51]
v_cndmask_b32 v13, 0, v39, s[50:51]
v_cndmask_b32 v14, 0, v40, s[50:51]
v_cndmask_b32 v15, 0, v41, s[50:51]
v_mfma_f32_32x32x16_bf16 v[96:111], a[16:19], v[68:71], v[96:111]
v_mfma_f32_32x32x16_bf16 v[144:159], a[16:19], v[72:75], v[144:159]
v_mfma_f32_32x32x16_bf16 v[112:127], a[20:23], v[68:71], v[112:127]
v_mfma_f32_32x32x16_bf16 v[160:175], a[20:23], v[72:75], v[160:175]
v_mfma_f32_32x32x16_bf16 v[128:143], v[12:15], v[68:71], v[128:143]
v_mfma_f32_32x32x16_bf16 v[176:191], v[12:15], v[72:75], v[176:191]
s_waitcnt vmcnt(9)
buffer_load_dwordx4 a[16:19], v2, s[16:19], s41 offen
buffer_load_dwordx4 v[68:71], v2, s[16:19], s42 offen
buffer_load_dwordx4 v[72:75], v3, s[16:19], s42 offen
buffer_load_dwordx4 a[20:23], v2, s[16:19], s41 offen offset:1024
buffer_load_dwordx4 v[46:49], v4, s[16:19], s41 offen offset:2048
s_add_u32 s41, s41, 2560
s_add_u32 s42, s42, 1024
v_cndmask_b32 v16, 0, v38, s[52:53]
v_cndmask_b32 v17, 0, v39, s[52:53]
v_cndmask_b32 v18, 0, v40, s[52:53]
v_cndmask_b32 v19, 0, v41, s[52:53]
v_mfma_f32_32x32x16_bf16 v[96:111], a[24:27], v[76:79], v[96:111]
v_mfma_f32_32x32x16_bf16 v[144:159], a[24:27], v[80:83], v[144:159]
v_mfma_f32_32x32x16_bf16 v[112:127], a[28:31], v[76:79], v[112:127]
v_mfma_f32_32x32x16_bf16 v[160:175], a[28:31], v[80:83], v[160:175]
v_mfma_f32_32x32x16_bf16 v[128:143], v[16:19], v[76:79], v[128:143]
v_mfma_f32_32x32x16_bf16 v[176:191], v[16:19], v[80:83], v[176:191]
s_waitcnt vmcnt(9)
buffer_load_dwordx4 a[24:27], v2, s[16:19], s41 offen
buffer_load_dwordx4 v[76:79], v2, s[16:19], s42 offen
buffer_load_dwordx4 v[80:83], v3, s[16:19], s42 offen
buffer_load_dwordx4 a[28:31], v2, s[16:19], s41 offen offset:1024
s_add_u32 s41, s41, 2560
s_add_u32 s42, s42, 1024
v_cndmask_b32 v12, 0, v42, s[50:51]
v_cndmask_b32 v13, 0, v43, s[50:51]
v_cndmask_b32 v14, 0, v44, s[50:51]
v_cndmask_b32 v15, 0, v45, s[50:51]
v_mfma_f32_32x32x16_bf16 v[96:111], a[0:3], v[52:55], v[96:111]
v_mfma_f32_32x32x16_bf16 v[144:159], a[0:3], v[56:59], v[144:159]
v_mfma_f32_32x32x16_bf16 v[112:127], a[4:7], v[52:55], v[112:127]
v_mfma_f32_32x32x16_bf16 v[160:175], a[4:7], v[56:59], v[160:175]
v_mfma_f32_32x32x16_bf16 v[128:143], v[12:15], v[52:55], v[128:143]
v_mfma_f32_32x32x16_bf16 v[176:191], v[12:15], v[56:59], v[176:191]
s_waitcnt vmcnt(9)
buffer_load_dwordx4 a[0:3], v2, s[16:19], s41 offen
buffer_load_dwordx4 v[52:55], v2, s[16:19], s42 offen
buffer_load_dwordx4 v[56:59], v3, s[16:19], s42 offen
buffer_load_dwordx4 a[4:7], v2, s[16:19], s41 offen offset:1024
buffer_load_dwordx4 v[38:41], v4, s[16:19], s41 offen offset:2048
s_add_u32 s41, s41, 2560
s_add_u32 s42, s42, 1024
v_cndmask_b32 v16, 0, v42, s[52:53]
v_cndmask_b32 v17, 0, v43, s[52:53]
v_cndmask_b32 v18, 0, v44, s[52:53]
v_cndmask_b32 v19, 0, v45, s[52:53]
v_mfma_f32_32x32x16_bf16 v[96:111], a[8:11], v[60:63], v[96:111]
v_mfma_f32_32x32x16_bf16 v[144:159], a[8:11], v[64:67], v[144:159]
v_mfma_f32_32x32x16_bf16 v[112:127], a[12:15], v[60:63], v[112:127]
v_mfma_f32_32x32x16_bf16 v[160:175], a[12:15], v[64:67], v[160:175]
v_mfma_f32_32x32x16_bf16 v[128:143], v[16:19], v[60:63], v[128:143]
v_mfma_f32_32x32x16_bf16 v[176:191], v[16:19], v[64:67], v[176:191]
s_waitcnt vmcnt(9)
buffer_load_dwordx4 a[8:11], v2, s[16:19], s41 offen
buffer_load_dwordx4 v[60:63], v2, s[16:19], s42 offen
buffer_load_dwordx4 v[64:67], v3, s[16:19], s42 offen
buffer_load_dwordx4 a[12:15], v2, s[16:19], s41 offen offset:1024
s_add_u32 s41, s41, 2560
s_add_u32 s42, s42, 1024
v_cndmask_b32 v12, 0, v46, s[50:51]
v_cndmask_b32 v13, 0, v47, s[50:51]
v_cndmask_b32 v14, 0, v48, s[50:51]
v_cndmask_b32 v15, 0, v49, s[50:51]
v_mfma_f32_32x32x16_bf16 v[96:111], a[16:19], v[68:71], v[96:111]
v_mfma_f32_32x32x16_bf16 v[144:159], a[16:19], v[72:75], v[144:159]
v_mfma_f32_32x32x16_bf16 v[112:127], a[20:23], v[68:71], v[112:127]
v_mfma_f32_32x32x16_bf16 v[160:175], a[20:23], v[72:75], v[160:175]
v_mfma_f32_32x32x16_bf16 v[128:143], v[12:15], v[68:71], v[128:143]
v_mfma_f32_32x32x16_bf16 v[176:191], v[12:15], v[72:75], v[176:191]
s_waitcnt vmcnt(9)
buffer_load_dwordx4 a[16:19], v2, s[16:19], s41 offen
buffer_load_dwordx4 v[68:71], v2, s[16:19], s42 offen
buffer_load_dwordx4 v[72:75], v3, s[16:19], s42 offen
buffer_load_dwordx4 a[20:23], v2, s[16:19], s41 offen offset:1024
buffer_load_dwordx4 v[42:45], v4, s[16:19], s41 offen offset:2048
s_add_u32 s41, s41, 2560
s_add_u32 s42, s42, 1024
v_cndmask_b32 v16, 0, v46, s[52:53]
v_cndmask_b32 v17, 0, v47, s[52:53]
v_cndmask_b32 v18, 0, v48, s[52:53]
v_cndmask_b32 v19, 0, v49, s[52:53]
v_mfma_f32_32x32x16_bf16 v[96:111], a[24:27], v[76:79], v[96:111]
v_mfma_f32_32x32x16_bf16 v[144:159], a[24:27], v[80:83], v[144:159]
v_mfma_f32_32x32x16_bf16 v[112:127], a[28:31], v[76:79], v[112:127]
v_mfma_f32_32x32x16_bf16 v[160:175], a[28:31], v[80:83], v[160:175]
v_mfma_f32_32x32x16_bf16 v[128:143], v[16:19], v[76:79], v[128:143]
v_mfma_f32_32x32x16_bf16 v[176:191], v[16:19], v[80:83], v[176:191]
s_lshl_b32 s37, s33, 6
s_lshl_b32 s38, s32, 3
s_add_u32 s37, s37, s38
s_lshl_b32 s54, s37, 10
s_add_u32 s54, s54, 16777216
s_add_u32 s55, s54, 32768
s_lshl_b32 s56, s37, 8
s_add_u32 s56, s56, 18874368
s_add_u32 s57, s56, 8192
s_lshl_b32 s46, s33, 7
s_lshl_b32 s37, s32, 5
s_add_u32 s46, s46, s37
s_add_u32 s46, s46, 19922944
v_and_b32 v20, 7, v1
v_lshlrev_b32 v20, 2, v20
s_mov_b32 s39, 200000
G_POLL:
buffer_load_dword v21, v20, s[16:19], s46 offen sc1
s_sub_u32 s39, s39, 1
s_waitcnt vmcnt(0)
v_cmp_ne_u32 vcc, 1, v21
s_cmp_eq_u32 s39, 0
s_cbranch_scc1 G_POLLED
s_cbranch_vccnz G_POLL
G_POLLED:
s_waitcnt vmcnt(9)
buffer_load_dwordx4 a[56:59], v2, s[16:19], s54 offen offset:0 sc1
buffer_load_dwordx4 a[60:63], v2, s[16:19], s55 offen offset:0 sc1
buffer_load_dwordx4 v[84:87], v2, s[16:19], s54 offen offset:1024 sc1
buffer_load_dwordx4 v[88:91], v2, s[16:19], s55 offen offset:1024 sc1
buffer_load_dwordx4 v[76:79], v2, s[16:19], s54 offen offset:2048 sc1
buffer_load_dwordx4 v[80:83], v2, s[16:19], s55 offen offset:2048 sc1
buffer_load_dwordx4 a[24:27], v2, s[16:19], s54 offen offset:3072 sc1
buffer_load_dwordx4 a[28:31], v2, s[16:19], s55 offen offset:3072 sc1
s_add_u32 s54, s54, 4096
s_add_u32 s55, s55, 4096
ds_read_b128 a[32:35], v10 offset:0
ds_read_b128 a[36:39], v10 offset:1024
ds_read_b128 a[40:43], v11 offset:2048
ds_read_b128 a[44:47], v10 offset:2560
ds_read_b128 a[48:51], v10 offset:3584
ds_read_b128 a[52:55], v11 offset:4608
v_cndmask_b32 v12, 0, v38, s[50:51]
v_cndmask_b32 v13, 0, v39, s[50:51]
v_cndmask_b32 v14, 0, v40, s[50:51]
v_cndmask_b32 v15, 0, v41, s[50:51]
v_mfma_f32_32x32x16_bf16 v[96:111], a[0:3], v[52:55], v[96:111]
v_mfma_f32_32x32x16_bf16 v[144:159], a[0:3], v[56:59], v[144:159]
v_mfma_f32_32x32x16_bf16 v[112:127], a[4:7], v[52:55], v[112:127]
v_mfma_f32_32x32x16_bf16 v[160:175], a[4:7], v[56:59], v[160:175]
v_mfma_f32_32x32x16_bf16 v[128:143], v[12:15], v[52:55], v[128:143]
v_mfma_f32_32x32x16_bf16 v[176:191], v[12:15], v[56:59], v[176:191]
s_waitcnt vmcnt(13)
buffer_load_dwordx4 v[52:55], v2, s[16:19], s54 offen offset:0 sc1
buffer_load_dwordx4 v[56:59], v2, s[16:19], s55 offen offset:0 sc1
buffer_load_dwordx4 a[0:3], v2, s[16:19], s54 offen offset:1024 sc1
buffer_load_dwordx4 a[4:7], v2, s[16:19], s55 offen offset:1024 sc1
v_cndmask_b32 v16, 0, v38, s[52:53]
v_cndmask_b32 v17, 0, v39, s[52:53]
v_cndmask_b32 v18, 0, v40, s[52:53]
v_cndmask_b32 v19, 0, v41, s[52:53]
v_mfma_f32_32x32x16_bf16 v[96:111], a[8:11], v[60:63], v[96:111]
v_mfma_f32_32x32x16_bf16 v[144:159], a[8:11], v[64:67], v[144:159]
v_mfma_f32_32x32x16_bf16 v[112:127], a[12:15], v[60:63], v[112:127]
v_mfma_f32_32x32x16_bf16 v[160:175], a[12:15], v[64:67], v[160:175]
v_mfma_f32_32x32x16_bf16 v[128:143], v[16:19], v[60:63], v[128:143]
v_mfma_f32_32x32x16_bf16 v[176:191], v[16:19], v[64:67], v[176:191]
s_waitcnt vmcnt(12)
buffer_load_dwordx4 v[60:63], v2, s[16:19], s54 offen offset:2048 sc1
buffer_load_dwordx4 v[64:67], v2, s[16:19], s55 offen offset:2048 sc1
buffer_load_dwordx4 a[8:11], v2, s[16:19], s54 offen offset:3072 sc1
buffer_load_dwordx4 a[12:15], v2, s[16:19], s55 offen offset:3072 sc1
v_cndmask_b32 v12, 0, v42, s[50:51]
v_cndmask_b32 v13, 0, v43, s[50:51]
v_cndmask_b32 v14, 0, v44, s[50:51]
v_cndmask_b32 v15, 0, v45, s[50:51]
v_mfma_f32_32x32x16_bf16 v[96:111], a[16:19], v[68:71], v[96:111]
v_mfma_f32_32x32x16_bf16 v[144:159], a[16:19], v[72:75], v[144:159]
v_mfma_f32_32x32x16_bf16 v[112:127], a[20:23], v[68:71], v[112:127]
v_mfma_f32_32x32x16_bf16 v[160:175], a[20:23], v[72:75], v[160:175]
v_mfma_f32_32x32x16_bf16 v[128:143], v[12:15], v[68:71], v[128:143]
v_mfma_f32_32x32x16_bf16 v[176:191], v[12:15], v[72:75], v[176:191]
buffer_load_dwordx2 v[68:69], v5, s[16:19], s56 offen offset:0 sc1
buffer_load_dwordx2 v[70:71], v5, s[16:19], s56 offen offset:512 sc1
buffer_load_dwordx2 v[72:73], v5, s[16:19], s57 offen offset:0 sc1
buffer_load_dwordx2 v[74:75], v5, s[16:19], s57 offen offset:512 sc1
buffer_load_dwordx2 a[16:17], v5, s[16:19], s56 offen offset:1024 sc1
buffer_load_dwordx2 a[18:19], v5, s[16:19], s56 offen offset:1536 sc1
buffer_load_dwordx2 a[20:21], v5, s[16:19], s57 offen offset:1024 sc1
buffer_load_dwordx2 a[22:23], v5, s[16:19], s57 offen offset:1536 sc1
s_nop 2
v_add_f32 v128, v128, v136
v_add_f32 v129, v129, v137
v_add_f32 v130, v130, v138
v_add_f32 v131, v131, v139
v_add_f32 v132, v132, v140
v_add_f32 v133, v133, v141
v_add_f32 v134, v134, v142
v_add_f32 v135, v135, v143
v_add_f32 v176, v176, v184
v_add_f32 v177, v177, v185
v_add_f32 v178, v178, v186
v_add_f32 v179, v179, v187
v_add_f32 v180, v180, v188
v_add_f32 v181, v181, v189
v_add_f32 v182, v182, v190
v_add_f32 v183, v183, v191
s_waitcnt vmcnt(22)
s_waitcnt lgkmcnt(5)
v_mfma_f32_32x32x16_bf16 v[96:111], a[32:35], a[56:59], v[96:111]
v_mfma_f32_32x32x16_bf16 v[144:159], a[32:35], a[60:63], v[144:159]
s_waitcnt lgkmcnt(4)
v_mfma_f32_32x32x16_bf16 v[112:127], a[36:39], a[56:59], v[112:127]
v_mfma_f32_32x32x16_bf16 v[160:175], a[36:39], a[60:63], v[160:175]
s_waitcnt lgkmcnt(3)
v_mfma_f32_32x32x16_bf16 v[128:143], a[40:43], a[56:59], v[128:143]
v_mfma_f32_32x32x16_bf16 v[176:191], a[40:43], a[60:63], v[176:191]
ds_read_b128 a[32:35], v10 offset:5120
ds_read_b128 a[36:39], v10 offset:6144
ds_read_b128 a[40:43], v11 offset:7168
s_waitcnt vmcnt(20)
s_waitcnt lgkmcnt(5)
v_mfma_f32_32x32x16_bf16 v[96:111], a[44:47], v[84:87], v[96:111]
v_mfma_f32_32x32x16_bf16 v[144:159], a[44:47], v[88:91], v[144:159]
s_waitcnt lgkmcnt(4)
v_mfma_f32_32x32x16_bf16 v[112:127], a[48:51], v[84:87], v[112:127]
v_mfma_f32_32x32x16_bf16 v[160:175], a[48:51], v[88:91], v[160:175]
s_waitcnt lgkmcnt(3)
v_mfma_f32_32x32x16_bf16 v[128:143], a[52:55], v[84:87], v[128:143]
v_mfma_f32_32x32x16_bf16 v[176:191], a[52:55], v[88:91], v[176:191]
ds_read_b128 a[44:47], v10 offset:7680
ds_read_b128 a[48:51], v10 offset:8704
ds_read_b128 a[52:55], v11 offset:9728
s_waitcnt vmcnt(18)
s_waitcnt lgkmcnt(5)
v_mfma_f32_32x32x16_bf16 v[96:111], a[32:35], v[76:79], v[96:111]
v_mfma_f32_32x32x16_bf16 v[144:159], a[32:35], v[80:83], v[144:159]
s_waitcnt lgkmcnt(4)
v_mfma_f32_32x32x16_bf16 v[112:127], a[36:39], v[76:79], v[112:127]
v_mfma_f32_32x32x16_bf16 v[160:175], a[36:39], v[80:83], v[160:175]
s_waitcnt lgkmcnt(3)
v_mfma_f32_32x32x16_bf16 v[128:143], a[40:43], v[76:79], v[128:143]
v_mfma_f32_32x32x16_bf16 v[176:191], a[40:43], v[80:83], v[176:191]
ds_read_b128 a[32:35], v10 offset:10240
ds_read_b128 a[36:39], v10 offset:11264
ds_read_b128 a[40:43], v11 offset:12288
s_waitcnt vmcnt(16)
s_waitcnt lgkmcnt(5)
v_mfma_f32_32x32x16_bf16 v[96:111], a[44:47], a[24:27], v[96:111]
v_mfma_f32_32x32x16_bf16 v[144:159], a[44:47], a[28:31], v[144:159]
s_waitcnt lgkmcnt(4)
v_mfma_f32_32x32x16_bf16 v[112:127], a[48:51], a[24:27], v[112:127]
v_mfma_f32_32x32x16_bf16 v[160:175], a[48:51], a[28:31], v[160:175]
s_waitcnt lgkmcnt(3)
v_mfma_f32_32x32x16_bf16 v[128:143], a[52:55], a[24:27], v[128:143]
v_mfma_f32_32x32x16_bf16 v[176:191], a[52:55], a[28:31], v[176:191]
ds_read_b128 a[44:47], v10 offset:12800
ds_read_b128 a[48:51], v10 offset:13824
ds_read_b128 a[52:55], v11 offset:14848
s_waitcnt vmcnt(14)
s_waitcnt lgkmcnt(5)
v_mfma_f32_32x32x16_bf16 v[96:111], a[32:35], v[52:55], v[96:111]
v_mfma_f32_32x32x16_bf16 v[144:159], a[32:35], v[56:59], v[144:159]
s_waitcnt lgkmcnt(4)
v_mfma_f32_32x32x16_bf16 v[112:127], a[36:39], v[52:55], v[112:127]
v_mfma_f32_32x32x16_bf16 v[160:175], a[36:39], v[56:59], v[160:175]
s_waitcnt lgkmcnt(3)
v_mfma_f32_32x32x16_bf16 v[128:143], a[40:43], v[52:55], v[128:143]
v_mfma_f32_32x32x16_bf16 v[176:191], a[40:43], v[56:59], v[176:191]
ds_read_b128 a[32:35], v10 offset:15360
ds_read_b128 a[36:39], v10 offset:16384
ds_read_b128 a[40:43], v11 offset:17408
s_waitcnt vmcnt(12)
s_waitcnt lgkmcnt(5)
v_mfma_f32_32x32x16_bf16 v[96:111], a[44:47], a[0:3], v[96:111]
v_mfma_f32_32x32x16_bf16 v[144:159], a[44:47], a[4:7], v[144:159]
s_waitcnt lgkmcnt(4)
v_mfma_f32_32x32x16_bf16 v[112:127], a[48:51], a[0:3], v[112:127]
v_mfma_f32_32x32x16_bf16 v[160:175], a[48:51], a[4:7], v[160:175]
s_waitcnt lgkmcnt(3)
v_mfma_f32_32x32x16_bf16 v[128:143], a[52:55], a[0:3], v[128:143]
v_mfma_f32_32x32x16_bf16 v[176:191], a[52:55], a[4:7], v[176:191]
ds_read_b128 a[44:47], v10 offset:17920
ds_read_b128 a[48:51], v10 offset:18944
ds_read_b128 a[52:55], v11 offset:19968
s_waitcnt vmcnt(10)
s_waitcnt lgkmcnt(5)
v_mfma_f32_32x32x16_bf16 v[96:111], a[32:35], v[60:63], v[96:111]
v_mfma_f32_32x32x16_bf16 v[144:159], a[32:35], v[64:67], v[144:159]
s_waitcnt lgkmcnt(4)
v_mfma_f32_32x32x16_bf16 v[112:127], a[36:39], v[60:63], v[112:127]
v_mfma_f32_32x32x16_bf16 v[160:175], a[36:39], v[64:67], v[160:175]
s_waitcnt lgkmcnt(3)
v_mfma_f32_32x32x16_bf16 v[128:143], a[40:43], v[60:63], v[128:143]
v_mfma_f32_32x32x16_bf16 v[176:191], a[40:43], v[64:67], v[176:191]
ds_read_b128 a[32:35], v10 offset:20480
ds_read_b128 a[36:39], v10 offset:21504
ds_read_b128 a[40:43], v11 offset:22528
s_waitcnt vmcnt(8)
s_waitcnt lgkmcnt(5)
v_mfma_f32_32x32x16_bf16 v[96:111], a[44:47], a[8:11], v[96:111]
v_mfma_f32_32x32x16_bf16 v[144:159], a[44:47], a[12:15], v[144:159]
s_waitcnt lgkmcnt(4)
v_mfma_f32_32x32x16_bf16 v[112:127], a[48:51], a[8:11], v[112:127]
v_mfma_f32_32x32x16_bf16 v[160:175], a[48:51], a[12:15], v[160:175]
s_waitcnt lgkmcnt(3)
v_mfma_f32_32x32x16_bf16 v[128:143], a[52:55], a[8:11], v[128:143]
v_mfma_f32_32x32x16_bf16 v[176:191], a[52:55], a[12:15], v[176:191]
ds_read_b128 a[44:47], v10 offset:23040
ds_read_b128 a[48:51], v10 offset:24064
ds_read_b128 a[52:55], v11 offset:25088
s_waitcnt vmcnt(4)
s_waitcnt lgkmcnt(5)
v_mfma_f32_32x32x16_bf16 v[96:111], a[32:35], v[68:71], v[96:111]
v_mfma_f32_32x32x16_bf16 v[144:159], a[32:35], v[72:75], v[144:159]
s_waitcnt lgkmcnt(4)
v_mfma_f32_32x32x16_bf16 v[112:127], a[36:39], v[68:71], v[112:127]
v_mfma_f32_32x32x16_bf16 v[160:175], a[36:39], v[72:75], v[160:175]
s_waitcnt lgkmcnt(3)
v_mfma_f32_32x32x16_bf16 v[128:143], a[40:43], v[68:71], v[128:143]
v_mfma_f32_32x32x16_bf16 v[176:191], a[40:43], v[72:75], v[176:191]
s_waitcnt vmcnt(0)
s_waitcnt lgkmcnt(2)
v_mfma_f32_32x32x16_bf16 v[96:111], a[44:47], a[16:19], v[96:111]
v_mfma_f32_32x32x16_bf16 v[144:159], a[44:47], a[20:23], v[144:159]
s_waitcnt lgkmcnt(1)
v_mfma_f32_32x32x16_bf16 v[112:127], a[48:51], a[16:19], v[112:127]
v_mfma_f32_32x32x16_bf16 v[160:175], a[48:51], a[20:23], v[160:175]
s_waitcnt lgkmcnt(0)
v_mfma_f32_32x32x16_bf16 v[128:143], a[52:55], a[16:19], v[128:143]
v_mfma_f32_32x32x16_bf16 v[176:191], a[52:55], a[20:23], v[176:191]
s_cmp_lg_u32 s32, 0
s_cbranch_scc1 G_RED1
s_nop 5
ds_write_b128 v10, v[116:119] offset:0
ds_write_b128 v10, v[120:123] offset:1024
ds_write_b128 v10, v[124:127] offset:2048
ds_write_b128 v10, v[128:131] offset:3072
ds_write_b128 v10, v[132:135] offset:4096
ds_write_b128 v10, v[144:147] offset:5120
ds_write_b128 v10, v[148:151] offset:6144
ds_write_b128 v10, v[152:155] offset:7168
ds_write_b128 v10, v[156:159] offset:8192
ds_write_b128 v10, v[160:163] offset:9216
ds_write_b128 v10, v[164:167] offset:10240
ds_write_b128 v10, v[168:171] offset:11264
ds_write_b128 v10, v[172:175] offset:12288
ds_write_b128 v10, v[176:179] offset:13312
ds_write_b128 v10, v[180:183] offset:14336
s_waitcnt lgkmcnt(0)
s_barrier
v_add_u32 v17, 28160, v2
ds_read_b128 v[38:41], v17 offset:10240
ds_read_b128 v[42:45], v17 offset:11264
ds_read_b128 v[46:49], v17 offset:12288
ds_read_b128 v[50:53], v17 offset:13312
ds_read_b128 v[54:57], v17 offset:14336
v_add_u32 v18, 56320, v2
ds_read_b128 v[58:61], v18 offset:5120
ds_read_b128 v[62:65], v18 offset:6144
ds_read_b128 v[66:69], v18 offset:7168
ds_read_b128 v[70:73], v18 offset:8192
ds_read_b128 v[74:77], v18 offset:9216
v_add_u32 v19, 84480, v2
ds_read_b128 v[78:81], v19 offset:0
ds_read_b128 v[82:85], v19 offset:1024
ds_read_b128 v[86:89], v19 offset:2048
ds_read_b128 v[90:93], v19 offset:3072
ds_read_b128 v[12:15], v19 offset:4096
v_lshlrev_b32 v20, 16, v28
v_and_b32 v21, 0xffff0000, v28
v_lshlrev_b32 v22, 16, v29
v_and_b32 v23, 0xffff0000, v29
v_add_f32 v96, v96, v20
v_add_f32 v97, v97, v21
v_add_f32 v98, v98, v22
v_add_f32 v99, v99, v23
v_lshlrev_b32 v20, 16, v30
v_and_b32 v21, 0xffff0000, v30
v_lshlrev_b32 v22, 16, v31
v_and_b32 v23, 0xffff0000, v31
v_add_f32 v100, v100, v20
v_add_f32 v101, v101, v21
v_add_f32 v102, v102, v22
v_add_f32 v103, v103, v23
v_lshlrev_b32 v20, 16, v32
v_and_b32 v21, 0xffff0000, v32
v_lshlrev_b32 v22, 16, v33
v_and_b32 v23, 0xffff0000, v33
v_add_f32 v104, v104, v20
v_add_f32 v105, v105, v21
v_add_f32 v106, v106, v22
v_add_f32 v107, v107, v23
v_lshlrev_b32 v20, 16, v34
v_and_b32 v21, 0xffff0000, v34
v_lshlrev_b32 v22, 16, v35
v_and_b32 v23, 0xffff0000, v35
v_add_f32 v108, v108, v20
v_add_f32 v109, v109, v21
v_add_f32 v110, v110, v22
v_add_f32 v111, v111, v23
v_lshlrev_b32 v20, 16, v36
v_and_b32 v21, 0xffff0000, v36
v_lshlrev_b32 v22, 16, v37
v_and_b32 v23, 0xffff0000, v37
v_add_f32 v112, v112, v20
v_add_f32 v113, v113, v21
v_add_f32 v114, v114, v22
v_add_f32 v115, v115, v23
s_waitcnt lgkmcnt(14)
v_add_f32 v96, v96, v38
v_add_f32 v97, v97, v39
v_add_f32 v98, v98, v40
v_add_f32 v99, v99, v41
s_waitcnt lgkmcnt(13)
v_add_f32 v100, v100, v42
v_add_f32 v101, v101, v43
v_add_f32 v102, v102, v44
v_add_f32 v103, v103, v45
s_waitcnt lgkmcnt(12)
v_add_f32 v104, v104, v46
v_add_f32 v105, v105, v47
v_add_f32 v106, v106, v48
v_add_f32 v107, v107, v49
s_waitcnt lgkmcnt(11)
v_add_f32 v108, v108, v50
v_add_f32 v109, v109, v51
v_add_f32 v110, v110, v52
v_add_f32 v111, v111, v53
s_waitcnt lgkmcnt(10)
v_add_f32 v112, v112, v54
v_add_f32 v113, v113, v55
v_add_f32 v114, v114, v56
v_add_f32 v115, v115, v57
s_waitcnt lgkmcnt(9)
v_add_f32 v96, v96, v58
v_add_f32 v97, v97, v59
v_add_f32 v98, v98, v60
v_add_f32 v99, v99, v61
s_waitcnt lgkmcnt(8)
v_add_f32 v100, v100, v62
v_add_f32 v101, v101, v63
v_add_f32 v102, v102, v64
v_add_f32 v103, v103, v65
s_waitcnt lgkmcnt(7)
v_add_f32 v104, v104, v66
v_add_f32 v105, v105, v67
v_add_f32 v106, v106, v68
v_add_f32 v107, v107, v69
s_waitcnt lgkmcnt(6)
v_add_f32 v108, v108, v70
v_add_f32 v109, v109, v71
v_add_f32 v110, v110, v72
v_add_f32 v111, v111, v73
s_waitcnt lgkmcnt(5)
v_add_f32 v112, v112, v74
v_add_f32 v113, v113, v75
v_add_f32 v114, v114, v76
v_add_f32 v115, v115, v77
s_waitcnt lgkmcnt(4)
v_add_f32 v96, v96, v78
v_add_f32 v97, v97, v79
v_add_f32 v98, v98, v80
v_add_f32 v99, v99, v81
v_cvt_pk_bf16_f32 v96, v96, v97
v_cvt_pk_bf16_f32 v97, v98, v99
ds_write_b64 v9, v[96:97] offset:0
s_waitcnt lgkmcnt(4)
v_add_f32 v100, v100, v82
v_add_f32 v101, v101, v83
v_add_f32 v102, v102, v84
v_add_f32 v103, v103, v85
v_cvt_pk_bf16_f32 v100, v100, v101
v_cvt_pk_bf16_f32 v101, v102, v103
ds_write_b64 v9, v[100:101] offset:16
s_waitcnt lgkmcnt(4)
v_add_f32 v104, v104, v86
v_add_f32 v105, v105, v87
v_add_f32 v106, v106, v88
v_add_f32 v107, v107, v89
v_cvt_pk_bf16_f32 v104, v104, v105
v_cvt_pk_bf16_f32 v105, v106, v107
ds_write_b64 v9, v[104:105] offset:32
s_waitcnt lgkmcnt(4)
v_add_f32 v108, v108, v90
v_add_f32 v109, v109, v91
v_add_f32 v110, v110, v92
v_add_f32 v111, v111, v93
v_cvt_pk_bf16_f32 v108, v108, v109
v_cvt_pk_bf16_f32 v109, v110, v111
ds_write_b64 v9, v[108:109] offset:48
s_waitcnt lgkmcnt(4)
v_add_f32 v112, v112, v12
v_add_f32 v113, v113, v13
v_add_f32 v114, v114, v14
v_add_f32 v115, v115, v15
v_cvt_pk_bf16_f32 v112, v112, v113
v_cvt_pk_bf16_f32 v113, v114, v115
ds_write_b64 v9, v[112:113] offset:64
s_waitcnt lgkmcnt(0)
ds_read_b128 v[48:51], v10 offset:25600
ds_read_b128 v[52:55], v10 offset:26624
ds_read_b128 v[56:59], v10 offset:27648
s_waitcnt lgkmcnt(2)
buffer_store_dwordx4 v[48:51], v6, s[20:23], s47 offen
s_waitcnt lgkmcnt(1)
buffer_store_dwordx4 v[52:55], v7, s[20:23], s47 offen
s_mov_b32 exec_hi, 0
s_waitcnt lgkmcnt(0)
buffer_store_dwordx4 v[56:59], v8, s[20:23], s47 offen
s_endpgm
G_RED1:
s_cmp_lg_u32 s32, 1
s_cbranch_scc1 G_RED2
s_nop 0
ds_write_b128 v10, v[96:99] offset:10240
ds_write_b128 v10, v[100:103] offset:11264
ds_write_b128 v10, v[104:107] offset:12288
ds_write_b128 v10, v[108:111] offset:13312
ds_write_b128 v10, v[112:115] offset:14336
ds_write_b128 v10, v[144:147] offset:0
ds_write_b128 v10, v[148:151] offset:1024
ds_write_b128 v10, v[152:155] offset:2048
ds_write_b128 v10, v[156:159] offset:3072
ds_write_b128 v10, v[160:163] offset:4096
ds_write_b128 v10, v[164:167] offset:5120
ds_write_b128 v10, v[168:171] offset:6144
ds_write_b128 v10, v[172:175] offset:7168
ds_write_b128 v10, v[176:179] offset:8192
ds_write_b128 v10, v[180:183] offset:9216
s_waitcnt lgkmcnt(0)
s_barrier
v_add_u32 v17, 56320, v2
ds_read_b128 v[38:41], v17 offset:10240
ds_read_b128 v[42:45], v17 offset:11264
ds_read_b128 v[46:49], v17 offset:12288
ds_read_b128 v[50:53], v17 offset:13312
ds_read_b128 v[54:57], v17 offset:14336
v_add_u32 v18, 84480, v2
ds_read_b128 v[58:61], v18 offset:5120
ds_read_b128 v[62:65], v18 offset:6144
ds_read_b128 v[66:69], v18 offset:7168
ds_read_b128 v[70:73], v18 offset:8192
ds_read_b128 v[74:77], v18 offset:9216
v_add_u32 v19, 0, v2
ds_read_b128 v[78:81], v19 offset:0
ds_read_b128 v[82:85], v19 offset:1024
ds_read_b128 v[86:89], v19 offset:2048
ds_read_b128 v[90:93], v19 offset:3072
ds_read_b128 v[12:15], v19 offset:4096
v_lshlrev_b32 v20, 16, v28
v_and_b32 v21, 0xffff0000, v28
v_lshlrev_b32 v22, 16, v29
v_and_b32 v23, 0xffff0000, v29
v_add_f32 v116, v116, v20
v_add_f32 v117, v117, v21
v_add_f32 v118, v118, v22
v_add_f32 v119, v119, v23
v_lshlrev_b32 v20, 16, v30
v_and_b32 v21, 0xffff0000, v30
v_lshlrev_b32 v22, 16, v31
v_and_b32 v23, 0xffff0000, v31
v_add_f32 v120, v120, v20
v_add_f32 v121, v121, v21
v_add_f32 v122, v122, v22
v_add_f32 v123, v123, v23
v_lshlrev_b32 v20, 16, v32
v_and_b32 v21, 0xffff0000, v32
v_lshlrev_b32 v22, 16, v33
v_and_b32 v23, 0xffff0000, v33
v_add_f32 v124, v124, v20
v_add_f32 v125, v125, v21
v_add_f32 v126, v126, v22
v_add_f32 v127, v127, v23
v_lshlrev_b32 v20, 16, v34
v_and_b32 v21, 0xffff0000, v34
v_lshlrev_b32 v22, 16, v35
v_and_b32 v23, 0xffff0000, v35
v_add_f32 v128, v128, v20
v_add_f32 v129, v129, v21
v_add_f32 v130, v130, v22
v_add_f32 v131, v131, v23
v_lshlrev_b32 v20, 16, v36
v_and_b32 v21, 0xffff0000, v36
v_lshlrev_b32 v22, 16, v37
v_and_b32 v23, 0xffff0000, v37
v_add_f32 v132, v132, v20
v_add_f32 v133, v133, v21
v_add_f32 v134, v134, v22
v_add_f32 v135, v135, v23
s_waitcnt lgkmcnt(14)
v_add_f32 v116, v116, v38
v_add_f32 v117, v117, v39
v_add_f32 v118, v118, v40
v_add_f32 v119, v119, v41
s_waitcnt lgkmcnt(13)
v_add_f32 v120, v120, v42
v_add_f32 v121, v121, v43
v_add_f32 v122, v122, v44
v_add_f32 v123, v123, v45
s_waitcnt lgkmcnt(12)
v_add_f32 v124, v124, v46
v_add_f32 v125, v125, v47
v_add_f32 v126, v126, v48
v_add_f32 v127, v127, v49
s_waitcnt lgkmcnt(11)
v_add_f32 v128, v128, v50
v_add_f32 v129, v129, v51
v_add_f32 v130, v130, v52
v_add_f32 v131, v131, v53
s_waitcnt lgkmcnt(10)
v_add_f32 v132, v132, v54
v_add_f32 v133, v133, v55
v_add_f32 v134, v134, v56
v_add_f32 v135, v135, v57
s_waitcnt lgkmcnt(9)
v_add_f32 v116, v116, v58
v_add_f32 v117, v117, v59
v_add_f32 v118, v118, v60
v_add_f32 v119, v119, v61
s_waitcnt lgkmcnt(8)
v_add_f32 v120, v120, v62
v_add_f32 v121, v121, v63
v_add_f32 v122, v122, v64
v_add_f32 v123, v123, v65
s_waitcnt lgkmcnt(7)
v_add_f32 v124, v124, v66
v_add_f32 v125, v125, v67
v_add_f32 v126, v126, v68
v_add_f32 v127, v127, v69
s_waitcnt lgkmcnt(6)
v_add_f32 v128, v128, v70
v_add_f32 v129, v129, v71
v_add_f32 v130, v130, v72
v_add_f32 v131, v131, v73
s_waitcnt lgkmcnt(5)
v_add_f32 v132, v132, v74
v_add_f32 v133, v133, v75
v_add_f32 v134, v134, v76
v_add_f32 v135, v135, v77
s_waitcnt lgkmcnt(4)
v_add_f32 v116, v116, v78
v_add_f32 v117, v117, v79
v_add_f32 v118, v118, v80
v_add_f32 v119, v119, v81
v_cvt_pk_bf16_f32 v116, v116, v117
v_cvt_pk_bf16_f32 v117, v118, v119
ds_write_b64 v9, v[116:117] offset:0
s_waitcnt lgkmcnt(4)
v_add_f32 v120, v120, v82
v_add_f32 v121, v121, v83
v_add_f32 v122, v122, v84
v_add_f32 v123, v123, v85
v_cvt_pk_bf16_f32 v120, v120, v121
v_cvt_pk_bf16_f32 v121, v122, v123
ds_write_b64 v9, v[120:121] offset:16
s_waitcnt lgkmcnt(4)
v_add_f32 v124, v124, v86
v_add_f32 v125, v125, v87
v_add_f32 v126, v126, v88
v_add_f32 v127, v127, v89
v_cvt_pk_bf16_f32 v124, v124, v125
v_cvt_pk_bf16_f32 v125, v126, v127
ds_write_b64 v9, v[124:125] offset:32
s_waitcnt lgkmcnt(4)
v_add_f32 v128, v128, v90
v_add_f32 v129, v129, v91
v_add_f32 v130, v130, v92
v_add_f32 v131, v131, v93
v_cvt_pk_bf16_f32 v128, v128, v129
v_cvt_pk_bf16_f32 v129, v130, v131
ds_write_b64 v9, v[128:129] offset:48
s_waitcnt lgkmcnt(4)
v_add_f32 v132, v132, v12
v_add_f32 v133, v133, v13
v_add_f32 v134, v134, v14
v_add_f32 v135, v135, v15
v_cvt_pk_bf16_f32 v132, v132, v133
v_cvt_pk_bf16_f32 v133, v134, v135
ds_write_b64 v9, v[132:133] offset:64
s_waitcnt lgkmcnt(0)
ds_read_b128 v[48:51], v10 offset:25600
ds_read_b128 v[52:55], v10 offset:26624
ds_read_b128 v[56:59], v10 offset:27648
s_waitcnt lgkmcnt(2)
buffer_store_dwordx4 v[48:51], v6, s[20:23], s47 offen
s_waitcnt lgkmcnt(1)
buffer_store_dwordx4 v[52:55], v7, s[20:23], s47 offen
s_mov_b32 exec_hi, 0
s_waitcnt lgkmcnt(0)
buffer_store_dwordx4 v[56:59], v8, s[20:23], s47 offen
s_endpgm
G_RED2:
s_cmp_lg_u32 s32, 2
s_cbranch_scc1 G_RED3
s_nop 0
ds_write_b128 v10, v[96:99] offset:5120
ds_write_b128 v10, v[100:103] offset:6144
ds_write_b128 v10, v[104:107] offset:7168
ds_write_b128 v10, v[108:111] offset:8192
ds_write_b128 v10, v[112:115] offset:9216
ds_write_b128 v10, v[116:119] offset:10240
ds_write_b128 v10, v[120:123] offset:11264
ds_write_b128 v10, v[124:127] offset:12288
ds_write_b128 v10, v[128:131] offset:13312
ds_write_b128 v10, v[132:135] offset:14336
ds_write_b128 v10, v[164:167] offset:0
ds_write_b128 v10, v[168:171] offset:1024
ds_write_b128 v10, v[172:175] offset:2048
ds_write_b128 v10, v[176:179] offset:3072
ds_write_b128 v10, v[180:183] offset:4096
s_waitcnt lgkmcnt(0)
s_barrier
v_add_u32 v17, 84480, v2
ds_read_b128 v[38:41], v17 offset:10240
ds_read_b128 v[42:45], v17 offset:11264
ds_read_b128 v[46:49], v17 offset:12288
ds_read_b128 v[50:53], v17 offset:13312
ds_read_b128 v[54:57], v17 offset:14336
v_add_u32 v18, 0, v2
ds_read_b128 v[58:61], v18 offset:5120
ds_read_b128 v[62:65], v18 offset:6144
ds_read_b128 v[66:69], v18 offset:7168
ds_read_b128 v[70:73], v18 offset:8192
ds_read_b128 v[74:77], v18 offset:9216
v_add_u32 v19, 28160, v2
ds_read_b128 v[78:81], v19 offset:0
ds_read_b128 v[82:85], v19 offset:1024
ds_read_b128 v[86:89], v19 offset:2048
ds_read_b128 v[90:93], v19 offset:3072
ds_read_b128 v[12:15], v19 offset:4096
v_lshlrev_b32 v20, 16, v28
v_and_b32 v21, 0xffff0000, v28
v_lshlrev_b32 v22, 16, v29
v_and_b32 v23, 0xffff0000, v29
v_add_f32 v144, v144, v20
v_add_f32 v145, v145, v21
v_add_f32 v146, v146, v22
v_add_f32 v147, v147, v23
v_lshlrev_b32 v20, 16, v30
v_and_b32 v21, 0xffff0000, v30
v_lshlrev_b32 v22, 16, v31
v_and_b32 v23, 0xffff0000, v31
v_add_f32 v148, v148, v20
v_add_f32 v149, v149, v21
v_add_f32 v150, v150, v22
v_add_f32 v151, v151, v23
v_lshlrev_b32 v20, 16, v32
v_and_b32 v21, 0xffff0000, v32
v_lshlrev_b32 v22, 16, v33
v_and_b32 v23, 0xffff0000, v33
v_add_f32 v152, v152, v20
v_add_f32 v153, v153, v21
v_add_f32 v154, v154, v22
v_add_f32 v155, v155, v23
v_lshlrev_b32 v20, 16, v34
v_and_b32 v21, 0xffff0000, v34
v_lshlrev_b32 v22, 16, v35
v_and_b32 v23, 0xffff0000, v35
v_add_f32 v156, v156, v20
v_add_f32 v157, v157, v21
v_add_f32 v158, v158, v22
v_add_f32 v159, v159, v23
v_lshlrev_b32 v20, 16, v36
v_and_b32 v21, 0xffff0000, v36
v_lshlrev_b32 v22, 16, v37
v_and_b32 v23, 0xffff0000, v37
v_add_f32 v160, v160, v20
v_add_f32 v161, v161, v21
v_add_f32 v162, v162, v22
v_add_f32 v163, v163, v23
s_waitcnt lgkmcnt(14)
v_add_f32 v144, v144, v38
v_add_f32 v145, v145, v39
v_add_f32 v146, v146, v40
v_add_f32 v147, v147, v41
s_waitcnt lgkmcnt(13)
v_add_f32 v148, v148, v42
v_add_f32 v149, v149, v43
v_add_f32 v150, v150, v44
v_add_f32 v151, v151, v45
s_waitcnt lgkmcnt(12)
v_add_f32 v152, v152, v46
v_add_f32 v153, v153, v47
v_add_f32 v154, v154, v48
v_add_f32 v155, v155, v49
s_waitcnt lgkmcnt(11)
v_add_f32 v156, v156, v50
v_add_f32 v157, v157, v51
v_add_f32 v158, v158, v52
v_add_f32 v159, v159, v53
s_waitcnt lgkmcnt(10)
v_add_f32 v160, v160, v54
v_add_f32 v161, v161, v55
v_add_f32 v162, v162, v56
v_add_f32 v163, v163, v57
s_waitcnt lgkmcnt(9)
v_add_f32 v144, v144, v58
v_add_f32 v145, v145, v59
v_add_f32 v146, v146, v60
v_add_f32 v147, v147, v61
s_waitcnt lgkmcnt(8)
v_add_f32 v148, v148, v62
v_add_f32 v149, v149, v63
v_add_f32 v150, v150, v64
v_add_f32 v151, v151, v65
s_waitcnt lgkmcnt(7)
v_add_f32 v152, v152, v66
v_add_f32 v153, v153, v67
v_add_f32 v154, v154, v68
v_add_f32 v155, v155, v69
s_waitcnt lgkmcnt(6)
v_add_f32 v156, v156, v70
v_add_f32 v157, v157, v71
v_add_f32 v158, v158, v72
v_add_f32 v159, v159, v73
s_waitcnt lgkmcnt(5)
v_add_f32 v160, v160, v74
v_add_f32 v161, v161, v75
v_add_f32 v162, v162, v76
v_add_f32 v163, v163, v77
s_waitcnt lgkmcnt(4)
v_add_f32 v144, v144, v78
v_add_f32 v145, v145, v79
v_add_f32 v146, v146, v80
v_add_f32 v147, v147, v81
v_cvt_pk_bf16_f32 v144, v144, v145
v_cvt_pk_bf16_f32 v145, v146, v147
ds_write_b64 v9, v[144:145] offset:0
s_waitcnt lgkmcnt(4)
v_add_f32 v148, v148, v82
v_add_f32 v149, v149, v83
v_add_f32 v150, v150, v84
v_add_f32 v151, v151, v85
v_cvt_pk_bf16_f32 v148, v148, v149
v_cvt_pk_bf16_f32 v149, v150, v151
ds_write_b64 v9, v[148:149] offset:16
s_waitcnt lgkmcnt(4)
v_add_f32 v152, v152, v86
v_add_f32 v153, v153, v87
v_add_f32 v154, v154, v88
v_add_f32 v155, v155, v89
v_cvt_pk_bf16_f32 v152, v152, v153
v_cvt_pk_bf16_f32 v153, v154, v155
ds_write_b64 v9, v[152:153] offset:32
s_waitcnt lgkmcnt(4)
v_add_f32 v156, v156, v90
v_add_f32 v157, v157, v91
v_add_f32 v158, v158, v92
v_add_f32 v159, v159, v93
v_cvt_pk_bf16_f32 v156, v156, v157
v_cvt_pk_bf16_f32 v157, v158, v159
ds_write_b64 v9, v[156:157] offset:48
s_waitcnt lgkmcnt(4)
v_add_f32 v160, v160, v12
v_add_f32 v161, v161, v13
v_add_f32 v162, v162, v14
v_add_f32 v163, v163, v15
v_cvt_pk_bf16_f32 v160, v160, v161
v_cvt_pk_bf16_f32 v161, v162, v163
ds_write_b64 v9, v[160:161] offset:64
s_waitcnt lgkmcnt(0)
ds_read_b128 v[48:51], v10 offset:25600
ds_read_b128 v[52:55], v10 offset:26624
ds_read_b128 v[56:59], v10 offset:27648
s_waitcnt lgkmcnt(2)
buffer_store_dwordx4 v[48:51], v6, s[20:23], s47 offen
s_waitcnt lgkmcnt(1)
buffer_store_dwordx4 v[52:55], v7, s[20:23], s47 offen
s_mov_b32 exec_hi, 0
s_waitcnt lgkmcnt(0)
buffer_store_dwordx4 v[56:59], v8, s[20:23], s47 offen
s_endpgm
G_RED3:
s_nop 2
ds_write_b128 v10, v[96:99] offset:0
ds_write_b128 v10, v[100:103] offset:1024
ds_write_b128 v10, v[104:107] offset:2048
ds_write_b128 v10, v[108:111] offset:3072
ds_write_b128 v10, v[112:115] offset:4096
ds_write_b128 v10, v[116:119] offset:5120
ds_write_b128 v10, v[120:123] offset:6144
ds_write_b128 v10, v[124:127] offset:7168
ds_write_b128 v10, v[128:131] offset:8192
ds_write_b128 v10, v[132:135] offset:9216
ds_write_b128 v10, v[144:147] offset:10240
ds_write_b128 v10, v[148:151] offset:11264
ds_write_b128 v10, v[152:155] offset:12288
ds_write_b128 v10, v[156:159] offset:13312
ds_write_b128 v10, v[160:163] offset:14336
s_waitcnt lgkmcnt(0)
s_barrier
v_add_u32 v17, 0, v2
ds_read_b128 v[38:41], v17 offset:10240
ds_read_b128 v[42:45], v17 offset:11264
ds_read_b128 v[46:49], v17 offset:12288
ds_read_b128 v[50:53], v17 offset:13312
ds_read_b128 v[54:57], v17 offset:14336
v_add_u32 v18, 28160, v2
ds_read_b128 v[58:61], v18 offset:5120
ds_read_b128 v[62:65], v18 offset:6144
ds_read_b128 v[66:69], v18 offset:7168
ds_read_b128 v[70:73], v18 offset:8192
ds_read_b128 v[74:77], v18 offset:9216
v_add_u32 v19, 56320, v2
ds_read_b128 v[78:81], v19 offset:0
ds_read_b128 v[82:85], v19 offset:1024
ds_read_b128 v[86:89], v19 offset:2048
ds_read_b128 v[90:93], v19 offset:3072
ds_read_b128 v[12:15], v19 offset:4096
v_lshlrev_b32 v20, 16, v28
v_and_b32 v21, 0xffff0000, v28
v_lshlrev_b32 v22, 16, v29
v_and_b32 v23, 0xffff0000, v29
v_add_f32 v164, v164, v20
v_add_f32 v165, v165, v21
v_add_f32 v166, v166, v22
v_add_f32 v167, v167, v23
v_lshlrev_b32 v20, 16, v30
v_and_b32 v21, 0xffff0000, v30
v_lshlrev_b32 v22, 16, v31
v_and_b32 v23, 0xffff0000, v31
v_add_f32 v168, v168, v20
v_add_f32 v169, v169, v21
v_add_f32 v170, v170, v22
v_add_f32 v171, v171, v23
v_lshlrev_b32 v20, 16, v32
v_and_b32 v21, 0xffff0000, v32
v_lshlrev_b32 v22, 16, v33
v_and_b32 v23, 0xffff0000, v33
v_add_f32 v172, v172, v20
v_add_f32 v173, v173, v21
v_add_f32 v174, v174, v22
v_add_f32 v175, v175, v23
v_lshlrev_b32 v20, 16, v34
v_and_b32 v21, 0xffff0000, v34
v_lshlrev_b32 v22, 16, v35
v_and_b32 v23, 0xffff0000, v35
v_add_f32 v176, v176, v20
v_add_f32 v177, v177, v21
v_add_f32 v178, v178, v22
v_add_f32 v179, v179, v23
v_lshlrev_b32 v20, 16, v36
v_and_b32 v21, 0xffff0000, v36
v_lshlrev_b32 v22, 16, v37
v_and_b32 v23, 0xffff0000, v37
v_add_f32 v180, v180, v20
v_add_f32 v181, v181, v21
v_add_f32 v182, v182, v22
v_add_f32 v183, v183, v23
s_waitcnt lgkmcnt(14)
v_add_f32 v164, v164, v38
v_add_f32 v165, v165, v39
v_add_f32 v166, v166, v40
v_add_f32 v167, v167, v41
s_waitcnt lgkmcnt(13)
v_add_f32 v168, v168, v42
v_add_f32 v169, v169, v43
v_add_f32 v170, v170, v44
v_add_f32 v171, v171, v45
s_waitcnt lgkmcnt(12)
v_add_f32 v172, v172, v46
v_add_f32 v173, v173, v47
v_add_f32 v174, v174, v48
v_add_f32 v175, v175, v49
s_waitcnt lgkmcnt(11)
v_add_f32 v176, v176, v50
v_add_f32 v177, v177, v51
v_add_f32 v178, v178, v52
v_add_f32 v179, v179, v53
s_waitcnt lgkmcnt(10)
v_add_f32 v180, v180, v54
v_add_f32 v181, v181, v55
v_add_f32 v182, v182, v56
v_add_f32 v183, v183, v57
s_waitcnt lgkmcnt(9)
v_add_f32 v164, v164, v58
v_add_f32 v165, v165, v59
v_add_f32 v166, v166, v60
v_add_f32 v167, v167, v61
s_waitcnt lgkmcnt(8)
v_add_f32 v168, v168, v62
v_add_f32 v169, v169, v63
v_add_f32 v170, v170, v64
v_add_f32 v171, v171, v65
s_waitcnt lgkmcnt(7)
v_add_f32 v172, v172, v66
v_add_f32 v173, v173, v67
v_add_f32 v174, v174, v68
v_add_f32 v175, v175, v69
s_waitcnt lgkmcnt(6)
v_add_f32 v176, v176, v70
v_add_f32 v177, v177, v71
v_add_f32 v178, v178, v72
v_add_f32 v179, v179, v73
s_waitcnt lgkmcnt(5)
v_add_f32 v180, v180, v74
v_add_f32 v181, v181, v75
v_add_f32 v182, v182, v76
v_add_f32 v183, v183, v77
s_waitcnt lgkmcnt(4)
v_add_f32 v164, v164, v78
v_add_f32 v165, v165, v79
v_add_f32 v166, v166, v80
v_add_f32 v167, v167, v81
v_cvt_pk_bf16_f32 v164, v164, v165
v_cvt_pk_bf16_f32 v165, v166, v167
ds_write_b64 v9, v[164:165] offset:0
s_waitcnt lgkmcnt(4)
v_add_f32 v168, v168, v82
v_add_f32 v169, v169, v83
v_add_f32 v170, v170, v84
v_add_f32 v171, v171, v85
v_cvt_pk_bf16_f32 v168, v168, v169
v_cvt_pk_bf16_f32 v169, v170, v171
ds_write_b64 v9, v[168:169] offset:16
s_waitcnt lgkmcnt(4)
v_add_f32 v172, v172, v86
v_add_f32 v173, v173, v87
v_add_f32 v174, v174, v88
v_add_f32 v175, v175, v89
v_cvt_pk_bf16_f32 v172, v172, v173
v_cvt_pk_bf16_f32 v173, v174, v175
ds_write_b64 v9, v[172:173] offset:32
s_waitcnt lgkmcnt(4)
v_add_f32 v176, v176, v90
v_add_f32 v177, v177, v91
v_add_f32 v178, v178, v92
v_add_f32 v179, v179, v93
v_cvt_pk_bf16_f32 v176, v176, v177
v_cvt_pk_bf16_f32 v177, v178, v179
ds_write_b64 v9, v[176:177] offset:48
s_waitcnt lgkmcnt(4)
v_add_f32 v180, v180, v12
v_add_f32 v181, v181, v13
v_add_f32 v182, v182, v14
v_add_f32 v183, v183, v15
v_cvt_pk_bf16_f32 v180, v180, v181
v_cvt_pk_bf16_f32 v181, v182, v183
ds_write_b64 v9, v[180:181] offset:64
s_waitcnt lgkmcnt(0)
ds_read_b128 v[48:51], v10 offset:25600
ds_read_b128 v[52:55], v10 offset:26624
ds_read_b128 v[56:59], v10 offset:27648
s_waitcnt lgkmcnt(2)
buffer_store_dwordx4 v[48:51], v6, s[20:23], s47 offen
s_waitcnt lgkmcnt(1)
buffer_store_dwordx4 v[52:55], v7, s[20:23], s47 offen
s_mov_b32 exec_hi, 0
s_waitcnt lgkmcnt(0)
buffer_store_dwordx4 v[56:59], v8, s[20:23], s47 offen
s_endpgm
K2_T:
s_sub_u32 s40, s32, 4
s_lshl_b32 s37, s36, 8
s_sub_u32 s37, s37, 256
s_lshl_b32 s37, s37, 3
s_mul_i32 s38, s35, 81920
s_add_u32 s41, s37, s38
s_add_u32 s41, s41, 2621440
v_lshlrev_b32 v6, 4, v1
s_lshl_b32 s38, s40, 10
s_add_u32 s41, s41, s38
s_add_u32 m0, s38, 112640
s_add_u32 s37, s41, 0
buffer_load_dwordx4 v6, s[16:19], s37 offen lds
s_add_u32 m0, s38, 116768
s_add_u32 s37, s41, 16384
buffer_load_dwordx4 v6, s[16:19], s37 offen lds
s_add_u32 m0, s38, 120896
s_add_u32 s37, s41, 32768
buffer_load_dwordx4 v6, s[16:19], s37 offen lds
s_add_u32 m0, s38, 125024
s_add_u32 s37, s41, 49152
buffer_load_dwordx4 v6, s[16:19], s37 offen lds
s_add_u32 m0, s38, 129152
s_add_u32 s37, s41, 65536
buffer_load_dwordx4 v6, s[16:19], s37 offen lds
v_lshrrev_b32 v5, 5, v1
v_and_b32 v7, 31, v1
v_lshlrev_b32 v8, 3, v7
v_lshl_add_u32 v4, v5, 15, v8
s_lshl_b32 s37, s36, 3
s_lshl_b32 s39, s40, 1
s_add_u32 s37, s37, s39
s_lshl_b32 s37, s37, 8
s_mul_i32 s39, s35, 81920
s_add_u32 s37, s37, s39
s_add_u32 s37, s37, 0
s_add_u32 s39, s37, 0
buffer_load_dwordx2 v[16:17], v4, s[16:19], s39 offen
s_add_u32 s39, s37, 16384
buffer_load_dwordx2 v[18:19], v4, s[16:19], s39 offen
s_add_u32 s39, s37, 65536
buffer_load_dwordx2 v[20:21], v8, s[16:19], s39 offen
s_add_u32 s39, s37, 256
buffer_load_dwordx2 v[22:23], v4, s[16:19], s39 offen
s_add_u32 s39, s37, 16640
buffer_load_dwordx2 v[24:25], v4, s[16:19], s39 offen
s_add_u32 s39, s37, 65792
buffer_load_dwordx2 v[26:27], v8, s[16:19], s39 offen
s_lshl_b32 s37, s40, 2
s_add_u32 s37, s37, 162240
v_mov_b32 v47, s37
v_mov_b32 v10, 0
ds_write_b32 v47, v10
ds_write_b32 v47, v10 offset:16
s_waitcnt lgkmcnt(0)
s_barrier
s_setprio 2
s_cmp_eq_u32 s36, 0
s_cselect_b32 s37, 0xc780, 0
s_cmp_lt_u32 s40, 2
s_cselect_b32 s37, s37, 0
v_mov_b32 v10, s37
v_mov_b32 v11, 0
v_mov_b32 v12, s37
v_mov_b32 v13, 0
v_add_u32 v9, s38, v6
v_add_u32 v9, 133280, v9
ds_write_b128 v9, v[10:13]
v_mov_b32 v10, 0x3f80
v_mov_b32 v12, 0x3f80
ds_write_b128 v9, v[10:13] offset:24768
v_mul_u32_u24 v9, 8256, v5
v_lshl_add_u32 v9, v7, 3, v9
s_lshl_b32 s37, s40, 9
s_add_u32 s37, s37, 112640
v_add_u32 v2, s37, v9
v_mul_u32_u24 v9, 4128, v5
v_lshl_add_u32 v9, v7, 3, v9
s_add_u32 s39, s37, 16512
v_add_u32 v14, s39, v9
v_bfe_u32 v9, v1, 4, 1
v_and_b32 v10, 3, v1
v_lshl_add_u32 v9, v9, 2, v10
v_min_u32 v9, 5, v9
v_mul_u32_u24 v9, 4128, v9
v_bfe_u32 v10, v1, 2, 2
v_lshl_add_u32 v10, v5, 2, v10
v_lshl_add_u32 v9, v10, 3, v9
s_add_u32 s39, s37, 24768
v_add_u32 v3, s39, v9
v_lshlrev_b32 v9, 2, v5
v_sub_u32 v9, v7, v9
v_cmp_le_i32 s[42:43], 0, v9
v_cmp_le_i32 s[44:45], 1, v9
v_cmp_le_i32 s[46:47], 2, v9
v_cmp_le_i32 s[48:49], 3, v9
v_cmp_le_i32 s[50:51], 8, v9
v_cmp_le_i32 s[52:53], 9, v9
v_cmp_le_i32 s[54:55], 10, v9
v_cmp_le_i32 s[56:57], 11, v9
v_cmp_le_i32 s[58:59], 16, v9
v_cmp_le_i32 s[60:61], 17, v9
v_cmp_le_i32 s[62:63], 18, v9
v_cmp_le_i32 s[64:65], 19, v9
v_cmp_le_i32 s[66:67], 24, v9
v_cmp_le_i32 s[68:69], 25, v9
v_cmp_le_i32 s[70:71], 26, v9
v_cmp_le_i32 s[72:73], 27, v9
v_cmp_eq_u32 vcc, 1, v5
v_mov_b32 v10, 0x3f80
s_waitcnt vmcnt(3)
v_cndmask_b32 v20, v20, v10, vcc
v_mov_b32 v11, 0
v_cndmask_b32 v21, v21, v11, vcc
v_mov_b32 v10, 0x3f80
s_waitcnt vmcnt(0)
v_cndmask_b32 v26, v26, v10, vcc
v_mov_b32 v11, 0
v_cndmask_b32 v27, v27, v11, vcc
v_mov_b32 v32, 0xffff
v_cndmask_b32 v9, 0, v32, s[42:43]
v_mov_b32 v33, 0xffff0000
v_cndmask_b32 v33, 0, v33, s[44:45]
v_or_b32 v9, v9, v33
v_mov_b32 v32, 0xffff
v_cndmask_b32 v12, 0, v32, s[46:47]
v_mov_b32 v33, 0xffff0000
v_cndmask_b32 v33, 0, v33, s[48:49]
v_or_b32 v12, v12, v33
v_mov_b32 v32, 0xffff
v_cndmask_b32 v13, 0, v32, s[50:51]
v_mov_b32 v33, 0xffff0000
v_cndmask_b32 v33, 0, v33, s[52:53]
v_or_b32 v13, v13, v33
v_mov_b32 v32, 0xffff
v_cndmask_b32 v15, 0, v32, s[54:55]
v_mov_b32 v33, 0xffff0000
v_cndmask_b32 v33, 0, v33, s[56:57]
v_or_b32 v15, v15, v33
v_mov_b32 v32, 0xffff
v_cndmask_b32 v31, 0, v32, s[58:59]
v_mov_b32 v33, 0xffff0000
v_cndmask_b32 v33, 0, v33, s[60:61]
v_or_b32 v31, v31, v33
v_mov_b32 v32, 0xffff
v_cndmask_b32 v44, 0, v32, s[62:63]
v_mov_b32 v33, 0xffff0000
v_cndmask_b32 v33, 0, v33, s[64:65]
v_or_b32 v44, v44, v33
v_mov_b32 v32, 0xffff
v_cndmask_b32 v45, 0, v32, s[66:67]
v_mov_b32 v33, 0xffff0000
v_cndmask_b32 v33, 0, v33, s[68:69]
v_or_b32 v45, v45, v33
v_mov_b32 v32, 0xffff
v_cndmask_b32 v46, 0, v32, s[70:71]
v_mov_b32 v33, 0xffff0000
v_cndmask_b32 v33, 0, v33, s[72:73]
v_or_b32 v46, v46, v33
s_waitcnt lgkmcnt(0)
v_mov_b32 v32, 1
ds_write_b32 v47, v32 offset:0
v_mov_b32 v36, 162240
s_mov_b32 s39, 1000000
T_SYNC0:
ds_read_b128 v[32:35], v36
s_sub_u32 s39, s39, 1
s_waitcnt lgkmcnt(0)
v_and_b32 v32, v32, v33
v_and_b32 v34, v34, v35
v_and_b32 v32, v32, v34
v_cmp_ne_u32 vcc, 1, v32
s_cmp_eq_u32 s39, 0
s_cbranch_scc1 T_SYNCED0
s_cbranch_vccnz T_SYNC0
T_SYNCED0:
s_mov_b32 s26, 0.15499242141443584
ds_read_b64 a[16:17], v2 offset:0
ds_read_b64 a[18:19], v2 offset:4128
ds_read_b64 a[20:21], v14 offset:0
ds_read_b64 a[24:25], v2 offset:256
ds_read_b64 a[26:27], v2 offset:4384
ds_read_b64 a[28:29], v14 offset:256
ds_read_b64 a[32:33], v2 offset:512
ds_read_b64 a[34:35], v2 offset:4640
ds_read_b64 a[36:37], v14 offset:512
s_waitcnt lgkmcnt(7)
v_mfma_f32_32x32x16_bf16 v[48:63], a[16:19], v[16:19], 0
s_waitcnt lgkmcnt(6)
v_mfma_f32_32x32x8_bf16 v[48:63], a[20:21], v[20:21], v[48:63]
s_add_u32 m0, s38, 137408
s_add_u32 s37, s41, 2621440
buffer_load_dwordx4 v6, s[16:19], s37 offen lds
ds_read_b64 a[16:17], v2 offset:768
ds_read_b64 a[18:19], v2 offset:4896
ds_read_b64 a[20:21], v14 offset:768
s_waitcnt lgkmcnt(7)
v_mfma_f32_32x32x16_bf16 v[64:79], a[24:27], v[16:19], 0
s_waitcnt lgkmcnt(6)
v_mfma_f32_32x32x8_bf16 v[64:79], a[28:29], v[20:21], v[64:79]
s_add_u32 m0, s38, 141536
s_add_u32 s37, s41, 2637824
buffer_load_dwordx4 v6, s[16:19], s37 offen lds
ds_read_b64 a[24:25], v2 offset:1024
ds_read_b64 a[26:27], v2 offset:5152
ds_read_b64 a[28:29], v14 offset:1024
s_waitcnt lgkmcnt(7)
v_mfma_f32_32x32x16_bf16 v[80:95], a[32:35], v[16:19], 0
s_waitcnt lgkmcnt(6)
v_mfma_f32_32x32x8_bf16 v[80:95], a[36:37], v[20:21], v[80:95]
s_add_u32 m0, s38, 145664
s_add_u32 s37, s41, 2654208
buffer_load_dwordx4 v6, s[16:19], s37 offen lds
ds_read_b64 a[32:33], v2 offset:1280
ds_read_b64 a[34:35], v2 offset:5408
ds_read_b64 a[36:37], v14 offset:1280
s_waitcnt lgkmcnt(7)
v_mfma_f32_32x32x16_bf16 v[96:111], a[16:19], v[16:19], 0
s_waitcnt lgkmcnt(6)
v_mfma_f32_32x32x8_bf16 v[96:111], a[20:21], v[20:21], v[96:111]
s_add_u32 m0, s38, 149792
s_add_u32 s37, s41, 2670592
buffer_load_dwordx4 v6, s[16:19], s37 offen lds
ds_read_b64 a[16:17], v2 offset:1536
ds_read_b64 a[18:19], v2 offset:5664
ds_read_b64 a[20:21], v14 offset:1536
s_waitcnt lgkmcnt(7)
v_mfma_f32_32x32x16_bf16 v[112:127], a[24:27], v[16:19], 0
s_waitcnt lgkmcnt(6)
v_mfma_f32_32x32x8_bf16 v[112:127], a[28:29], v[20:21], v[112:127]
s_add_u32 m0, s38, 153920
s_add_u32 s37, s41, 2686976
buffer_load_dwordx4 v6, s[16:19], s37 offen lds
ds_read_b64 a[24:25], v2 offset:1792
ds_read_b64 a[26:27], v2 offset:5920
ds_read_b64 a[28:29], v14 offset:1792
s_waitcnt lgkmcnt(7)
v_mfma_f32_32x32x16_bf16 v[128:143], a[32:35], v[16:19], 0
s_waitcnt lgkmcnt(6)
v_mfma_f32_32x32x8_bf16 v[128:143], a[36:37], v[20:21], v[128:143]
ds_read_b64 a[32:33], v2 offset:2048
ds_read_b64 a[34:35], v2 offset:6176
ds_read_b64 a[36:37], v14 offset:2048
s_waitcnt lgkmcnt(7)
v_mfma_f32_32x32x16_bf16 v[144:159], a[16:19], v[16:19], 0
s_waitcnt lgkmcnt(6)
v_mfma_f32_32x32x8_bf16 v[144:159], a[20:21], v[20:21], v[144:159]
s_waitcnt lgkmcnt(4)
v_mfma_f32_32x32x16_bf16 v[160:175], a[24:27], v[16:19], 0
s_waitcnt lgkmcnt(3)
v_mfma_f32_32x32x8_bf16 v[160:175], a[28:29], v[20:21], v[160:175]
s_waitcnt lgkmcnt(1)
v_mfma_f32_32x32x16_bf16 v[176:191], a[32:35], v[16:19], 0
s_waitcnt lgkmcnt(0)
v_mfma_f32_32x32x8_bf16 v[176:191], a[36:37], v[20:21], v[176:191]
v_max_f32 v28, v64, v65
v_max3_f32 v28, v28, v66, v67
v_max3_f32 v28, v28, v68, v69
v_max3_f32 v28, v28, v70, v71
v_max3_f32 v28, v28, v72, v73
v_max3_f32 v28, v28, v74, v75
v_max3_f32 v28, v28, v76, v77
v_max3_f32 v28, v28, v78, v79
v_max3_f32 v28, v28, v80, v81
v_max3_f32 v28, v28, v82, v83
v_max3_f32 v28, v28, v84, v85
v_max3_f32 v28, v28, v86, v87
v_max3_f32 v28, v28, v88, v89
v_max3_f32 v28, v28, v90, v91
v_max3_f32 v28, v28, v92, v93
v_max3_f32 v28, v28, v94, v95
v_max3_f32 v28, v28, v96, v97
v_max3_f32 v28, v28, v98, v99
v_max3_f32 v28, v28, v100, v101
v_max3_f32 v28, v28, v102, v103
v_max3_f32 v28, v28, v104, v105
v_max3_f32 v28, v28, v106, v107
v_max3_f32 v28, v28, v108, v109
v_max3_f32 v28, v28, v110, v111
v_max3_f32 v28, v28, v112, v113
v_max3_f32 v28, v28, v114, v115
v_max3_f32 v28, v28, v116, v117
v_max3_f32 v28, v28, v118, v119
v_max3_f32 v28, v28, v120, v121
v_max3_f32 v28, v28, v122, v123
v_max3_f32 v28, v28, v124, v125
v_max3_f32 v28, v28, v126, v127
v_max3_f32 v28, v28, v128, v129
v_max3_f32 v28, v28, v130, v131
v_max3_f32 v28, v28, v132, v133
v_max3_f32 v28, v28, v134, v135
v_max3_f32 v28, v28, v136, v137
v_max3_f32 v28, v28, v138, v139
v_max3_f32 v28, v28, v140, v141
v_max3_f32 v28, v28, v142, v143
v_max3_f32 v28, v28, v144, v145
v_max3_f32 v28, v28, v146, v147
v_max3_f32 v28, v28, v148, v149
v_max3_f32 v28, v28, v150, v151
v_max3_f32 v28, v28, v152, v153
v_max3_f32 v28, v28, v154, v155
v_max3_f32 v28, v28, v156, v157
v_max3_f32 v28, v28, v158, v159
v_max3_f32 v28, v28, v160, v161
v_max3_f32 v28, v28, v162, v163
v_max3_f32 v28, v28, v164, v165
v_max3_f32 v28, v28, v166, v167
v_max3_f32 v28, v28, v168, v169
v_max3_f32 v28, v28, v170, v171
v_max3_f32 v28, v28, v172, v173
v_max3_f32 v28, v28, v174, v175
v_cndmask_b32 v48, v48, v176, s[42:43]
v_cndmask_b32 v49, v49, v177, s[44:45]
v_cndmask_b32 v50, v50, v178, s[46:47]
v_cndmask_b32 v51, v51, v179, s[48:49]
v_cndmask_b32 v52, v52, v180, s[50:51]
v_cndmask_b32 v53, v53, v181, s[52:53]
v_cndmask_b32 v54, v54, v182, s[54:55]
v_cndmask_b32 v55, v55, v183, s[56:57]
v_cndmask_b32 v56, v56, v184, s[58:59]
v_cndmask_b32 v57, v57, v185, s[60:61]
v_cndmask_b32 v58, v58, v186, s[62:63]
v_cndmask_b32 v59, v59, v187, s[64:65]
v_cndmask_b32 v60, v60, v188, s[66:67]
v_cndmask_b32 v61, v61, v189, s[68:69]
v_cndmask_b32 v62, v62, v190, s[70:71]
v_cndmask_b32 v63, v63, v191, s[72:73]
v_max3_f32 v28, v28, v48, v49
v_max3_f32 v28, v28, v50, v51
v_max3_f32 v28, v28, v52, v53
v_max3_f32 v28, v28, v54, v55
v_max3_f32 v28, v28, v56, v57
v_max3_f32 v28, v28, v58, v59
v_max3_f32 v28, v28, v60, v61
v_max3_f32 v28, v28, v62, v63
v_mov_b32 v29, v28
s_nop 1
v_permlane32_swap_b32 v28, v29
v_max_f32 v28, v28, v29
v_mul_f32 v29, s26, v28
s_waitcnt vmcnt(0)
s_waitcnt lgkmcnt(0)
v_mov_b32 v32, 1
ds_write_b32 v47, v32 offset:16
v_mov_b32 v36, 162256
s_mov_b32 s39, 1000000
T_SYNC1:
ds_read_b128 v[32:35], v36
s_sub_u32 s39, s39, 1
s_waitcnt lgkmcnt(0)
v_and_b32 v32, v32, v33
v_and_b32 v34, v34, v35
v_and_b32 v32, v32, v34
v_cmp_ne_u32 vcc, 1, v32
s_cmp_eq_u32 s39, 0
s_cbranch_scc1 T_SYNCED1
s_cbranch_vccnz T_SYNC1
T_SYNCED1:
ds_read_b64_tr_b16 a[40:41], v3 offset:0
ds_read_b64_tr_b16 a[42:43], v3 offset:64
ds_read_b64_tr_b16 a[44:45], v3 offset:128
ds_read_b64_tr_b16 a[46:47], v3 offset:192
ds_read_b64_tr_b16 a[48:49], v3 offset:2048
ds_read_b64_tr_b16 a[50:51], v3 offset:2112
ds_read_b64_tr_b16 a[52:53], v3 offset:2176
ds_read_b64_tr_b16 a[54:55], v3 offset:2240
ds_read_b64_tr_b16 a[56:57], v3 offset:256
ds_read_b64_tr_b16 a[58:59], v3 offset:320
ds_read_b64_tr_b16 a[60:61], v3 offset:384
ds_read_b64_tr_b16 a[62:63], v3 offset:448
v_fma_f32 v48, v48, s26, -v29
v_fma_f32 v49, v49, s26, -v29
v_fma_f32 v50, v50, s26, -v29
v_fma_f32 v51, v51, s26, -v29
v_fma_f32 v52, v52, s26, -v29
v_fma_f32 v53, v53, s26, -v29
v_fma_f32 v54, v54, s26, -v29
v_fma_f32 v55, v55, s26, -v29
v_fma_f32 v56, v56, s26, -v29
v_fma_f32 v57, v57, s26, -v29
v_fma_f32 v58, v58, s26, -v29
v_fma_f32 v59, v59, s26, -v29
v_fma_f32 v60, v60, s26, -v29
v_fma_f32 v61, v61, s26, -v29
v_fma_f32 v62, v62, s26, -v29
v_fma_f32 v63, v63, s26, -v29
v_exp_f32 v48, v48
v_exp_f32 v49, v49
v_exp_f32 v50, v50
v_exp_f32 v51, v51
v_exp_f32 v52, v52
v_exp_f32 v53, v53
v_exp_f32 v54, v54
v_exp_f32 v55, v55
v_exp_f32 v56, v56
v_exp_f32 v57, v57
v_exp_f32 v58, v58
v_exp_f32 v59, v59
v_exp_f32 v60, v60
v_exp_f32 v61, v61
v_exp_f32 v62, v62
v_exp_f32 v63, v63
v_cvt_pk_bf16_f32 v48, v48, v49
v_cvt_pk_bf16_f32 v49, v50, v51
v_cvt_pk_bf16_f32 v50, v52, v53
v_cvt_pk_bf16_f32 v51, v54, v55
v_cvt_pk_bf16_f32 v52, v56, v57
v_cvt_pk_bf16_f32 v53, v58, v59
v_cvt_pk_bf16_f32 v54, v60, v61
v_cvt_pk_bf16_f32 v55, v62, v63
v_and_b32 v176, v9, v48
v_and_b32 v177, v12, v49
v_and_b32 v178, v13, v50
v_and_b32 v179, v15, v51
v_and_b32 v180, v31, v52
v_and_b32 v181, v44, v53
v_and_b32 v182, v45, v54
v_and_b32 v183, v46, v55
v_bfi_b32 v48, v9, 0, v48
v_bfi_b32 v49, v12, 0, v49
v_bfi_b32 v50, v13, 0, v50
v_bfi_b32 v51, v15, 0, v51
v_bfi_b32 v52, v31, 0, v52
v_bfi_b32 v53, v44, 0, v53
v_bfi_b32 v54, v45, 0, v54
v_bfi_b32 v55, v46, 0, v55
s_waitcnt lgkmcnt(10)
v_mfma_f32_32x32x16_bf16 a[0:15], a[40:43], v[48:51], 0
s_waitcnt lgkmcnt(8)
v_mfma_f32_32x32x16_bf16 a[0:15], a[44:47], v[52:55], a[0:15]
ds_read_b64_tr_b16 a[40:41], v3 offset:512
ds_read_b64_tr_b16 a[42:43], v3 offset:576
ds_read_b64_tr_b16 a[44:45], v3 offset:640
ds_read_b64_tr_b16 a[46:47], v3 offset:704
s_waitcnt lgkmcnt(10)
v_mfma_f32_32x32x16_bf16 a[0:15], a[48:51], v[176:179], a[0:15]
s_waitcnt lgkmcnt(8)
v_mfma_f32_32x32x16_bf16 a[0:15], a[52:55], v[180:183], a[0:15]
ds_read_b64_tr_b16 a[48:49], v3 offset:768
ds_read_b64_tr_b16 a[50:51], v3 offset:832
ds_read_b64_tr_b16 a[52:53], v3 offset:896
ds_read_b64_tr_b16 a[54:55], v3 offset:960
v_fma_f32 v64, v64, s26, -v29
v_fma_f32 v65, v65, s26, -v29
v_fma_f32 v66, v66, s26, -v29
v_fma_f32 v67, v67, s26, -v29
v_fma_f32 v68, v68, s26, -v29
v_fma_f32 v69, v69, s26, -v29
v_fma_f32 v70, v70, s26, -v29
v_fma_f32 v71, v71, s26, -v29
v_fma_f32 v72, v72, s26, -v29
v_fma_f32 v73, v73, s26, -v29
v_fma_f32 v74, v74, s26, -v29
v_fma_f32 v75, v75, s26, -v29
v_fma_f32 v76, v76, s26, -v29
v_fma_f32 v77, v77, s26, -v29
v_fma_f32 v78, v78, s26, -v29
v_fma_f32 v79, v79, s26, -v29
v_exp_f32 v64, v64
v_exp_f32 v65, v65
v_exp_f32 v66, v66
v_exp_f32 v67, v67
v_exp_f32 v68, v68
v_exp_f32 v69, v69
v_exp_f32 v70, v70
v_exp_f32 v71, v71
v_exp_f32 v72, v72
v_exp_f32 v73, v73
v_exp_f32 v74, v74
v_exp_f32 v75, v75
v_exp_f32 v76, v76
v_exp_f32 v77, v77
v_exp_f32 v78, v78
v_exp_f32 v79, v79
v_cvt_pk_bf16_f32 v64, v64, v65
v_cvt_pk_bf16_f32 v65, v66, v67
v_cvt_pk_bf16_f32 v66, v68, v69
v_cvt_pk_bf16_f32 v67, v70, v71
v_cvt_pk_bf16_f32 v68, v72, v73
v_cvt_pk_bf16_f32 v69, v74, v75
v_cvt_pk_bf16_f32 v70, v76, v77
v_cvt_pk_bf16_f32 v71, v78, v79
s_waitcnt lgkmcnt(10)
v_mfma_f32_32x32x16_bf16 a[0:15], a[56:59], v[64:67], a[0:15]
s_waitcnt lgkmcnt(8)
v_mfma_f32_32x32x16_bf16 a[0:15], a[60:63], v[68:71], a[0:15]
ds_read_b64_tr_b16 a[56:57], v3 offset:1024
ds_read_b64_tr_b16 a[58:59], v3 offset:1088
ds_read_b64_tr_b16 a[60:61], v3 offset:1152
ds_read_b64_tr_b16 a[62:63], v3 offset:1216
v_fma_f32 v80, v80, s26, -v29
v_fma_f32 v81, v81, s26, -v29
v_fma_f32 v82, v82, s26, -v29
v_fma_f32 v83, v83, s26, -v29
v_fma_f32 v84, v84, s26, -v29
v_fma_f32 v85, v85, s26, -v29
v_fma_f32 v86, v86, s26, -v29
v_fma_f32 v87, v87, s26, -v29
v_fma_f32 v88, v88, s26, -v29
v_fma_f32 v89, v89, s26, -v29
v_fma_f32 v90, v90, s26, -v29
v_fma_f32 v91, v91, s26, -v29
v_fma_f32 v92, v92, s26, -v29
v_fma_f32 v93, v93, s26, -v29
v_fma_f32 v94, v94, s26, -v29
v_fma_f32 v95, v95, s26, -v29
v_exp_f32 v80, v80
v_exp_f32 v81, v81
v_exp_f32 v82, v82
v_exp_f32 v83, v83
v_exp_f32 v84, v84
v_exp_f32 v85, v85
v_exp_f32 v86, v86
v_exp_f32 v87, v87
v_exp_f32 v88, v88
v_exp_f32 v89, v89
v_exp_f32 v90, v90
v_exp_f32 v91, v91
v_exp_f32 v92, v92
v_exp_f32 v93, v93
v_exp_f32 v94, v94
v_exp_f32 v95, v95
v_cvt_pk_bf16_f32 v80, v80, v81
v_cvt_pk_bf16_f32 v81, v82, v83
v_cvt_pk_bf16_f32 v82, v84, v85
v_cvt_pk_bf16_f32 v83, v86, v87
v_cvt_pk_bf16_f32 v84, v88, v89
v_cvt_pk_bf16_f32 v85, v90, v91
v_cvt_pk_bf16_f32 v86, v92, v93
v_cvt_pk_bf16_f32 v87, v94, v95
s_waitcnt lgkmcnt(10)
v_mfma_f32_32x32x16_bf16 a[0:15], a[40:43], v[80:83], a[0:15]
s_waitcnt lgkmcnt(8)
v_mfma_f32_32x32x16_bf16 a[0:15], a[44:47], v[84:87], a[0:15]
ds_read_b64_tr_b16 a[40:41], v3 offset:1280
ds_read_b64_tr_b16 a[42:43], v3 offset:1344
ds_read_b64_tr_b16 a[44:45], v3 offset:1408
ds_read_b64_tr_b16 a[46:47], v3 offset:1472
v_fma_f32 v96, v96, s26, -v29
v_fma_f32 v97, v97, s26, -v29
v_fma_f32 v98, v98, s26, -v29
v_fma_f32 v99, v99, s26, -v29
v_fma_f32 v100, v100, s26, -v29
v_fma_f32 v101, v101, s26, -v29
v_fma_f32 v102, v102, s26, -v29
v_fma_f32 v103, v103, s26, -v29
v_fma_f32 v104, v104, s26, -v29
v_fma_f32 v105, v105, s26, -v29
v_fma_f32 v106, v106, s26, -v29
v_fma_f32 v107, v107, s26, -v29
v_fma_f32 v108, v108, s26, -v29
v_fma_f32 v109, v109, s26, -v29
v_fma_f32 v110, v110, s26, -v29
v_fma_f32 v111, v111, s26, -v29
v_exp_f32 v96, v96
v_exp_f32 v97, v97
v_exp_f32 v98, v98
v_exp_f32 v99, v99
v_exp_f32 v100, v100
v_exp_f32 v101, v101
v_exp_f32 v102, v102
v_exp_f32 v103, v103
v_exp_f32 v104, v104
v_exp_f32 v105, v105
v_exp_f32 v106, v106
v_exp_f32 v107, v107
v_exp_f32 v108, v108
v_exp_f32 v109, v109
v_exp_f32 v110, v110
v_exp_f32 v111, v111
v_cvt_pk_bf16_f32 v96, v96, v97
v_cvt_pk_bf16_f32 v97, v98, v99
v_cvt_pk_bf16_f32 v98, v100, v101
v_cvt_pk_bf16_f32 v99, v102, v103
v_cvt_pk_bf16_f32 v100, v104, v105
v_cvt_pk_bf16_f32 v101, v106, v107
v_cvt_pk_bf16_f32 v102, v108, v109
v_cvt_pk_bf16_f32 v103, v110, v111
s_waitcnt lgkmcnt(10)
v_mfma_f32_32x32x16_bf16 a[0:15], a[48:51], v[96:99], a[0:15]
s_waitcnt lgkmcnt(8)
v_mfma_f32_32x32x16_bf16 a[0:15], a[52:55], v[100:103], a[0:15]
ds_read_b64_tr_b16 a[48:49], v3 offset:1536
ds_read_b64_tr_b16 a[50:51], v3 offset:1600
ds_read_b64_tr_b16 a[52:53], v3 offset:1664
ds_read_b64_tr_b16 a[54:55], v3 offset:1728
v_fma_f32 v112, v112, s26, -v29
v_fma_f32 v113, v113, s26, -v29
v_fma_f32 v114, v114, s26, -v29
v_fma_f32 v115, v115, s26, -v29
v_fma_f32 v116, v116, s26, -v29
v_fma_f32 v117, v117, s26, -v29
v_fma_f32 v118, v118, s26, -v29
v_fma_f32 v119, v119, s26, -v29
v_fma_f32 v120, v120, s26, -v29
v_fma_f32 v121, v121, s26, -v29
v_fma_f32 v122, v122, s26, -v29
v_fma_f32 v123, v123, s26, -v29
v_fma_f32 v124, v124, s26, -v29
v_fma_f32 v125, v125, s26, -v29
v_fma_f32 v126, v126, s26, -v29
v_fma_f32 v127, v127, s26, -v29
v_exp_f32 v112, v112
v_exp_f32 v113, v113
v_exp_f32 v114, v114
v_exp_f32 v115, v115
v_exp_f32 v116, v116
v_exp_f32 v117, v117
v_exp_f32 v118, v118
v_exp_f32 v119, v119
v_exp_f32 v120, v120
v_exp_f32 v121, v121
v_exp_f32 v122, v122
v_exp_f32 v123, v123
v_exp_f32 v124, v124
v_exp_f32 v125, v125
v_exp_f32 v126, v126
v_exp_f32 v127, v127
v_cvt_pk_bf16_f32 v112, v112, v113
v_cvt_pk_bf16_f32 v113, v114, v115
v_cvt_pk_bf16_f32 v114, v116, v117
v_cvt_pk_bf16_f32 v115, v118, v119
v_cvt_pk_bf16_f32 v116, v120, v121
v_cvt_pk_bf16_f32 v117, v122, v123
v_cvt_pk_bf16_f32 v118, v124, v125
v_cvt_pk_bf16_f32 v119, v126, v127
s_waitcnt lgkmcnt(10)
v_mfma_f32_32x32x16_bf16 a[0:15], a[56:59], v[112:115], a[0:15]
s_waitcnt lgkmcnt(8)
v_mfma_f32_32x32x16_bf16 a[0:15], a[60:63], v[116:119], a[0:15]
ds_read_b64_tr_b16 a[56:57], v3 offset:1792
ds_read_b64_tr_b16 a[58:59], v3 offset:1856
ds_read_b64_tr_b16 a[60:61], v3 offset:1920
ds_read_b64_tr_b16 a[62:63], v3 offset:1984
v_fma_f32 v128, v128, s26, -v29
v_fma_f32 v129, v129, s26, -v29
v_fma_f32 v130, v130, s26, -v29
v_fma_f32 v131, v131, s26, -v29
v_fma_f32 v132, v132, s26, -v29
v_fma_f32 v133, v133, s26, -v29
v_fma_f32 v134, v134, s26, -v29
v_fma_f32 v135, v135, s26, -v29
v_fma_f32 v136, v136, s26, -v29
v_fma_f32 v137, v137, s26, -v29
v_fma_f32 v138, v138, s26, -v29
v_fma_f32 v139, v139, s26, -v29
v_fma_f32 v140, v140, s26, -v29
v_fma_f32 v141, v141, s26, -v29
v_fma_f32 v142, v142, s26, -v29
v_fma_f32 v143, v143, s26, -v29
v_exp_f32 v128, v128
v_exp_f32 v129, v129
v_exp_f32 v130, v130
v_exp_f32 v131, v131
v_exp_f32 v132, v132
v_exp_f32 v133, v133
v_exp_f32 v134, v134
v_exp_f32 v135, v135
v_exp_f32 v136, v136
v_exp_f32 v137, v137
v_exp_f32 v138, v138
v_exp_f32 v139, v139
v_exp_f32 v140, v140
v_exp_f32 v141, v141
v_exp_f32 v142, v142
v_exp_f32 v143, v143
v_cvt_pk_bf16_f32 v128, v128, v129
v_cvt_pk_bf16_f32 v129, v130, v131
v_cvt_pk_bf16_f32 v130, v132, v133
v_cvt_pk_bf16_f32 v131, v134, v135
v_cvt_pk_bf16_f32 v132, v136, v137
v_cvt_pk_bf16_f32 v133, v138, v139
v_cvt_pk_bf16_f32 v134, v140, v141
v_cvt_pk_bf16_f32 v135, v142, v143
s_waitcnt lgkmcnt(10)
v_mfma_f32_32x32x16_bf16 a[0:15], a[40:43], v[128:131], a[0:15]
s_waitcnt lgkmcnt(8)
v_mfma_f32_32x32x16_bf16 a[0:15], a[44:47], v[132:135], a[0:15]
v_fma_f32 v144, v144, s26, -v29
v_fma_f32 v145, v145, s26, -v29
v_fma_f32 v146, v146, s26, -v29
v_fma_f32 v147, v147, s26, -v29
v_fma_f32 v148, v148, s26, -v29
v_fma_f32 v149, v149, s26, -v29
v_fma_f32 v150, v150, s26, -v29
v_fma_f32 v151, v151, s26, -v29
v_fma_f32 v152, v152, s26, -v29
v_fma_f32 v153, v153, s26, -v29
v_fma_f32 v154, v154, s26, -v29
v_fma_f32 v155, v155, s26, -v29
v_fma_f32 v156, v156, s26, -v29
v_fma_f32 v157, v157, s26, -v29
v_fma_f32 v158, v158, s26, -v29
v_fma_f32 v159, v159, s26, -v29
v_exp_f32 v144, v144
v_exp_f32 v145, v145
v_exp_f32 v146, v146
v_exp_f32 v147, v147
v_exp_f32 v148, v148
v_exp_f32 v149, v149
v_exp_f32 v150, v150
v_exp_f32 v151, v151
v_exp_f32 v152, v152
v_exp_f32 v153, v153
v_exp_f32 v154, v154
v_exp_f32 v155, v155
v_exp_f32 v156, v156
v_exp_f32 v157, v157
v_exp_f32 v158, v158
v_exp_f32 v159, v159
v_cvt_pk_bf16_f32 v144, v144, v145
v_cvt_pk_bf16_f32 v145, v146, v147
v_cvt_pk_bf16_f32 v146, v148, v149
v_cvt_pk_bf16_f32 v147, v150, v151
v_cvt_pk_bf16_f32 v148, v152, v153
v_cvt_pk_bf16_f32 v149, v154, v155
v_cvt_pk_bf16_f32 v150, v156, v157
v_cvt_pk_bf16_f32 v151, v158, v159
s_waitcnt lgkmcnt(6)
v_mfma_f32_32x32x16_bf16 a[0:15], a[48:51], v[144:147], a[0:15]
s_waitcnt lgkmcnt(4)
v_mfma_f32_32x32x16_bf16 a[0:15], a[52:55], v[148:151], a[0:15]
v_fma_f32 v160, v160, s26, -v29
v_fma_f32 v161, v161, s26, -v29
v_fma_f32 v162, v162, s26, -v29
v_fma_f32 v163, v163, s26, -v29
v_fma_f32 v164, v164, s26, -v29
v_fma_f32 v165, v165, s26, -v29
v_fma_f32 v166, v166, s26, -v29
v_fma_f32 v167, v167, s26, -v29
v_fma_f32 v168, v168, s26, -v29
v_fma_f32 v169, v169, s26, -v29
v_fma_f32 v170, v170, s26, -v29
v_fma_f32 v171, v171, s26, -v29
v_fma_f32 v172, v172, s26, -v29
v_fma_f32 v173, v173, s26, -v29
v_fma_f32 v174, v174, s26, -v29
v_fma_f32 v175, v175, s26, -v29
v_exp_f32 v160, v160
v_exp_f32 v161, v161
v_exp_f32 v162, v162
v_exp_f32 v163, v163
v_exp_f32 v164, v164
v_exp_f32 v165, v165
v_exp_f32 v166, v166
v_exp_f32 v167, v167
v_exp_f32 v168, v168
v_exp_f32 v169, v169
v_exp_f32 v170, v170
v_exp_f32 v171, v171
v_exp_f32 v172, v172
v_exp_f32 v173, v173
v_exp_f32 v174, v174
v_exp_f32 v175, v175
v_cvt_pk_bf16_f32 v160, v160, v161
v_cvt_pk_bf16_f32 v161, v162, v163
v_cvt_pk_bf16_f32 v162, v164, v165
v_cvt_pk_bf16_f32 v163, v166, v167
v_cvt_pk_bf16_f32 v164, v168, v169
v_cvt_pk_bf16_f32 v165, v170, v171
v_cvt_pk_bf16_f32 v166, v172, v173
v_cvt_pk_bf16_f32 v167, v174, v175
s_waitcnt lgkmcnt(2)
v_mfma_f32_32x32x16_bf16 a[0:15], a[56:59], v[160:163], a[0:15]
s_waitcnt lgkmcnt(0)
v_mfma_f32_32x32x16_bf16 a[0:15], a[60:63], v[164:167], a[0:15]
s_nop 11
v_accvgpr_read_b32 v30, a12
v_accvgpr_read_b32 v32, a0
v_accvgpr_read_b32 v33, a1
v_accvgpr_read_b32 v34, a2
v_accvgpr_read_b32 v35, a3
v_accvgpr_read_b32 v36, a4
v_accvgpr_read_b32 v37, a5
v_accvgpr_read_b32 v38, a6
v_accvgpr_read_b32 v39, a7
v_accvgpr_read_b32 v40, a8
v_accvgpr_read_b32 v41, a9
v_accvgpr_read_b32 v42, a10
v_accvgpr_read_b32 v43, a11
v_mul_f32 v30, 1.4426950408889634, v30
v_rcp_f32 v30, v30
s_nop 0
v_mul_f32 v32, v32, v30
v_mul_f32 v33, v33, v30
v_mul_f32 v34, v34, v30
v_mul_f32 v35, v35, v30
v_mul_f32 v36, v36, v30
v_mul_f32 v37, v37, v30
v_mul_f32 v38, v38, v30
v_mul_f32 v39, v39, v30
v_mul_f32 v40, v40, v30
v_mul_f32 v41, v41, v30
v_mul_f32 v42, v42, v30
v_mul_f32 v43, v43, v30
v_cvt_pk_bf16_f32 v32, v32, v33
v_cvt_pk_bf16_f32 v33, v34, v35
v_cvt_pk_bf16_f32 v34, v36, v37
v_cvt_pk_bf16_f32 v35, v38, v39
v_cvt_pk_bf16_f32 v36, v40, v41
v_cvt_pk_bf16_f32 v37, v42, v43
s_lshl_b32 s37, s36, 3
s_lshl_b32 s38, s40, 1
s_add_u32 s37, s37, s38
s_add_u32 s37, s37, 0
s_lshl_b32 s37, s37, 5
s_add_u32 s37, s37, s35
s_lshl_b32 s38, s37, 10
s_add_u32 s38, s38, 16777216
s_lshl_b32 s37, s37, 8
s_add_u32 s37, s37, 18874368
v_lshlrev_b32 v6, 4, v1
v_lshlrev_b32 v8, 3, v1
buffer_store_dwordx4 v[32:35], v6, s[16:19], s38 offen sc1
s_mov_b32 exec_hi, 0
buffer_store_dwordx2 v[36:37], v8, s[16:19], s37 offen sc1
s_mov_b64 exec, -1
ds_read_b64 a[16:17], v2 offset:256
ds_read_b64 a[18:19], v2 offset:4384
ds_read_b64 a[20:21], v14 offset:256
ds_read_b64 a[24:25], v2 offset:512
ds_read_b64 a[26:27], v2 offset:4640
ds_read_b64 a[28:29], v14 offset:512
ds_read_b64 a[32:33], v2 offset:768
ds_read_b64 a[34:35], v2 offset:4896
ds_read_b64 a[36:37], v14 offset:768
s_waitcnt lgkmcnt(7)
v_mfma_f32_32x32x16_bf16 v[48:63], a[16:19], v[22:25], 0
s_waitcnt lgkmcnt(6)
v_mfma_f32_32x32x8_bf16 v[48:63], a[20:21], v[26:27], v[48:63]
ds_read_b64 a[16:17], v2 offset:1024
ds_read_b64 a[18:19], v2 offset:5152
ds_read_b64 a[20:21], v14 offset:1024
s_waitcnt lgkmcnt(7)
v_mfma_f32_32x32x16_bf16 v[64:79], a[24:27], v[22:25], 0
s_waitcnt lgkmcnt(6)
v_mfma_f32_32x32x8_bf16 v[64:79], a[28:29], v[26:27], v[64:79]
ds_read_b64 a[24:25], v2 offset:1280
ds_read_b64 a[26:27], v2 offset:5408
ds_read_b64 a[28:29], v14 offset:1280
s_waitcnt lgkmcnt(7)
v_mfma_f32_32x32x16_bf16 v[80:95], a[32:35], v[22:25], 0
s_waitcnt lgkmcnt(6)
v_mfma_f32_32x32x8_bf16 v[80:95], a[36:37], v[26:27], v[80:95]
ds_read_b64 a[32:33], v2 offset:1536
ds_read_b64 a[34:35], v2 offset:5664
ds_read_b64 a[36:37], v14 offset:1536
s_waitcnt lgkmcnt(7)
v_mfma_f32_32x32x16_bf16 v[96:111], a[16:19], v[22:25], 0
s_waitcnt lgkmcnt(6)
v_mfma_f32_32x32x8_bf16 v[96:111], a[20:21], v[26:27], v[96:111]
ds_read_b64 a[16:17], v2 offset:1792
ds_read_b64 a[18:19], v2 offset:5920
ds_read_b64 a[20:21], v14 offset:1792
s_waitcnt lgkmcnt(7)
v_mfma_f32_32x32x16_bf16 v[112:127], a[24:27], v[22:25], 0
s_waitcnt lgkmcnt(6)
v_mfma_f32_32x32x8_bf16 v[112:127], a[28:29], v[26:27], v[112:127]
ds_read_b64 a[24:25], v2 offset:2048
ds_read_b64 a[26:27], v2 offset:6176
ds_read_b64 a[28:29], v14 offset:2048
s_waitcnt lgkmcnt(7)
v_mfma_f32_32x32x16_bf16 v[128:143], a[32:35], v[22:25], 0
s_waitcnt lgkmcnt(6)
v_mfma_f32_32x32x8_bf16 v[128:143], a[36:37], v[26:27], v[128:143]
ds_read_b64 a[32:33], v2 offset:2304
ds_read_b64 a[34:35], v2 offset:6432
ds_read_b64 a[36:37], v14 offset:2304
s_waitcnt lgkmcnt(7)
v_mfma_f32_32x32x16_bf16 v[144:159], a[16:19], v[22:25], 0
s_waitcnt lgkmcnt(6)
v_mfma_f32_32x32x8_bf16 v[144:159], a[20:21], v[26:27], v[144:159]
s_waitcnt lgkmcnt(4)
v_mfma_f32_32x32x16_bf16 v[160:175], a[24:27], v[22:25], 0
s_waitcnt lgkmcnt(3)
v_mfma_f32_32x32x8_bf16 v[160:175], a[28:29], v[26:27], v[160:175]
s_waitcnt lgkmcnt(1)
v_mfma_f32_32x32x16_bf16 v[176:191], a[32:35], v[22:25], 0
s_waitcnt lgkmcnt(0)
v_mfma_f32_32x32x8_bf16 v[176:191], a[36:37], v[26:27], v[176:191]
v_max_f32 v28, v64, v65
v_max3_f32 v28, v28, v66, v67
v_max3_f32 v28, v28, v68, v69
v_max3_f32 v28, v28, v70, v71
v_max3_f32 v28, v28, v72, v73
v_max3_f32 v28, v28, v74, v75
v_max3_f32 v28, v28, v76, v77
v_max3_f32 v28, v28, v78, v79
v_max3_f32 v28, v28, v80, v81
v_max3_f32 v28, v28, v82, v83
v_max3_f32 v28, v28, v84, v85
v_max3_f32 v28, v28, v86, v87
v_max3_f32 v28, v28, v88, v89
v_max3_f32 v28, v28, v90, v91
v_max3_f32 v28, v28, v92, v93
v_max3_f32 v28, v28, v94, v95
v_max3_f32 v28, v28, v96, v97
v_max3_f32 v28, v28, v98, v99
v_max3_f32 v28, v28, v100, v101
v_max3_f32 v28, v28, v102, v103
v_max3_f32 v28, v28, v104, v105
v_max3_f32 v28, v28, v106, v107
v_max3_f32 v28, v28, v108, v109
v_max3_f32 v28, v28, v110, v111
v_max3_f32 v28, v28, v112, v113
v_max3_f32 v28, v28, v114, v115
v_max3_f32 v28, v28, v116, v117
v_max3_f32 v28, v28, v118, v119
v_max3_f32 v28, v28, v120, v121
v_max3_f32 v28, v28, v122, v123
v_max3_f32 v28, v28, v124, v125
v_max3_f32 v28, v28, v126, v127
v_max3_f32 v28, v28, v128, v129
v_max3_f32 v28, v28, v130, v131
v_max3_f32 v28, v28, v132, v133
v_max3_f32 v28, v28, v134, v135
v_max3_f32 v28, v28, v136, v137
v_max3_f32 v28, v28, v138, v139
v_max3_f32 v28, v28, v140, v141
v_max3_f32 v28, v28, v142, v143
v_max3_f32 v28, v28, v144, v145
v_max3_f32 v28, v28, v146, v147
v_max3_f32 v28, v28, v148, v149
v_max3_f32 v28, v28, v150, v151
v_max3_f32 v28, v28, v152, v153
v_max3_f32 v28, v28, v154, v155
v_max3_f32 v28, v28, v156, v157
v_max3_f32 v28, v28, v158, v159
v_max3_f32 v28, v28, v160, v161
v_max3_f32 v28, v28, v162, v163
v_max3_f32 v28, v28, v164, v165
v_max3_f32 v28, v28, v166, v167
v_max3_f32 v28, v28, v168, v169
v_max3_f32 v28, v28, v170, v171
v_max3_f32 v28, v28, v172, v173
v_max3_f32 v28, v28, v174, v175
v_cndmask_b32 v48, v48, v176, s[42:43]
v_cndmask_b32 v49, v49, v177, s[44:45]
v_cndmask_b32 v50, v50, v178, s[46:47]
v_cndmask_b32 v51, v51, v179, s[48:49]
v_cndmask_b32 v52, v52, v180, s[50:51]
v_cndmask_b32 v53, v53, v181, s[52:53]
v_cndmask_b32 v54, v54, v182, s[54:55]
v_cndmask_b32 v55, v55, v183, s[56:57]
v_cndmask_b32 v56, v56, v184, s[58:59]
v_cndmask_b32 v57, v57, v185, s[60:61]
v_cndmask_b32 v58, v58, v186, s[62:63]
v_cndmask_b32 v59, v59, v187, s[64:65]
v_cndmask_b32 v60, v60, v188, s[66:67]
v_cndmask_b32 v61, v61, v189, s[68:69]
v_cndmask_b32 v62, v62, v190, s[70:71]
v_cndmask_b32 v63, v63, v191, s[72:73]
v_max3_f32 v28, v28, v48, v49
v_max3_f32 v28, v28, v50, v51
v_max3_f32 v28, v28, v52, v53
v_max3_f32 v28, v28, v54, v55
v_max3_f32 v28, v28, v56, v57
v_max3_f32 v28, v28, v58, v59
v_max3_f32 v28, v28, v60, v61
v_max3_f32 v28, v28, v62, v63
v_mov_b32 v29, v28
s_nop 1
v_permlane32_swap_b32 v28, v29
v_max_f32 v28, v28, v29
v_mul_f32 v29, s26, v28
ds_read_b64_tr_b16 a[40:41], v3 offset:256
ds_read_b64_tr_b16 a[42:43], v3 offset:320
ds_read_b64_tr_b16 a[44:45], v3 offset:384
ds_read_b64_tr_b16 a[46:47], v3 offset:448
ds_read_b64_tr_b16 a[48:49], v3 offset:2304
ds_read_b64_tr_b16 a[50:51], v3 offset:2368
ds_read_b64_tr_b16 a[52:53], v3 offset:2432
ds_read_b64_tr_b16 a[54:55], v3 offset:2496
ds_read_b64_tr_b16 a[56:57], v3 offset:512
ds_read_b64_tr_b16 a[58:59], v3 offset:576
ds_read_b64_tr_b16 a[60:61], v3 offset:640
ds_read_b64_tr_b16 a[62:63], v3 offset:704
v_fma_f32 v48, v48, s26, -v29
v_fma_f32 v49, v49, s26, -v29
v_fma_f32 v50, v50, s26, -v29
v_fma_f32 v51, v51, s26, -v29
v_fma_f32 v52, v52, s26, -v29
v_fma_f32 v53, v53, s26, -v29
v_fma_f32 v54, v54, s26, -v29
v_fma_f32 v55, v55, s26, -v29
v_fma_f32 v56, v56, s26, -v29
v_fma_f32 v57, v57, s26, -v29
v_fma_f32 v58, v58, s26, -v29
v_fma_f32 v59, v59, s26, -v29
v_fma_f32 v60, v60, s26, -v29
v_fma_f32 v61, v61, s26, -v29
v_fma_f32 v62, v62, s26, -v29
v_fma_f32 v63, v63, s26, -v29
v_exp_f32 v48, v48
v_exp_f32 v49, v49
v_exp_f32 v50, v50
v_exp_f32 v51, v51
v_exp_f32 v52, v52
v_exp_f32 v53, v53
v_exp_f32 v54, v54
v_exp_f32 v55, v55
v_exp_f32 v56, v56
v_exp_f32 v57, v57
v_exp_f32 v58, v58
v_exp_f32 v59, v59
v_exp_f32 v60, v60
v_exp_f32 v61, v61
v_exp_f32 v62, v62
v_exp_f32 v63, v63
v_cvt_pk_bf16_f32 v48, v48, v49
v_cvt_pk_bf16_f32 v49, v50, v51
v_cvt_pk_bf16_f32 v50, v52, v53
v_cvt_pk_bf16_f32 v51, v54, v55
v_cvt_pk_bf16_f32 v52, v56, v57
v_cvt_pk_bf16_f32 v53, v58, v59
v_cvt_pk_bf16_f32 v54, v60, v61
v_cvt_pk_bf16_f32 v55, v62, v63
v_and_b32 v176, v9, v48
v_and_b32 v177, v12, v49
v_and_b32 v178, v13, v50
v_and_b32 v179, v15, v51
v_and_b32 v180, v31, v52
v_and_b32 v181, v44, v53
v_and_b32 v182, v45, v54
v_and_b32 v183, v46, v55
v_bfi_b32 v48, v9, 0, v48
v_bfi_b32 v49, v12, 0, v49
v_bfi_b32 v50, v13, 0, v50
v_bfi_b32 v51, v15, 0, v51
v_bfi_b32 v52, v31, 0, v52
v_bfi_b32 v53, v44, 0, v53
v_bfi_b32 v54, v45, 0, v54
v_bfi_b32 v55, v46, 0, v55
s_waitcnt lgkmcnt(10)
v_mfma_f32_32x32x16_bf16 a[0:15], a[40:43], v[48:51], 0
s_waitcnt lgkmcnt(8)
v_mfma_f32_32x32x16_bf16 a[0:15], a[44:47], v[52:55], a[0:15]
ds_read_b64_tr_b16 a[40:41], v3 offset:768
ds_read_b64_tr_b16 a[42:43], v3 offset:832
ds_read_b64_tr_b16 a[44:45], v3 offset:896
ds_read_b64_tr_b16 a[46:47], v3 offset:960
s_waitcnt lgkmcnt(10)
v_mfma_f32_32x32x16_bf16 a[0:15], a[48:51], v[176:179], a[0:15]
s_waitcnt lgkmcnt(8)
v_mfma_f32_32x32x16_bf16 a[0:15], a[52:55], v[180:183], a[0:15]
ds_read_b64_tr_b16 a[48:49], v3 offset:1024
ds_read_b64_tr_b16 a[50:51], v3 offset:1088
ds_read_b64_tr_b16 a[52:53], v3 offset:1152
ds_read_b64_tr_b16 a[54:55], v3 offset:1216
v_fma_f32 v64, v64, s26, -v29
v_fma_f32 v65, v65, s26, -v29
v_fma_f32 v66, v66, s26, -v29
v_fma_f32 v67, v67, s26, -v29
v_fma_f32 v68, v68, s26, -v29
v_fma_f32 v69, v69, s26, -v29
v_fma_f32 v70, v70, s26, -v29
v_fma_f32 v71, v71, s26, -v29
v_fma_f32 v72, v72, s26, -v29
v_fma_f32 v73, v73, s26, -v29
v_fma_f32 v74, v74, s26, -v29
v_fma_f32 v75, v75, s26, -v29
v_fma_f32 v76, v76, s26, -v29
v_fma_f32 v77, v77, s26, -v29
v_fma_f32 v78, v78, s26, -v29
v_fma_f32 v79, v79, s26, -v29
v_exp_f32 v64, v64
v_exp_f32 v65, v65
v_exp_f32 v66, v66
v_exp_f32 v67, v67
v_exp_f32 v68, v68
v_exp_f32 v69, v69
v_exp_f32 v70, v70
v_exp_f32 v71, v71
v_exp_f32 v72, v72
v_exp_f32 v73, v73
v_exp_f32 v74, v74
v_exp_f32 v75, v75
v_exp_f32 v76, v76
v_exp_f32 v77, v77
v_exp_f32 v78, v78
v_exp_f32 v79, v79
v_cvt_pk_bf16_f32 v64, v64, v65
v_cvt_pk_bf16_f32 v65, v66, v67
v_cvt_pk_bf16_f32 v66, v68, v69
v_cvt_pk_bf16_f32 v67, v70, v71
v_cvt_pk_bf16_f32 v68, v72, v73
v_cvt_pk_bf16_f32 v69, v74, v75
v_cvt_pk_bf16_f32 v70, v76, v77
v_cvt_pk_bf16_f32 v71, v78, v79
s_waitcnt lgkmcnt(10)
v_mfma_f32_32x32x16_bf16 a[0:15], a[56:59], v[64:67], a[0:15]
s_waitcnt lgkmcnt(8)
v_mfma_f32_32x32x16_bf16 a[0:15], a[60:63], v[68:71], a[0:15]
ds_read_b64_tr_b16 a[56:57], v3 offset:1280
ds_read_b64_tr_b16 a[58:59], v3 offset:1344
ds_read_b64_tr_b16 a[60:61], v3 offset:1408
ds_read_b64_tr_b16 a[62:63], v3 offset:1472
v_fma_f32 v80, v80, s26, -v29
v_fma_f32 v81, v81, s26, -v29
v_fma_f32 v82, v82, s26, -v29
v_fma_f32 v83, v83, s26, -v29
v_fma_f32 v84, v84, s26, -v29
v_fma_f32 v85, v85, s26, -v29
v_fma_f32 v86, v86, s26, -v29
v_fma_f32 v87, v87, s26, -v29
v_fma_f32 v88, v88, s26, -v29
v_fma_f32 v89, v89, s26, -v29
v_fma_f32 v90, v90, s26, -v29
v_fma_f32 v91, v91, s26, -v29
v_fma_f32 v92, v92, s26, -v29
v_fma_f32 v93, v93, s26, -v29
v_fma_f32 v94, v94, s26, -v29
v_fma_f32 v95, v95, s26, -v29
v_exp_f32 v80, v80
v_exp_f32 v81, v81
v_exp_f32 v82, v82
v_exp_f32 v83, v83
v_exp_f32 v84, v84
v_exp_f32 v85, v85
v_exp_f32 v86, v86
v_exp_f32 v87, v87
v_exp_f32 v88, v88
v_exp_f32 v89, v89
v_exp_f32 v90, v90
v_exp_f32 v91, v91
v_exp_f32 v92, v92
v_exp_f32 v93, v93
v_exp_f32 v94, v94
v_exp_f32 v95, v95
v_cvt_pk_bf16_f32 v80, v80, v81
v_cvt_pk_bf16_f32 v81, v82, v83
v_cvt_pk_bf16_f32 v82, v84, v85
v_cvt_pk_bf16_f32 v83, v86, v87
v_cvt_pk_bf16_f32 v84, v88, v89
v_cvt_pk_bf16_f32 v85, v90, v91
v_cvt_pk_bf16_f32 v86, v92, v93
v_cvt_pk_bf16_f32 v87, v94, v95
s_waitcnt lgkmcnt(10)
v_mfma_f32_32x32x16_bf16 a[0:15], a[40:43], v[80:83], a[0:15]
s_waitcnt lgkmcnt(8)
v_mfma_f32_32x32x16_bf16 a[0:15], a[44:47], v[84:87], a[0:15]
ds_read_b64_tr_b16 a[40:41], v3 offset:1536
ds_read_b64_tr_b16 a[42:43], v3 offset:1600
ds_read_b64_tr_b16 a[44:45], v3 offset:1664
ds_read_b64_tr_b16 a[46:47], v3 offset:1728
v_fma_f32 v96, v96, s26, -v29
v_fma_f32 v97, v97, s26, -v29
v_fma_f32 v98, v98, s26, -v29
v_fma_f32 v99, v99, s26, -v29
v_fma_f32 v100, v100, s26, -v29
v_fma_f32 v101, v101, s26, -v29
v_fma_f32 v102, v102, s26, -v29
v_fma_f32 v103, v103, s26, -v29
v_fma_f32 v104, v104, s26, -v29
v_fma_f32 v105, v105, s26, -v29
v_fma_f32 v106, v106, s26, -v29
v_fma_f32 v107, v107, s26, -v29
v_fma_f32 v108, v108, s26, -v29
v_fma_f32 v109, v109, s26, -v29
v_fma_f32 v110, v110, s26, -v29
v_fma_f32 v111, v111, s26, -v29
v_exp_f32 v96, v96
v_exp_f32 v97, v97
v_exp_f32 v98, v98
v_exp_f32 v99, v99
v_exp_f32 v100, v100
v_exp_f32 v101, v101
v_exp_f32 v102, v102
v_exp_f32 v103, v103
v_exp_f32 v104, v104
v_exp_f32 v105, v105
v_exp_f32 v106, v106
v_exp_f32 v107, v107
v_exp_f32 v108, v108
v_exp_f32 v109, v109
v_exp_f32 v110, v110
v_exp_f32 v111, v111
v_cvt_pk_bf16_f32 v96, v96, v97
v_cvt_pk_bf16_f32 v97, v98, v99
v_cvt_pk_bf16_f32 v98, v100, v101
v_cvt_pk_bf16_f32 v99, v102, v103
v_cvt_pk_bf16_f32 v100, v104, v105
v_cvt_pk_bf16_f32 v101, v106, v107
v_cvt_pk_bf16_f32 v102, v108, v109
v_cvt_pk_bf16_f32 v103, v110, v111
s_waitcnt lgkmcnt(10)
v_mfma_f32_32x32x16_bf16 a[0:15], a[48:51], v[96:99], a[0:15]
s_waitcnt lgkmcnt(8)
v_mfma_f32_32x32x16_bf16 a[0:15], a[52:55], v[100:103], a[0:15]
ds_read_b64_tr_b16 a[48:49], v3 offset:1792
ds_read_b64_tr_b16 a[50:51], v3 offset:1856
ds_read_b64_tr_b16 a[52:53], v3 offset:1920
ds_read_b64_tr_b16 a[54:55], v3 offset:1984
v_fma_f32 v112, v112, s26, -v29
v_fma_f32 v113, v113, s26, -v29
v_fma_f32 v114, v114, s26, -v29
v_fma_f32 v115, v115, s26, -v29
v_fma_f32 v116, v116, s26, -v29
v_fma_f32 v117, v117, s26, -v29
v_fma_f32 v118, v118, s26, -v29
v_fma_f32 v119, v119, s26, -v29
v_fma_f32 v120, v120, s26, -v29
v_fma_f32 v121, v121, s26, -v29
v_fma_f32 v122, v122, s26, -v29
v_fma_f32 v123, v123, s26, -v29
v_fma_f32 v124, v124, s26, -v29
v_fma_f32 v125, v125, s26, -v29
v_fma_f32 v126, v126, s26, -v29
v_fma_f32 v127, v127, s26, -v29
v_exp_f32 v112, v112
v_exp_f32 v113, v113
v_exp_f32 v114, v114
v_exp_f32 v115, v115
v_exp_f32 v116, v116
v_exp_f32 v117, v117
v_exp_f32 v118, v118
v_exp_f32 v119, v119
v_exp_f32 v120, v120
v_exp_f32 v121, v121
v_exp_f32 v122, v122
v_exp_f32 v123, v123
v_exp_f32 v124, v124
v_exp_f32 v125, v125
v_exp_f32 v126, v126
v_exp_f32 v127, v127
v_cvt_pk_bf16_f32 v112, v112, v113
v_cvt_pk_bf16_f32 v113, v114, v115
v_cvt_pk_bf16_f32 v114, v116, v117
v_cvt_pk_bf16_f32 v115, v118, v119
v_cvt_pk_bf16_f32 v116, v120, v121
v_cvt_pk_bf16_f32 v117, v122, v123
v_cvt_pk_bf16_f32 v118, v124, v125
v_cvt_pk_bf16_f32 v119, v126, v127
s_waitcnt lgkmcnt(10)
v_mfma_f32_32x32x16_bf16 a[0:15], a[56:59], v[112:115], a[0:15]
s_waitcnt lgkmcnt(8)
v_mfma_f32_32x32x16_bf16 a[0:15], a[60:63], v[116:119], a[0:15]
ds_read_b64_tr_b16 a[56:57], v3 offset:2048
ds_read_b64_tr_b16 a[58:59], v3 offset:2112
ds_read_b64_tr_b16 a[60:61], v3 offset:2176
ds_read_b64_tr_b16 a[62:63], v3 offset:2240
v_fma_f32 v128, v128, s26, -v29
v_fma_f32 v129, v129, s26, -v29
v_fma_f32 v130, v130, s26, -v29
v_fma_f32 v131, v131, s26, -v29
v_fma_f32 v132, v132, s26, -v29
v_fma_f32 v133, v133, s26, -v29
v_fma_f32 v134, v134, s26, -v29
v_fma_f32 v135, v135, s26, -v29
v_fma_f32 v136, v136, s26, -v29
v_fma_f32 v137, v137, s26, -v29
v_fma_f32 v138, v138, s26, -v29
v_fma_f32 v139, v139, s26, -v29
v_fma_f32 v140, v140, s26, -v29
v_fma_f32 v141, v141, s26, -v29
v_fma_f32 v142, v142, s26, -v29
v_fma_f32 v143, v143, s26, -v29
v_exp_f32 v128, v128
v_exp_f32 v129, v129
v_exp_f32 v130, v130
v_exp_f32 v131, v131
v_exp_f32 v132, v132
v_exp_f32 v133, v133
v_exp_f32 v134, v134
v_exp_f32 v135, v135
v_exp_f32 v136, v136
v_exp_f32 v137, v137
v_exp_f32 v138, v138
v_exp_f32 v139, v139
v_exp_f32 v140, v140
v_exp_f32 v141, v141
v_exp_f32 v142, v142
v_exp_f32 v143, v143
v_cvt_pk_bf16_f32 v128, v128, v129
v_cvt_pk_bf16_f32 v129, v130, v131
v_cvt_pk_bf16_f32 v130, v132, v133
v_cvt_pk_bf16_f32 v131, v134, v135
v_cvt_pk_bf16_f32 v132, v136, v137
v_cvt_pk_bf16_f32 v133, v138, v139
v_cvt_pk_bf16_f32 v134, v140, v141
v_cvt_pk_bf16_f32 v135, v142, v143
s_waitcnt lgkmcnt(10)
v_mfma_f32_32x32x16_bf16 a[0:15], a[40:43], v[128:131], a[0:15]
s_waitcnt lgkmcnt(8)
v_mfma_f32_32x32x16_bf16 a[0:15], a[44:47], v[132:135], a[0:15]
v_fma_f32 v144, v144, s26, -v29
v_fma_f32 v145, v145, s26, -v29
v_fma_f32 v146, v146, s26, -v29
v_fma_f32 v147, v147, s26, -v29
v_fma_f32 v148, v148, s26, -v29
v_fma_f32 v149, v149, s26, -v29
v_fma_f32 v150, v150, s26, -v29
v_fma_f32 v151, v151, s26, -v29
v_fma_f32 v152, v152, s26, -v29
v_fma_f32 v153, v153, s26, -v29
v_fma_f32 v154, v154, s26, -v29
v_fma_f32 v155, v155, s26, -v29
v_fma_f32 v156, v156, s26, -v29
v_fma_f32 v157, v157, s26, -v29
v_fma_f32 v158, v158, s26, -v29
v_fma_f32 v159, v159, s26, -v29
v_exp_f32 v144, v144
v_exp_f32 v145, v145
v_exp_f32 v146, v146
v_exp_f32 v147, v147
v_exp_f32 v148, v148
v_exp_f32 v149, v149
v_exp_f32 v150, v150
v_exp_f32 v151, v151
v_exp_f32 v152, v152
v_exp_f32 v153, v153
v_exp_f32 v154, v154
v_exp_f32 v155, v155
v_exp_f32 v156, v156
v_exp_f32 v157, v157
v_exp_f32 v158, v158
v_exp_f32 v159, v159
v_cvt_pk_bf16_f32 v144, v144, v145
v_cvt_pk_bf16_f32 v145, v146, v147
v_cvt_pk_bf16_f32 v146, v148, v149
v_cvt_pk_bf16_f32 v147, v150, v151
v_cvt_pk_bf16_f32 v148, v152, v153
v_cvt_pk_bf16_f32 v149, v154, v155
v_cvt_pk_bf16_f32 v150, v156, v157
v_cvt_pk_bf16_f32 v151, v158, v159
s_waitcnt lgkmcnt(6)
v_mfma_f32_32x32x16_bf16 a[0:15], a[48:51], v[144:147], a[0:15]
s_waitcnt lgkmcnt(4)
v_mfma_f32_32x32x16_bf16 a[0:15], a[52:55], v[148:151], a[0:15]
v_fma_f32 v160, v160, s26, -v29
v_fma_f32 v161, v161, s26, -v29
v_fma_f32 v162, v162, s26, -v29
v_fma_f32 v163, v163, s26, -v29
v_fma_f32 v164, v164, s26, -v29
v_fma_f32 v165, v165, s26, -v29
v_fma_f32 v166, v166, s26, -v29
v_fma_f32 v167, v167, s26, -v29
v_fma_f32 v168, v168, s26, -v29
v_fma_f32 v169, v169, s26, -v29
v_fma_f32 v170, v170, s26, -v29
v_fma_f32 v171, v171, s26, -v29
v_fma_f32 v172, v172, s26, -v29
v_fma_f32 v173, v173, s26, -v29
v_fma_f32 v174, v174, s26, -v29
v_fma_f32 v175, v175, s26, -v29
v_exp_f32 v160, v160
v_exp_f32 v161, v161
v_exp_f32 v162, v162
v_exp_f32 v163, v163
v_exp_f32 v164, v164
v_exp_f32 v165, v165
v_exp_f32 v166, v166
v_exp_f32 v167, v167
v_exp_f32 v168, v168
v_exp_f32 v169, v169
v_exp_f32 v170, v170
v_exp_f32 v171, v171
v_exp_f32 v172, v172
v_exp_f32 v173, v173
v_exp_f32 v174, v174
v_exp_f32 v175, v175
v_cvt_pk_bf16_f32 v160, v160, v161
v_cvt_pk_bf16_f32 v161, v162, v163
v_cvt_pk_bf16_f32 v162, v164, v165
v_cvt_pk_bf16_f32 v163, v166, v167
v_cvt_pk_bf16_f32 v164, v168, v169
v_cvt_pk_bf16_f32 v165, v170, v171
v_cvt_pk_bf16_f32 v166, v172, v173
v_cvt_pk_bf16_f32 v167, v174, v175
s_waitcnt lgkmcnt(2)
v_mfma_f32_32x32x16_bf16 a[0:15], a[56:59], v[160:163], a[0:15]
s_waitcnt lgkmcnt(0)
v_mfma_f32_32x32x16_bf16 a[0:15], a[60:63], v[164:167], a[0:15]
s_nop 11
v_accvgpr_read_b32 v30, a12
v_accvgpr_read_b32 v32, a0
v_accvgpr_read_b32 v33, a1
v_accvgpr_read_b32 v34, a2
v_accvgpr_read_b32 v35, a3
v_accvgpr_read_b32 v36, a4
v_accvgpr_read_b32 v37, a5
v_accvgpr_read_b32 v38, a6
v_accvgpr_read_b32 v39, a7
v_accvgpr_read_b32 v40, a8
v_accvgpr_read_b32 v41, a9
v_accvgpr_read_b32 v42, a10
v_accvgpr_read_b32 v43, a11
v_mul_f32 v30, 1.4426950408889634, v30
v_rcp_f32 v30, v30
s_nop 0
v_mul_f32 v32, v32, v30
v_mul_f32 v33, v33, v30
v_mul_f32 v34, v34, v30
v_mul_f32 v35, v35, v30
v_mul_f32 v36, v36, v30
v_mul_f32 v37, v37, v30
v_mul_f32 v38, v38, v30
v_mul_f32 v39, v39, v30
v_mul_f32 v40, v40, v30
v_mul_f32 v41, v41, v30
v_mul_f32 v42, v42, v30
v_mul_f32 v43, v43, v30
v_cvt_pk_bf16_f32 v32, v32, v33
v_cvt_pk_bf16_f32 v33, v34, v35
v_cvt_pk_bf16_f32 v34, v36, v37
v_cvt_pk_bf16_f32 v35, v38, v39
v_cvt_pk_bf16_f32 v36, v40, v41
v_cvt_pk_bf16_f32 v37, v42, v43
s_lshl_b32 s37, s36, 3
s_lshl_b32 s38, s40, 1
s_add_u32 s37, s37, s38
s_add_u32 s37, s37, 1
s_lshl_b32 s37, s37, 5
s_add_u32 s37, s37, s35
s_lshl_b32 s38, s37, 10
s_add_u32 s38, s38, 16777216
s_lshl_b32 s37, s37, 8
s_add_u32 s37, s37, 18874368
v_lshlrev_b32 v6, 4, v1
v_lshlrev_b32 v8, 3, v1
buffer_store_dwordx4 v[32:35], v6, s[16:19], s38 offen sc1
s_mov_b32 exec_hi, 0
buffer_store_dwordx2 v[36:37], v8, s[16:19], s37 offen sc1
s_mov_b64 exec, -1
s_lshl_b32 s37, s36, 2
s_add_u32 s37, s37, s40
s_lshl_b32 s37, s37, 5
s_add_u32 s37, s37, s35
s_lshl_b32 s37, s37, 2
s_add_u32 s37, s37, 19922944
v_mov_b32 v10, 1
v_mov_b32 v11, 0
s_waitcnt vmcnt(0)
s_mov_b64 exec, 1
buffer_store_dword v10, v11, s[16:19], s37 offen sc1
s_endpgm
K2_END:

s_endpgm
TEXT_END:
s_endpgm
.section .rodata,"a"
.p2align 6
.amdhsa_kernel k2_kernel
  .amdhsa_next_free_vgpr 256
  .amdhsa_next_free_sgpr 102
  .amdhsa_accum_offset 192
  .amdhsa_group_segment_fixed_size 0
  .amdhsa_kernarg_size 80
  .amdhsa_user_sgpr_count 2
  .amdhsa_user_sgpr_kernarg_segment_ptr 1
  .amdhsa_system_sgpr_workgroup_id_x 1
.end_amdhsa_kernel
.text
```
